```python
import torch

def _softmax(x, axis=-1):
    return torch.softmax(x, dim=axis)
def _gelu(x):
    return torch.nn.functional.gelu(x, approximate="tanh")
def _silu(x):
    return torch.nn.functional.silu(x)
def _sigmoid(x):
    return torch.sigmoid(x)
def _layernorm(x, axis=-1, eps=1e-5):
    m = x.mean(dim=axis, keepdim=True)
    v = x.var(dim=axis, keepdim=True, unbiased=False)
    return (x - m) / torch.sqrt(v + eps)
def _scatter_add(tgt, idx, src, axis=0):
    return tgt.clone().index_add_(axis, idx, src)
def _segment_sum(src, seg, n):
    out = torch.zeros((n,) + src.shape[1:], dtype=src.dtype)
    return out.index_add_(0, seg, src)
def _pad(x, pw):
    flat = tuple(v for pair in reversed(pw) for v in pair)
    return torch.nn.functional.pad(x, flat)

kernel_name = 'standalone__batchnorm__sampling'

def setup_inputs():

    _w = (lambda a: (lambda t: t.to(torch.bfloat16) if t.is_floating_point() else t)(torch.as_tensor(a)))
    B, S, C = 1024, 16, 448
    K = 3
    return {
        "x": _w((lambda *s: torch.randn(*s, dtype=torch.bfloat16) * 0.05)(B, S, C)),
        "w": _w((lambda *s: torch.randn(*s, dtype=torch.bfloat16) * 0.05)(K, C, C) * (1.0 / (K * C) ** 0.5)),
        "mean": _w((lambda *s: torch.randn(*s, dtype=torch.bfloat16) * 0.05)(C) * 0.1),
        "var": _w(torch.abs((lambda *s: torch.randn(*s, dtype=torch.bfloat16) * 0.05)(C)) + 0.5),
        "g": _w((lambda *s: torch.randn(*s, dtype=torch.bfloat16) * 0.05)(C) + 1.0),
        "b": _w((lambda *s: torch.randn(*s, dtype=torch.bfloat16) * 0.05)(C) * 0.1),
    }

def reference(x, w, mean, var, g, b):
    K = 3
    P = K // 2
    S = x.shape[1]
    xp = _pad(x, ((0, 0), (P, P), (0, 0)))
    y = sum(torch.einsum('bsc,cd->bsd', xp[:, k:k + S, :], w[k]) for k in range(K))
    inv_std = 1.0 / torch.sqrt(var + 1e-5)
    y = (y - mean) * (g * inv_std) + b
    return _silu(y)
```

```asm
; @launch grid=(256,1,1) block=(256,1,1) lds=160768
.amdgcn_target "amdgcn-amd-amdhsa--gfx950"
.text
.globl standalone__batchnorm__sampling_kernel
.p2align 8
.type standalone__batchnorm__sampling_kernel,@function
standalone__batchnorm__sampling_kernel:
s_load_dwordx2 s[24:25], s[0:1], 0
s_load_dwordx2 s[28:29], s[0:1], 8
s_load_dwordx8 s[12:19], s[0:1], 16
s_load_dwordx2 s[32:33], s[0:1], 48
s_cmp_ge_u32 s2, 256
s_cbranch_scc1 L_exit
v_lshrrev_b32 v58, 6, v0
v_and_b32 v1, 63, v0
s_lshr_b32 s39, s2, 3
s_getpc_b64 s[8:9]
L_pc:
s_lshl_b32 s3, s39, 11
v_lshrrev_b32 v56, 4, v0
v_lshl_add_u32 v56, v56, 7, s3
v_min_u32 v56, L_last-L_pc, v56
v_mov_b32 v57, s9
v_add_co_u32 v56, vcc, s8, v56
v_readfirstlane_b32 s36, v58
s_and_b32 s38, s2, 7
v_addc_co_u32 v57, vcc, 0, v57, vcc
global_load_dword v4, v[56:57], off
s_and_b32 s37, s39, 3
s_lshr_b32 s3, s39, 2
s_lshl_b32 s38, s38, 3
s_add_u32 s38, s38, s3
s_mul_i32 s40, s38, 229376
s_mul_i32 s3, s36, 3584
s_lshl_b32 s20, s36, 13
s_mul_i32 s21, s36, 3072
s_sub_u32 s4, 20608, s3
s_movk_i32 s52, 896
s_bitcmp1_b32 s36, 1
s_cselect_b32 s3, s4, s3
s_cselect_b32 s52, -896, s52
s_add_u32 s8, s40, s3
s_add_u32 s9, s8, s52
s_add_u32 s9, s9, s52
s_sub_u32 s5, s52, 2048
s_add_u32 s100, s20, 4096
s_bitcmp1_b32 9, s37
s_cselect_b32 s3, s9, s8
s_cselect_b32 s9, s8, s9
s_cselect_b32 s4, s100, s20
s_cselect_b32 s100, s20, s100
s_mov_b32 s8, s3
s_mov_b32 s20, s4
v_lshrrev_b32 v59, 3, v1
v_and_b32 v60, 7, v1
v_lshrrev_b32 v61, 4, v1
v_xor_b32 v62, v60, v61
v_mul_u32_u24 v63, 14336, v59
v_lshl_add_u32 v63, v62, 4, v63
s_bitcmp1_b32 s37, 1
s_cselect_b32 s3, 114688, 0
s_sub_u32 s4, 117760, s3
s_addk_i32 s3, 4096
v_xor_b32 v7, 64, v63
v_add_u32 v6, s3, v63
v_add_u32 v7, s4, v7
v_add_u32 v8, s5, v6
v_add_u32 v9, s5, v7
s_mul_i32 s3, s39, 42
s_mul_i32 s4, s36, 11
s_add_u32 s3, s3, s4
v_min_u32 v64, 10, v1
v_add_u32 v64, s3, v64
v_min_u32 v64, 1343, v64
v_mul_u32_u24 v65, 2341, v64
v_lshrrev_b32 v65, 20, v65
v_mul_u32_u24 v65, 344064, v65
v_lshl_add_u32 v50, v64, 7, v65
s_mov_b32 s30, 1204224
s_mov_b32 s31, 0x20000
s_mov_b32 s26, 14684160
s_mov_b32 s27, 0x20000
s_movk_i32 s55, 0
s_mov_b32 s48, s8
s_add_u32 m0, s20, 32768
s_waitcnt lgkmcnt(0)
buffer_load_dword v2, v50, s[28:31], s55 offen
s_sub_u32 s24, s24, 4096
s_subb_u32 s25, s25, 0
buffer_load_dwordx4 v6, s[24:27], s48 offen offset:0 nt lds
buffer_load_dwordx4 v8, s[24:27], s48 offen offset:2048 nt lds
buffer_load_dwordx4 v7, s[24:27], s48 offen offset:1024 nt lds
buffer_load_dwordx4 v9, s[24:27], s48 offen offset:3072 nt lds
s_mov_b32 s49, s9
s_add_u32 m0, s100, 32768
s_nop 0
buffer_load_dwordx4 v6, s[24:27], s49 offen offset:0 nt lds
buffer_load_dwordx4 v8, s[24:27], s49 offen offset:2048 nt lds
buffer_load_dwordx4 v7, s[24:27], s49 offen offset:1024 nt lds
buffer_load_dwordx4 v9, s[24:27], s49 offen offset:3072 nt lds
s_lshl_b32 s6, s37, 8
s_lshr_b32 s4, s37, 1
s_mul_i32 s7, s4, 448
s_add_u32 s7, s7, 192
s_mul_i32 s4, s4, 192
s_sub_u32 s10, s6, s4
s_add_u32 s10, s10, 128
s_lshl_b32 s3, s36, 2
s_and_b32 s3, s3, 4
v_and_b32 v61, 1, v61
v_lshl_add_u32 v61, v61, 1, s3
v_xor_b32 v60, v60, v61
s_mul_i32 s3, s36, 7168
v_mul_u32_u24 v59, 896, v59
v_lshl_add_u32 v59, v60, 4, v59
v_add_u32 v59, s3, v59
v_add_u32 v10, s6, v59
v_add_u32 v11, 400384, v10
v_add_u32 v12, 800768, v10
s_sub_u32 s11, s7, 64
v_mov_b32 v61, s10
v_mov_b32 v62, s11
v_cmp_gt_u32 vcc, 4, v60
s_mov_b32 s50, 0xbfb8aa3b
s_mov_b32 s51, s50
s_mov_b32 s34, 14680064
s_mov_b32 s35, 0x20000
v_cndmask_b32 v61, v62, v61, vcc
v_add_u32 v13, v61, v59
v_add_u32 v14, 400384, v13
v_add_u32 v15, 800768, v13
s_movk_i32 s53, 0
s_add_u32 m0, s21, 98304
s_nop 0
buffer_load_dwordx4 v10, s[28:31], s53 offen offset:0  lds
buffer_load_dwordx4 v11, s[28:31], s53 offen offset:1024  lds
buffer_load_dwordx4 v12, s[28:31], s53 offen offset:2048  lds
s_and_b32 s3, s36, 1
s_lshr_b32 s4, s36, 1
s_lshl_b32 s5, s4, 11
s_sub_u32 s5, 1024, s5
v_lshrrev_b32 v56, 4, v1
v_bfe_u32 v57, v1, 2, 2
v_mul_u32_u24 v58, 3072, v56
v_and_b32 v59, 3, v1
v_lshl_add_u32 v58, v57, 7, v58
v_lshl_add_u32 v58, v59, 3, v58
v_bfe_u32 v60, v1, 3, 2
v_lshl_add_u32 v58, v60, 5, v58
v_add_u32 v58, 99328, v58
s_lshl_b32 s11, s3, 6
v_xor_b32 v17, s11, v58
v_xor_b32 v20, 32, v17
s_lshl_b32 s54, s3, 5
v_xor_b32 v23, s54, v58
v_xor_b32 v26, 64, v23
v_subrev_u32 v16, s5, v17
v_add_u32 v18, s5, v17
v_subrev_u32 v19, s5, v20
v_add_u32 v21, s5, v20
v_subrev_u32 v22, s5, v23
v_add_u32 v24, s5, v23
v_subrev_u32 v25, s5, v26
v_add_u32 v27, s5, v26
v_subrev_u32 v28, 65536, v22
v_subrev_u32 v29, 65536, v23
v_subrev_u32 v30, 65536, v24
v_subrev_u32 v31, 65536, v25
v_subrev_u32 v32, 65536, v26
v_subrev_u32 v33, 65536, v27
v_and_b32 v57, 15, v1
v_lshrrev_b32 v58, 1, v57
v_xor_b32 v60, v58, v56
v_lshlrev_b32 v61, 7, v57
v_lshl_add_u32 v61, v60, 4, v61
s_bitcmp1_b32 s37, 1
s_cselect_b32 s5, 1088, 0
v_xor_b32 v61, s5, v61
s_lshl_b32 s5, s4, 14
v_add_u32 v34, s5, v61
s_sub_u32 s5, 30720, s5
v_add_u32 v38, s5, v61
v_xor_b32 v35, 64, v34
v_xor_b32 v39, 64, v38
v_add_u32 v36, 65536, v34
v_add_u32 v37, 65536, v35
v_add_u32 v40, 65536, v38
v_add_u32 v41, 65536, v39
s_mul_i32 s5, s4, 13440
s_add_u32 s40, s40, s5
s_add_u32 s41, s40, s52
s_add_u32 s42, s41, s52
s_add_u32 s43, s42, s52
s_add_u32 s44, s43, s52
s_add_u32 s45, s44, s52
s_add_u32 s46, s45, s52
s_add_u32 s47, s46, s52
s_cmp_eq_u32 s3, 0
s_cselect_b32 s56, s40, s41
s_cselect_b32 s57, s42, s43
s_cselect_b32 s58, s44, s45
s_cselect_b32 s59, s46, s47
v_mul_u32_u24 v61, 14336, v57
v_lshrrev_b32 v62, 1, v56
v_lshl_add_u32 v61, v62, 4, v61
v_and_b32 v63, 1, v56
v_lshl_add_u32 v61, v63, 5, v61
s_add_u32 s5, s6, s11
v_add_u32 v42, s5, v61
s_lshl_b32 s5, s3, 1
v_or_b32 v62, s5, v62
v_and_b32 v58, 3, v58
v_xor_b32 v62, v62, v58
v_lshlrev_b32 v61, 6, v57
v_lshl_add_u32 v61, v62, 4, v61
v_lshl_add_u32 v61, v63, 3, v61
s_mul_i32 s5, s4, 12288
s_add_u32 s5, s5, 0
v_add_u32 v45, s5, v61
v_lshrrev_b32 v61, 2, v1
v_bfe_u32 v62, v1, 3, 2
v_xor_b32 v62, v62, v59
v_lshlrev_b32 v63, 6, v61
v_lshl_add_u32 v63, v62, 4, v63
s_lshl_b32 s4, s3, 10
s_add_u32 s5, s5, s4
v_add_u32 v46, s5, v63
v_mul_u32_u24 v61, 14336, v61
v_lshl_add_u32 v61, v59, 4, v61
v_add_u32 v43, s10, v61
v_add_u32 v44, s7, v61
v_lshlrev_b32 v61, 4, v56
v_add_u32 v61, 159744, v61
s_lshl_b32 s4, s3, 7
v_add_u32 v47, s4, v61
s_add_u32 s4, s11, 256
v_add_u32 v48, s4, v61
v_lshlrev_b32 v49, 3, v1
v_add_u32 v49, 159744, v49
s_sub_u32 s4, s10, 128
s_sub_u32 s5, s7, 192
v_mov_b32 v68, s6
v_mov_b32 v69, s4
v_cmp_gt_u32 vcc, 32, v1
v_mov_b32 v70, s5
s_nop 0
v_cndmask_b32 v68, v69, v68, vcc
v_cmp_gt_u32 vcc, 48, v1
s_nop 1
v_cndmask_b32 v68, v70, v68, vcc
v_lshl_add_u32 v68, v1, 2, v68
s_mov_b64 exec, 0
s_bitcmp1_b32 9, s37
s_cbranch_scc1 L_hop1
s_cmp_eq_u32 s36, 0
s_cbranch_scc1 L_pad0_1
s_cmp_eq_u32 s36, 1
s_cbranch_scc1 L_pad0_2
s_cmp_eq_u32 s36, 2
s_cbranch_scc1 L_pad0_3
s_branch L_pad0_4
L_hop1:
s_cmp_eq_u32 s36, 0
s_cbranch_scc1 L_pad1_1
s_cmp_eq_u32 s36, 1
s_cbranch_scc1 L_pad1_2
s_cmp_eq_u32 s36, 2
s_cbranch_scc1 L_pad1_3
s_branch L_pad1_4
L_exit:
s_endpgm
.p2align 12
L_body0:
s_mov_b64 exec, -1
s_addk_i32 m0, 12288
s_nop 0
buffer_load_dwordx4 v13, s[28:31], s53 offen offset:0  lds
buffer_load_dwordx4 v14, s[28:31], s53 offen offset:1024  lds
buffer_load_dwordx4 v15, s[28:31], s53 offen offset:2048  lds
s_addk_i32 s53, 28672
s_addk_i32 m0, 12288
s_nop 0
buffer_load_dwordx4 v10, s[28:31], s53 offen offset:0  lds
buffer_load_dwordx4 v11, s[28:31], s53 offen offset:1024  lds
buffer_load_dwordx4 v12, s[28:31], s53 offen offset:2048  lds
s_addk_i32 m0, 12288
s_nop 0
buffer_load_dwordx4 v13, s[28:31], s53 offen offset:0  lds
buffer_load_dwordx4 v14, s[28:31], s53 offen offset:1024  lds
buffer_load_dwordx4 v15, s[28:31], s53 offen offset:2048  lds
s_waitcnt vmcnt(9)
s_barrier
ds_read_b64_tr_b16 a[224:225], v18 offset:0
ds_read_b64_tr_b16 a[226:227], v18 offset:512
ds_read_b128 a[32:35], v38 offset:32768
ds_read_b64_tr_b16 a[220:221], v17 offset:0
ds_read_b64_tr_b16 a[222:223], v17 offset:512
ds_read_b128 a[28:31], v34 offset:47104
ds_read_b64_tr_b16 a[216:217], v16 offset:0
ds_read_b64_tr_b16 a[218:219], v16 offset:512
ds_read_b128 a[24:27], v34 offset:45056
ds_read_b128 a[20:23], v34 offset:43008
s_waitcnt lgkmcnt(7)
v_mfma_f32_16x16x32_bf16 v[200:203], a[224:227], a[32:35], 0
ds_read_b128 a[16:19], v34 offset:40960
ds_read_b128 a[12:15], v34 offset:38912
s_waitcnt lgkmcnt(6)
v_mfma_f32_16x16x32_bf16 v[200:203], a[220:223], a[28:31], v[200:203]
ds_read_b128 a[8:11], v34 offset:36864
ds_read_b128 a[4:7], v34 offset:34816
s_waitcnt lgkmcnt(5)
v_mfma_f32_16x16x32_bf16 v[200:203], a[216:219], a[24:27], v[200:203]
ds_read_b128 a[0:3], v34 offset:32768
ds_read_b64_tr_b16 a[232:233], v20 offset:0
s_waitcnt lgkmcnt(6)
v_mfma_f32_16x16x32_bf16 v[192:195], a[216:219], a[20:23], 0
ds_read_b64_tr_b16 a[234:235], v20 offset:512
ds_read_b64_tr_b16 a[236:237], v21 offset:0
v_mfma_f32_16x16x32_bf16 v[192:195], a[220:223], a[24:27], v[192:195]
ds_read_b64_tr_b16 a[238:239], v21 offset:512
ds_read_b64_tr_b16 a[228:229], v19 offset:0
v_mfma_f32_16x16x32_bf16 v[192:195], a[224:227], a[28:31], v[192:195]
ds_read_b64_tr_b16 a[230:231], v19 offset:512
v_mfma_f32_16x16x32_bf16 v[184:187], a[224:227], a[24:27], 0
v_mfma_f32_16x16x32_bf16 v[184:187], a[220:223], a[20:23], v[184:187]
s_waitcnt lgkmcnt(10)
v_mfma_f32_16x16x32_bf16 v[184:187], a[216:219], a[16:19], v[184:187]
s_waitcnt lgkmcnt(9)
v_mfma_f32_16x16x32_bf16 v[176:179], a[216:219], a[12:15], 0
v_mfma_f32_16x16x32_bf16 v[176:179], a[220:223], a[16:19], v[176:179]
v_mfma_f32_16x16x32_bf16 v[176:179], a[224:227], a[20:23], v[176:179]
v_mfma_f32_16x16x32_bf16 v[168:171], a[224:227], a[16:19], 0
v_mfma_f32_16x16x32_bf16 v[168:171], a[220:223], a[12:15], v[168:171]
s_waitcnt lgkmcnt(1)
v_mfma_f32_16x16x32_bf16 v[168:171], a[216:219], a[8:11], v[168:171]
v_mfma_f32_16x16x32_bf16 v[160:163], a[216:219], a[4:7], 0
s_mov_b32 s55, 57344
v_mfma_f32_16x16x32_bf16 v[160:163], a[220:223], a[8:11], v[160:163]
buffer_load_dword v3, v50, s[28:31], s55 offen
v_mfma_f32_16x16x32_bf16 v[160:163], a[224:227], a[12:15], v[160:163]
v_mfma_f32_16x16x32_bf16 v[152:155], a[224:227], a[8:11], 0
s_addk_i32 s48, 128
v_mfma_f32_16x16x32_bf16 v[152:155], a[220:223], a[4:7], v[152:155]
s_add_u32 m0, s20, 65536
v_mfma_f32_16x16x32_bf16 v[152:155], a[216:219], a[0:3], v[152:155]
buffer_load_dwordx4 v6, s[24:27], s48 offen offset:0 nt lds
v_mfma_f32_16x16x32_bf16 v[144:147], a[220:223], a[0:3], 0
v_mfma_f32_16x16x32_bf16 v[144:147], a[224:227], a[4:7], v[144:147]
v_mfma_f32_16x16x32_bf16 v[148:151], a[232:235], a[0:3], 0
v_mfma_f32_16x16x32_bf16 v[148:151], a[236:239], a[4:7], v[148:151]
buffer_load_dwordx4 v8, s[24:27], s48 offen offset:2048 nt lds
v_mfma_f32_16x16x32_bf16 v[156:159], a[236:239], a[8:11], 0
s_waitcnt vmcnt(9) lgkmcnt(0)
s_barrier
ds_read_b64_tr_b16 a[240:241], v22 offset:12288
ds_read_b64_tr_b16 a[242:243], v22 offset:12800
v_mfma_f32_16x16x32_bf16 v[156:159], a[232:235], a[4:7], v[156:159]
ds_read_b64_tr_b16 a[244:245], v23 offset:12288
ds_read_b64_tr_b16 a[246:247], v23 offset:12800
v_mfma_f32_16x16x32_bf16 v[156:159], a[228:231], a[0:3], v[156:159]
ds_read_b64_tr_b16 a[248:249], v24 offset:12288
ds_read_b64_tr_b16 a[250:251], v24 offset:12800
v_mfma_f32_16x16x32_bf16 v[164:167], a[228:231], a[4:7], 0
buffer_load_dwordx4 v7, s[24:27], s48 offen offset:1024 nt lds
v_mfma_f32_16x16x32_bf16 v[164:167], a[232:235], a[8:11], v[164:167]
v_mfma_f32_16x16x32_bf16 v[164:167], a[236:239], a[12:15], v[164:167]
v_mfma_f32_16x16x32_bf16 v[172:175], a[236:239], a[16:19], 0
v_mfma_f32_16x16x32_bf16 v[172:175], a[232:235], a[12:15], v[172:175]
buffer_load_dwordx4 v9, s[24:27], s48 offen offset:3072 nt lds
v_mfma_f32_16x16x32_bf16 v[172:175], a[228:231], a[8:11], v[172:175]
v_mfma_f32_16x16x32_bf16 v[180:183], a[228:231], a[12:15], 0
s_addk_i32 s49, 128
v_mfma_f32_16x16x32_bf16 v[180:183], a[232:235], a[16:19], v[180:183]
s_add_u32 m0, s100, 65536
v_mfma_f32_16x16x32_bf16 v[180:183], a[236:239], a[20:23], v[180:183]
buffer_load_dwordx4 v6, s[24:27], s49 offen offset:0 nt lds
v_mfma_f32_16x16x32_bf16 v[188:191], a[236:239], a[24:27], 0
v_mfma_f32_16x16x32_bf16 v[188:191], a[232:235], a[20:23], v[188:191]
ds_read_b64_tr_b16 v[100:101], v26 offset:12288
v_mfma_f32_16x16x32_bf16 v[188:191], a[228:231], a[16:19], v[188:191]
ds_read_b64_tr_b16 v[102:103], v26 offset:12800
v_mfma_f32_16x16x32_bf16 v[196:199], a[228:231], a[20:23], 0
buffer_load_dwordx4 v8, s[24:27], s49 offen offset:2048 nt lds
v_mfma_f32_16x16x32_bf16 v[196:199], a[232:235], a[24:27], v[196:199]
ds_read_b64_tr_b16 v[104:105], v27 offset:12288
v_mfma_f32_16x16x32_bf16 v[196:199], a[236:239], a[28:31], v[196:199]
ds_read_b64_tr_b16 v[106:107], v27 offset:12800
v_mfma_f32_16x16x32_bf16 v[204:207], a[236:239], a[32:35], 0
ds_read_b64_tr_b16 a[252:253], v25 offset:12288
v_mfma_f32_16x16x32_bf16 v[204:207], a[232:235], a[28:31], v[204:207]
buffer_load_dwordx4 v7, s[24:27], s49 offen offset:1024 nt lds
v_mfma_f32_16x16x32_bf16 v[204:207], a[228:231], a[24:27], v[204:207]
ds_read_b64_tr_b16 a[254:255], v25 offset:12800
s_waitcnt lgkmcnt(6)
v_mfma_f32_16x16x32_bf16 v[236:239], a[240:243], a[24:27], 0
v_mfma_f32_16x16x32_bf16 v[236:239], a[244:247], a[28:31], v[236:239]
v_mfma_f32_16x16x32_bf16 v[236:239], a[248:251], a[32:35], v[236:239]
buffer_load_dwordx4 v9, s[24:27], s49 offen offset:3072 nt lds
v_mfma_f32_16x16x32_bf16 v[232:235], a[248:251], a[28:31], 0
v_mfma_f32_16x16x32_bf16 v[232:235], a[244:247], a[24:27], v[232:235]
v_mfma_f32_16x16x32_bf16 v[232:235], a[240:243], a[20:23], v[232:235]
s_waitcnt vmcnt(9) lgkmcnt(3)
s_barrier
ds_read_b64_tr_b16 v[116:117], v18 offset:24576
ds_read_b64_tr_b16 v[118:119], v18 offset:25088
v_mfma_f32_16x16x32_bf16 v[228:231], a[240:243], a[16:19], 0
s_addk_i32 s53, 28672
ds_read_b128 a[68:71], v39 offset:32768
ds_read_b64_tr_b16 v[112:113], v17 offset:24576
v_mfma_f32_16x16x32_bf16 v[228:231], a[244:247], a[20:23], v[228:231]
s_add_u32 m0, s21, 147456
ds_read_b64_tr_b16 v[114:115], v17 offset:25088
v_mfma_f32_16x16x32_bf16 v[228:231], a[248:251], a[24:27], v[228:231]
buffer_load_dwordx4 v10, s[28:31], s53 offen offset:0  lds
v_mfma_f32_16x16x32_bf16 v[224:227], a[248:251], a[20:23], 0
ds_read_b128 a[64:67], v35 offset:47104
ds_read_b64_tr_b16 v[108:109], v16 offset:24576
v_mfma_f32_16x16x32_bf16 v[224:227], a[244:247], a[16:19], v[224:227]
ds_read_b64_tr_b16 v[110:111], v16 offset:25088
ds_read_b128 a[60:63], v35 offset:45056
v_mfma_f32_16x16x32_bf16 v[224:227], a[240:243], a[12:15], v[224:227]
ds_read_b128 a[56:59], v35 offset:43008
v_mfma_f32_16x16x32_bf16 v[220:223], a[240:243], a[8:11], 0
v_mfma_f32_16x16x32_bf16 v[220:223], a[244:247], a[12:15], v[220:223]
v_mfma_f32_16x16x32_bf16 v[220:223], a[248:251], a[16:19], v[220:223]
v_mfma_f32_16x16x32_bf16 v[216:219], a[248:251], a[12:15], 0
v_mfma_f32_16x16x32_bf16 v[216:219], a[244:247], a[8:11], v[216:219]
ds_read_b128 a[52:55], v35 offset:40960
v_mfma_f32_16x16x32_bf16 v[216:219], a[240:243], a[4:7], v[216:219]
ds_read_b128 a[48:51], v35 offset:38912
v_mfma_f32_16x16x32_bf16 v[212:215], a[240:243], a[0:3], 0
v_mfma_f32_16x16x32_bf16 v[212:215], a[244:247], a[4:7], v[212:215]
v_mfma_f32_16x16x32_bf16 v[212:215], a[248:251], a[8:11], v[212:215]
v_mfma_f32_16x16x32_bf16 v[208:211], a[248:251], a[4:7], 0
v_mfma_f32_16x16x32_bf16 v[208:211], a[244:247], a[0:3], v[208:211]
ds_read_b128 a[44:47], v35 offset:36864
v_mfma_f32_16x16x32_bf16 v[240:243], v[100:103], a[0:3], 0
ds_read_b128 a[40:43], v35 offset:34816
s_waitcnt lgkmcnt(4)
v_mfma_f32_16x16x32_bf16 v[240:243], v[104:107], a[4:7], v[240:243]
v_mfma_f32_16x16x32_bf16 v[244:247], v[104:107], a[8:11], 0
v_mfma_f32_16x16x32_bf16 v[244:247], v[100:103], a[4:7], v[244:247]
v_mfma_f32_16x16x32_bf16 v[244:247], a[252:255], a[0:3], v[244:247]
v_mfma_f32_16x16x32_bf16 v[248:251], a[252:255], a[4:7], 0
ds_read_b128 a[36:39], v35 offset:32768
v_mfma_f32_16x16x32_bf16 v[248:251], v[100:103], a[8:11], v[248:251]
ds_read_b64_tr_b16 v[124:125], v20 offset:24576
v_mfma_f32_16x16x32_bf16 v[248:251], v[104:107], a[12:15], v[248:251]
ds_read_b64_tr_b16 v[126:127], v20 offset:25088
v_mfma_f32_16x16x32_bf16 v[252:255], v[104:107], a[16:19], 0
ds_read_b64_tr_b16 v[128:129], v21 offset:24576
v_mfma_f32_16x16x32_bf16 v[252:255], v[100:103], a[12:15], v[252:255]
ds_read_b64_tr_b16 v[130:131], v21 offset:25088
v_mfma_f32_16x16x32_bf16 v[252:255], a[252:255], a[8:11], v[252:255]
v_mfma_f32_16x16x32_bf16 v[200:203], v[116:119], a[68:71], v[200:203]
ds_read_b64_tr_b16 v[120:121], v19 offset:24576
v_mfma_f32_16x16x32_bf16 v[200:203], v[112:115], a[64:67], v[200:203]
ds_read_b64_tr_b16 v[122:123], v19 offset:25088
v_mfma_f32_16x16x32_bf16 v[200:203], v[108:111], a[60:63], v[200:203]
v_mfma_f32_16x16x32_bf16 v[192:195], v[108:111], a[56:59], v[192:195]
v_mfma_f32_16x16x32_bf16 v[192:195], v[112:115], a[60:63], v[192:195]
v_mfma_f32_16x16x32_bf16 v[192:195], v[116:119], a[64:67], v[192:195]
v_mfma_f32_16x16x32_bf16 v[184:187], v[116:119], a[60:63], v[184:187]
v_mfma_f32_16x16x32_bf16 v[184:187], v[112:115], a[56:59], v[184:187]
s_waitcnt lgkmcnt(2)
v_mfma_f32_16x16x32_bf16 v[184:187], v[108:111], a[52:55], v[184:187]
v_mfma_f32_16x16x32_bf16 v[176:179], v[108:111], a[48:51], v[176:179]
v_mfma_f32_16x16x32_bf16 v[176:179], v[112:115], a[52:55], v[176:179]
v_mfma_f32_16x16x32_bf16 v[176:179], v[116:119], a[56:59], v[176:179]
v_mfma_f32_16x16x32_bf16 v[168:171], v[116:119], a[52:55], v[168:171]
buffer_load_dwordx4 v11, s[28:31], s53 offen offset:1024  lds
v_mfma_f32_16x16x32_bf16 v[168:171], v[112:115], a[48:51], v[168:171]
v_mfma_f32_16x16x32_bf16 v[168:171], v[108:111], a[44:47], v[168:171]
v_mfma_f32_16x16x32_bf16 v[160:163], v[108:111], a[40:43], v[160:163]
ds_read_b64_tr_b16 v[132:133], v22 offset:36864
v_mfma_f32_16x16x32_bf16 v[160:163], v[112:115], a[44:47], v[160:163]
buffer_load_dwordx4 v12, s[28:31], s53 offen offset:2048  lds
v_mfma_f32_16x16x32_bf16 v[160:163], v[116:119], a[48:51], v[160:163]
ds_read_b64_tr_b16 v[134:135], v22 offset:37376
v_mfma_f32_16x16x32_bf16 v[152:155], v[116:119], a[44:47], v[152:155]
ds_read_b64_tr_b16 v[136:137], v23 offset:36864
v_mfma_f32_16x16x32_bf16 v[152:155], v[112:115], a[40:43], v[152:155]
s_add_u32 m0, s21, 98304
ds_read_b64_tr_b16 v[138:139], v23 offset:37376
v_mfma_f32_16x16x32_bf16 v[152:155], v[108:111], a[36:39], v[152:155]
buffer_load_dwordx4 v13, s[28:31], s53 offen offset:0  lds
v_mfma_f32_16x16x32_bf16 v[144:147], v[112:115], a[36:39], v[144:147]
ds_read_b64_tr_b16 v[140:141], v24 offset:36864
v_mfma_f32_16x16x32_bf16 v[144:147], v[116:119], a[40:43], v[144:147]
ds_read_b64_tr_b16 v[142:143], v24 offset:37376
v_mfma_f32_16x16x32_bf16 v[148:151], v[124:127], a[36:39], v[148:151]
v_mfma_f32_16x16x32_bf16 v[148:151], v[128:131], a[40:43], v[148:151]
buffer_load_dwordx4 v14, s[28:31], s53 offen offset:1024  lds
v_mfma_f32_16x16x32_bf16 v[156:159], v[128:131], a[44:47], v[156:159]
v_mfma_f32_16x16x32_bf16 v[156:159], v[124:127], a[40:43], v[156:159]
s_waitcnt lgkmcnt(4)
v_mfma_f32_16x16x32_bf16 v[156:159], v[120:123], a[36:39], v[156:159]
v_mfma_f32_16x16x32_bf16 v[164:167], v[120:123], a[40:43], v[164:167]
buffer_load_dwordx4 v15, s[28:31], s53 offen offset:2048  lds
v_mfma_f32_16x16x32_bf16 v[164:167], v[124:127], a[44:47], v[164:167]
v_mfma_f32_16x16x32_bf16 v[164:167], v[128:131], a[48:51], v[164:167]
v_mfma_f32_16x16x32_bf16 v[172:175], v[128:131], a[52:55], v[172:175]
v_mfma_f32_16x16x32_bf16 v[172:175], v[124:127], a[48:51], v[172:175]
global_load_dword v52, v68, s[12:13]
v_mfma_f32_16x16x32_bf16 v[172:175], v[120:123], a[44:47], v[172:175]
v_mfma_f32_16x16x32_bf16 v[180:183], v[120:123], a[48:51], v[180:183]
global_load_dword v53, v68, s[14:15]
v_mfma_f32_16x16x32_bf16 v[180:183], v[124:127], a[52:55], v[180:183]
v_mfma_f32_16x16x32_bf16 v[180:183], v[128:131], a[56:59], v[180:183]
global_load_dword v54, v68, s[16:17]
v_mfma_f32_16x16x32_bf16 v[188:191], v[128:131], a[60:63], v[188:191]
v_mfma_f32_16x16x32_bf16 v[188:191], v[124:127], a[56:59], v[188:191]
global_load_dword v55, v68, s[18:19]
v_mfma_f32_16x16x32_bf16 v[188:191], v[120:123], a[52:55], v[188:191]
v_mfma_f32_16x16x32_bf16 v[196:199], v[120:123], a[56:59], v[196:199]
v_mfma_f32_16x16x32_bf16 v[196:199], v[124:127], a[60:63], v[196:199]
ds_read_b64_tr_b16 a[220:221], v26 offset:36864
v_mfma_f32_16x16x32_bf16 v[196:199], v[128:131], a[64:67], v[196:199]
ds_read_b64_tr_b16 a[222:223], v26 offset:37376
v_mfma_f32_16x16x32_bf16 v[204:207], v[128:131], a[68:71], v[204:207]
ds_read_b64_tr_b16 a[224:225], v27 offset:36864
v_mfma_f32_16x16x32_bf16 v[204:207], v[124:127], a[64:67], v[204:207]
ds_read_b64_tr_b16 a[226:227], v27 offset:37376
v_mfma_f32_16x16x32_bf16 v[204:207], v[120:123], a[60:63], v[204:207]
ds_read_b64_tr_b16 a[216:217], v25 offset:36864
v_mfma_f32_16x16x32_bf16 v[236:239], v[132:135], a[60:63], v[236:239]
ds_read_b64_tr_b16 a[218:219], v25 offset:37376
s_waitcnt lgkmcnt(6)
v_mfma_f32_16x16x32_bf16 v[236:239], v[136:139], a[64:67], v[236:239]
v_mfma_f32_16x16x32_bf16 v[236:239], v[140:143], a[68:71], v[236:239]
v_mfma_f32_16x16x32_bf16 v[232:235], v[140:143], a[64:67], v[232:235]
v_mfma_f32_16x16x32_bf16 v[232:235], v[136:139], a[60:63], v[232:235]
v_mfma_f32_16x16x32_bf16 v[232:235], v[132:135], a[56:59], v[232:235]
s_waitcnt vmcnt(7) lgkmcnt(5)
s_barrier
ds_read_b64_tr_b16 a[236:237], v18 offset:49152
ds_read_b64_tr_b16 a[238:239], v18 offset:49664
v_mfma_f32_16x16x32_bf16 v[228:231], v[132:135], a[52:55], v[228:231]
s_addk_i32 s53, 28672
ds_read_b128 a[104:107], v40 offset:0
ds_read_b64_tr_b16 a[232:233], v17 offset:49152
v_mfma_f32_16x16x32_bf16 v[228:231], v[136:139], a[56:59], v[228:231]
s_addk_i32 m0, 12288
ds_read_b64_tr_b16 a[234:235], v17 offset:49664
ds_read_b128 a[100:103], v36 offset:14336
v_mfma_f32_16x16x32_bf16 v[228:231], v[140:143], a[60:63], v[228:231]
buffer_load_dwordx4 v10, s[28:31], s53 offen offset:0  lds
v_mfma_f32_16x16x32_bf16 v[224:227], v[140:143], a[56:59], v[224:227]
ds_read_b64_tr_b16 a[228:229], v16 offset:49152
ds_read_b64_tr_b16 a[230:231], v16 offset:49664
v_mfma_f32_16x16x32_bf16 v[224:227], v[136:139], a[52:55], v[224:227]
ds_read_b128 a[96:99], v36 offset:12288
v_mfma_f32_16x16x32_bf16 v[224:227], v[132:135], a[48:51], v[224:227]
ds_read_b128 a[92:95], v36 offset:10240
v_mfma_f32_16x16x32_bf16 v[220:223], v[132:135], a[44:47], v[220:223]
buffer_load_dwordx4 v11, s[28:31], s53 offen offset:1024  lds
v_mfma_f32_16x16x32_bf16 v[220:223], v[136:139], a[48:51], v[220:223]
v_mfma_f32_16x16x32_bf16 v[220:223], v[140:143], a[52:55], v[220:223]
v_mfma_f32_16x16x32_bf16 v[216:219], v[140:143], a[48:51], v[216:219]
ds_read_b128 a[88:91], v36 offset:8192
v_mfma_f32_16x16x32_bf16 v[216:219], v[136:139], a[44:47], v[216:219]
buffer_load_dwordx4 v12, s[28:31], s53 offen offset:2048  lds
v_mfma_f32_16x16x32_bf16 v[216:219], v[132:135], a[40:43], v[216:219]
ds_read_b128 a[84:87], v36 offset:6144
v_mfma_f32_16x16x32_bf16 v[212:215], v[132:135], a[36:39], v[212:215]
v_mfma_f32_16x16x32_bf16 v[212:215], v[136:139], a[40:43], v[212:215]
s_addk_i32 m0, 12288
v_mfma_f32_16x16x32_bf16 v[212:215], v[140:143], a[44:47], v[212:215]
buffer_load_dwordx4 v13, s[28:31], s53 offen offset:0  lds
v_mfma_f32_16x16x32_bf16 v[208:211], v[140:143], a[40:43], v[208:211]
v_mfma_f32_16x16x32_bf16 v[208:211], v[136:139], a[36:39], v[208:211]
ds_read_b128 a[80:83], v36 offset:4096
s_waitcnt lgkmcnt(3)
v_mfma_f32_16x16x32_bf16 v[240:243], a[220:223], a[36:39], v[240:243]
ds_read_b128 a[76:79], v36 offset:2048
v_mfma_f32_16x16x32_bf16 v[240:243], a[224:227], a[40:43], v[240:243]
buffer_load_dwordx4 v14, s[28:31], s53 offen offset:1024  lds
v_mfma_f32_16x16x32_bf16 v[244:247], a[224:227], a[44:47], v[244:247]
v_mfma_f32_16x16x32_bf16 v[244:247], a[220:223], a[40:43], v[244:247]
ds_read_b128 a[72:75], v36 offset:0
v_mfma_f32_16x16x32_bf16 v[244:247], a[216:219], a[36:39], v[244:247]
ds_read_b64_tr_b16 a[244:245], v20 offset:49152
v_mfma_f32_16x16x32_bf16 v[248:251], a[216:219], a[40:43], v[248:251]
buffer_load_dwordx4 v15, s[28:31], s53 offen offset:2048  lds
v_mfma_f32_16x16x32_bf16 v[248:251], a[220:223], a[44:47], v[248:251]
ds_read_b64_tr_b16 a[246:247], v20 offset:49664
v_mfma_f32_16x16x32_bf16 v[248:251], a[224:227], a[48:51], v[248:251]
ds_read_b64_tr_b16 a[248:249], v21 offset:49152
v_mfma_f32_16x16x32_bf16 v[252:255], a[224:227], a[52:55], v[252:255]
s_mov_b32 s55, 114688
ds_read_b64_tr_b16 a[250:251], v21 offset:49664
v_mfma_f32_16x16x32_bf16 v[252:255], a[220:223], a[48:51], v[252:255]
buffer_load_dword v2, v50, s[28:31], s55 offen
v_mfma_f32_16x16x32_bf16 v[252:255], a[216:219], a[44:47], v[252:255]
v_mfma_f32_16x16x32_bf16 v[200:203], a[236:239], a[104:107], v[200:203]
s_addk_i32 s48, 128
ds_read_b64_tr_b16 a[240:241], v19 offset:49152
v_mfma_f32_16x16x32_bf16 v[200:203], a[232:235], a[100:103], v[200:203]
s_mov_b32 m0, s20
ds_read_b64_tr_b16 a[242:243], v19 offset:49664
v_mfma_f32_16x16x32_bf16 v[200:203], a[228:231], a[96:99], v[200:203]
buffer_load_dwordx4 v6, s[24:27], s48 offen offset:0 nt lds
v_mfma_f32_16x16x32_bf16 v[192:195], a[228:231], a[92:95], v[192:195]
v_mfma_f32_16x16x32_bf16 v[192:195], a[232:235], a[96:99], v[192:195]
v_mfma_f32_16x16x32_bf16 v[192:195], a[236:239], a[100:103], v[192:195]
v_mfma_f32_16x16x32_bf16 v[184:187], a[236:239], a[96:99], v[184:187]
buffer_load_dwordx4 v8, s[24:27], s48 offen offset:2048 nt lds
v_mfma_f32_16x16x32_bf16 v[184:187], a[232:235], a[92:95], v[184:187]
s_waitcnt lgkmcnt(2)
v_mfma_f32_16x16x32_bf16 v[184:187], a[228:231], a[88:91], v[184:187]
v_mfma_f32_16x16x32_bf16 v[176:179], a[228:231], a[84:87], v[176:179]
v_mfma_f32_16x16x32_bf16 v[176:179], a[232:235], a[88:91], v[176:179]
buffer_load_dwordx4 v7, s[24:27], s48 offen offset:1024 nt lds
v_mfma_f32_16x16x32_bf16 v[176:179], a[236:239], a[92:95], v[176:179]
v_mfma_f32_16x16x32_bf16 v[168:171], a[236:239], a[88:91], v[168:171]
v_mfma_f32_16x16x32_bf16 v[168:171], a[232:235], a[84:87], v[168:171]
s_waitcnt vmcnt(14) lgkmcnt(0)
s_barrier
v_mfma_f32_16x16x32_bf16 v[168:171], a[228:231], a[80:83], v[168:171]
buffer_load_dwordx4 v9, s[24:27], s48 offen offset:3072 nt lds
v_mfma_f32_16x16x32_bf16 v[160:163], a[228:231], a[76:79], v[160:163]
ds_read_b64_tr_b16 a[252:253], v22 offset:0
v_mfma_f32_16x16x32_bf16 v[160:163], a[232:235], a[80:83], v[160:163]
s_addk_i32 s49, 128
ds_read_b64_tr_b16 a[254:255], v22 offset:512
v_mfma_f32_16x16x32_bf16 v[160:163], a[236:239], a[84:87], v[160:163]
s_mov_b32 m0, s100
ds_read_b64_tr_b16 v[100:101], v23 offset:0
v_mfma_f32_16x16x32_bf16 v[152:155], a[236:239], a[80:83], v[152:155]
buffer_load_dwordx4 v6, s[24:27], s49 offen offset:0 nt lds
v_mfma_f32_16x16x32_bf16 v[152:155], a[232:235], a[76:79], v[152:155]
ds_read_b64_tr_b16 v[102:103], v23 offset:512
v_mfma_f32_16x16x32_bf16 v[152:155], a[228:231], a[72:75], v[152:155]
ds_read_b64_tr_b16 v[104:105], v24 offset:0
v_mfma_f32_16x16x32_bf16 v[144:147], a[232:235], a[72:75], v[144:147]
ds_read_b64_tr_b16 v[106:107], v24 offset:512
v_mfma_f32_16x16x32_bf16 v[144:147], a[236:239], a[76:79], v[144:147]
buffer_load_dwordx4 v8, s[24:27], s49 offen offset:2048 nt lds
v_mfma_f32_16x16x32_bf16 v[148:151], a[244:247], a[72:75], v[148:151]
v_mfma_f32_16x16x32_bf16 v[148:151], a[248:251], a[76:79], v[148:151]
v_mfma_f32_16x16x32_bf16 v[156:159], a[248:251], a[80:83], v[156:159]
v_mfma_f32_16x16x32_bf16 v[156:159], a[244:247], a[76:79], v[156:159]
buffer_load_dwordx4 v7, s[24:27], s49 offen offset:1024 nt lds
v_mfma_f32_16x16x32_bf16 v[156:159], a[240:243], a[72:75], v[156:159]
v_mfma_f32_16x16x32_bf16 v[164:167], a[240:243], a[76:79], v[164:167]
v_mfma_f32_16x16x32_bf16 v[164:167], a[244:247], a[80:83], v[164:167]
v_mfma_f32_16x16x32_bf16 v[164:167], a[248:251], a[84:87], v[164:167]
buffer_load_dwordx4 v9, s[24:27], s49 offen offset:3072 nt lds
v_mfma_f32_16x16x32_bf16 v[172:175], a[248:251], a[88:91], v[172:175]
v_mfma_f32_16x16x32_bf16 v[172:175], a[244:247], a[84:87], v[172:175]
v_mfma_f32_16x16x32_bf16 v[172:175], a[240:243], a[80:83], v[172:175]
v_mfma_f32_16x16x32_bf16 v[180:183], a[240:243], a[84:87], v[180:183]
v_mfma_f32_16x16x32_bf16 v[180:183], a[244:247], a[88:91], v[180:183]
v_mfma_f32_16x16x32_bf16 v[180:183], a[248:251], a[92:95], v[180:183]
v_mfma_f32_16x16x32_bf16 v[188:191], a[248:251], a[96:99], v[188:191]
v_mfma_f32_16x16x32_bf16 v[188:191], a[244:247], a[92:95], v[188:191]
v_mfma_f32_16x16x32_bf16 v[188:191], a[240:243], a[88:91], v[188:191]
v_mfma_f32_16x16x32_bf16 v[196:199], a[240:243], a[92:95], v[196:199]
v_mfma_f32_16x16x32_bf16 v[196:199], a[244:247], a[96:99], v[196:199]
ds_read_b64_tr_b16 v[112:113], v26 offset:0
v_mfma_f32_16x16x32_bf16 v[196:199], a[248:251], a[100:103], v[196:199]
ds_read_b64_tr_b16 v[114:115], v26 offset:512
v_mfma_f32_16x16x32_bf16 v[204:207], a[248:251], a[104:107], v[204:207]
ds_read_b64_tr_b16 v[116:117], v27 offset:0
v_mfma_f32_16x16x32_bf16 v[204:207], a[244:247], a[100:103], v[204:207]
ds_read_b64_tr_b16 v[118:119], v27 offset:512
v_mfma_f32_16x16x32_bf16 v[204:207], a[240:243], a[96:99], v[204:207]
ds_read_b64_tr_b16 v[108:109], v25 offset:0
s_waitcnt lgkmcnt(5)
v_mfma_f32_16x16x32_bf16 v[236:239], a[252:255], a[96:99], v[236:239]
ds_read_b64_tr_b16 v[110:111], v25 offset:512
v_mfma_f32_16x16x32_bf16 v[236:239], v[100:103], a[100:103], v[236:239]
s_waitcnt vmcnt(9)
s_barrier
ds_read_b64_tr_b16 v[128:129], v18 offset:12288
v_mfma_f32_16x16x32_bf16 v[236:239], v[104:107], a[104:107], v[236:239]
s_addk_i32 s53, 28672
ds_read_b64_tr_b16 v[130:131], v18 offset:12800
v_mfma_f32_16x16x32_bf16 v[232:235], v[104:107], a[100:103], v[232:235]
s_add_u32 m0, s21, 135168
ds_read_b128 a[140:143], v41 offset:0
v_mfma_f32_16x16x32_bf16 v[232:235], v[100:103], a[96:99], v[232:235]
buffer_load_dwordx4 v10, s[28:31], s53 offen offset:0  lds
v_mfma_f32_16x16x32_bf16 v[232:235], a[252:255], a[92:95], v[232:235]
ds_read_b64_tr_b16 v[124:125], v17 offset:12288
v_mfma_f32_16x16x32_bf16 v[228:231], a[252:255], a[88:91], v[228:231]
ds_read_b64_tr_b16 v[126:127], v17 offset:12800
v_mfma_f32_16x16x32_bf16 v[228:231], v[100:103], a[92:95], v[228:231]
ds_read_b128 a[136:139], v37 offset:14336
v_mfma_f32_16x16x32_bf16 v[228:231], v[104:107], a[96:99], v[228:231]
ds_read_b64_tr_b16 v[120:121], v16 offset:12288
v_mfma_f32_16x16x32_bf16 v[224:227], v[104:107], a[92:95], v[224:227]
ds_read_b64_tr_b16 v[122:123], v16 offset:12800
v_mfma_f32_16x16x32_bf16 v[224:227], v[100:103], a[88:91], v[224:227]
ds_read_b128 a[132:135], v37 offset:12288
v_mfma_f32_16x16x32_bf16 v[224:227], a[252:255], a[84:87], v[224:227]
ds_read_b128 a[128:131], v37 offset:10240
v_mfma_f32_16x16x32_bf16 v[220:223], a[252:255], a[80:83], v[220:223]
v_mfma_f32_16x16x32_bf16 v[220:223], v[100:103], a[84:87], v[220:223]
v_mfma_f32_16x16x32_bf16 v[220:223], v[104:107], a[88:91], v[220:223]
v_mfma_f32_16x16x32_bf16 v[216:219], v[104:107], a[84:87], v[216:219]
v_mfma_f32_16x16x32_bf16 v[216:219], v[100:103], a[80:83], v[216:219]
ds_read_b128 a[124:127], v37 offset:8192
v_mfma_f32_16x16x32_bf16 v[216:219], a[252:255], a[76:79], v[216:219]
ds_read_b128 a[120:123], v37 offset:6144
v_mfma_f32_16x16x32_bf16 v[212:215], a[252:255], a[72:75], v[212:215]
v_mfma_f32_16x16x32_bf16 v[212:215], v[100:103], a[76:79], v[212:215]
v_mfma_f32_16x16x32_bf16 v[212:215], v[104:107], a[80:83], v[212:215]
v_mfma_f32_16x16x32_bf16 v[208:211], v[104:107], a[76:79], v[208:211]
v_mfma_f32_16x16x32_bf16 v[208:211], v[100:103], a[72:75], v[208:211]
ds_read_b128 a[116:119], v37 offset:4096
s_waitcnt lgkmcnt(3)
v_mfma_f32_16x16x32_bf16 v[240:243], v[112:115], a[72:75], v[240:243]
ds_read_b128 a[112:115], v37 offset:2048
v_mfma_f32_16x16x32_bf16 v[240:243], v[116:119], a[76:79], v[240:243]
v_mfma_f32_16x16x32_bf16 v[244:247], v[116:119], a[80:83], v[244:247]
v_mfma_f32_16x16x32_bf16 v[244:247], v[112:115], a[76:79], v[244:247]
ds_read_b128 a[108:111], v37 offset:0
v_mfma_f32_16x16x32_bf16 v[244:247], v[108:111], a[72:75], v[244:247]
ds_read_b64_tr_b16 v[136:137], v20 offset:12288
v_mfma_f32_16x16x32_bf16 v[248:251], v[108:111], a[76:79], v[248:251]
buffer_load_dwordx4 v11, s[28:31], s53 offen offset:1024  lds
v_mfma_f32_16x16x32_bf16 v[248:251], v[112:115], a[80:83], v[248:251]
ds_read_b64_tr_b16 v[138:139], v20 offset:12800
v_mfma_f32_16x16x32_bf16 v[248:251], v[116:119], a[84:87], v[248:251]
ds_read_b64_tr_b16 v[140:141], v21 offset:12288
v_mfma_f32_16x16x32_bf16 v[252:255], v[116:119], a[88:91], v[252:255]
ds_read_b64_tr_b16 v[142:143], v21 offset:12800
v_mfma_f32_16x16x32_bf16 v[252:255], v[112:115], a[84:87], v[252:255]
buffer_load_dwordx4 v12, s[28:31], s53 offen offset:2048  lds
v_mfma_f32_16x16x32_bf16 v[252:255], v[108:111], a[80:83], v[252:255]
v_mfma_f32_16x16x32_bf16 v[200:203], v[128:131], a[140:143], v[200:203]
ds_read_b64_tr_b16 v[132:133], v19 offset:12288
v_mfma_f32_16x16x32_bf16 v[200:203], v[124:127], a[136:139], v[200:203]
s_addk_i32 m0, 12288
ds_read_b64_tr_b16 v[134:135], v19 offset:12800
v_mfma_f32_16x16x32_bf16 v[200:203], v[120:123], a[132:135], v[200:203]
buffer_load_dwordx4 v13, s[28:31], s53 offen offset:0  lds
v_mfma_f32_16x16x32_bf16 v[192:195], v[120:123], a[128:131], v[192:195]
v_mfma_f32_16x16x32_bf16 v[192:195], v[124:127], a[132:135], v[192:195]
v_mfma_f32_16x16x32_bf16 v[192:195], v[128:131], a[136:139], v[192:195]
v_mfma_f32_16x16x32_bf16 v[184:187], v[128:131], a[132:135], v[184:187]
buffer_load_dwordx4 v14, s[28:31], s53 offen offset:1024  lds
v_mfma_f32_16x16x32_bf16 v[184:187], v[124:127], a[128:131], v[184:187]
s_waitcnt lgkmcnt(2)
v_mfma_f32_16x16x32_bf16 v[184:187], v[120:123], a[124:127], v[184:187]
v_mfma_f32_16x16x32_bf16 v[176:179], v[120:123], a[120:123], v[176:179]
v_mfma_f32_16x16x32_bf16 v[176:179], v[124:127], a[124:127], v[176:179]
buffer_load_dwordx4 v15, s[28:31], s53 offen offset:2048  lds
v_mfma_f32_16x16x32_bf16 v[176:179], v[128:131], a[128:131], v[176:179]
v_mfma_f32_16x16x32_bf16 v[168:171], v[128:131], a[124:127], v[168:171]
v_mfma_f32_16x16x32_bf16 v[168:171], v[124:127], a[120:123], v[168:171]
v_mfma_f32_16x16x32_bf16 v[168:171], v[120:123], a[116:119], v[168:171]
v_mfma_f32_16x16x32_bf16 v[160:163], v[120:123], a[112:115], v[160:163]
v_lshlrev_b32 v56, 16, v53
v_mfma_f32_16x16x32_bf16 v[160:163], v[124:127], a[116:119], v[160:163]
v_and_b32 v57, 0xffff0000, v53
v_mfma_f32_16x16x32_bf16 v[160:163], v[128:131], a[120:123], v[160:163]
ds_read_b64_tr_b16 a[216:217], v22 offset:24576
v_mfma_f32_16x16x32_bf16 v[152:155], v[128:131], a[116:119], v[152:155]
ds_read_b64_tr_b16 a[218:219], v22 offset:25088
v_mfma_f32_16x16x32_bf16 v[152:155], v[124:127], a[112:115], v[152:155]
ds_read_b64_tr_b16 a[220:221], v23 offset:24576
v_mfma_f32_16x16x32_bf16 v[152:155], v[120:123], a[108:111], v[152:155]
ds_read_b64_tr_b16 a[222:223], v23 offset:25088
v_mfma_f32_16x16x32_bf16 v[144:147], v[124:127], a[108:111], v[144:147]
ds_read_b64_tr_b16 a[224:225], v24 offset:24576
v_mfma_f32_16x16x32_bf16 v[144:147], v[128:131], a[112:115], v[144:147]
ds_read_b64_tr_b16 a[226:227], v24 offset:25088
v_mfma_f32_16x16x32_bf16 v[148:151], v[136:139], a[108:111], v[148:151]
v_add_f32 v56, 0x3727c5ac, v56
v_mfma_f32_16x16x32_bf16 v[148:151], v[140:143], a[112:115], v[148:151]
v_add_f32 v57, 0x3727c5ac, v57
v_mfma_f32_16x16x32_bf16 v[156:159], v[140:143], a[116:119], v[156:159]
v_cvt_pk_bf16_f32 v66, v56, v57
v_mfma_f32_16x16x32_bf16 v[156:159], v[136:139], a[112:115], v[156:159]
v_lshlrev_b32 v56, 16, v66
s_waitcnt lgkmcnt(5)
v_mfma_f32_16x16x32_bf16 v[156:159], v[132:135], a[108:111], v[156:159]
v_and_b32 v57, 0xffff0000, v66
v_mfma_f32_16x16x32_bf16 v[164:167], v[132:135], a[112:115], v[164:167]
v_sqrt_f32 v56, v56
v_mfma_f32_16x16x32_bf16 v[164:167], v[136:139], a[116:119], v[164:167]
v_sqrt_f32 v57, v57
v_mfma_f32_16x16x32_bf16 v[164:167], v[140:143], a[120:123], v[164:167]
v_lshlrev_b32 v58, 16, v54
v_mfma_f32_16x16x32_bf16 v[172:175], v[140:143], a[124:127], v[172:175]
v_and_b32 v59, 0xffff0000, v54
v_mfma_f32_16x16x32_bf16 v[172:175], v[136:139], a[120:123], v[172:175]
v_cvt_pk_bf16_f32 v66, v56, v57
v_mfma_f32_16x16x32_bf16 v[172:175], v[132:135], a[116:119], v[172:175]
v_lshlrev_b32 v56, 16, v66
v_mfma_f32_16x16x32_bf16 v[180:183], v[132:135], a[120:123], v[180:183]
v_and_b32 v57, 0xffff0000, v66
v_mfma_f32_16x16x32_bf16 v[180:183], v[136:139], a[124:127], v[180:183]
v_rcp_f32 v56, v56
v_mfma_f32_16x16x32_bf16 v[180:183], v[140:143], a[128:131], v[180:183]
v_rcp_f32 v57, v57
v_mfma_f32_16x16x32_bf16 v[188:191], v[140:143], a[132:135], v[188:191]
v_lshlrev_b32 v60, 16, v52
v_mfma_f32_16x16x32_bf16 v[188:191], v[136:139], a[128:131], v[188:191]
v_and_b32 v61, 0xffff0000, v52
v_mfma_f32_16x16x32_bf16 v[188:191], v[132:135], a[124:127], v[188:191]
v_cvt_pk_bf16_f32 v66, v56, v57
v_mfma_f32_16x16x32_bf16 v[196:199], v[132:135], a[128:131], v[196:199]
ds_read_b64_tr_b16 a[232:233], v26 offset:24576
v_mfma_f32_16x16x32_bf16 v[196:199], v[136:139], a[132:135], v[196:199]
ds_read_b64_tr_b16 a[234:235], v26 offset:25088
v_mfma_f32_16x16x32_bf16 v[196:199], v[140:143], a[136:139], v[196:199]
ds_read_b64_tr_b16 a[236:237], v27 offset:24576
v_mfma_f32_16x16x32_bf16 v[204:207], v[140:143], a[140:143], v[204:207]
ds_read_b64_tr_b16 a[238:239], v27 offset:25088
v_mfma_f32_16x16x32_bf16 v[204:207], v[136:139], a[136:139], v[204:207]
ds_read_b64_tr_b16 a[228:229], v25 offset:24576
v_mfma_f32_16x16x32_bf16 v[204:207], v[132:135], a[132:135], v[204:207]
L_pad0_1:
s_cbranch_execz L_body0
ds_read_b64_tr_b16 a[230:231], v25 offset:25088
s_waitcnt lgkmcnt(6)
v_mfma_f32_16x16x32_bf16 v[236:239], a[216:219], a[132:135], v[236:239]
v_lshlrev_b32 v56, 16, v66
v_mfma_f32_16x16x32_bf16 v[236:239], a[220:223], a[136:139], v[236:239]
s_waitcnt vmcnt(3)
s_barrier
ds_read_b64_tr_b16 a[248:249], v18 offset:36864
ds_read_b64_tr_b16 a[250:251], v18 offset:37376
v_mfma_f32_16x16x32_bf16 v[236:239], a[224:227], a[140:143], v[236:239]
s_addk_i32 s53, 28672
ds_read_b128 a[176:179], v38 offset:0
v_mfma_f32_16x16x32_bf16 v[232:235], a[224:227], a[136:139], v[232:235]
s_add_u32 m0, s21, 98304
ds_read_b64_tr_b16 a[244:245], v17 offset:36864
v_mfma_f32_16x16x32_bf16 v[232:235], a[220:223], a[132:135], v[232:235]
buffer_load_dwordx4 v10, s[28:31], s53 offen offset:0  lds
v_mfma_f32_16x16x32_bf16 v[232:235], a[216:219], a[128:131], v[232:235]
ds_read_b64_tr_b16 a[246:247], v17 offset:37376
v_mfma_f32_16x16x32_bf16 v[228:231], a[216:219], a[124:127], v[228:231]
ds_read_b128 a[172:175], v34 offset:14336
v_mfma_f32_16x16x32_bf16 v[228:231], a[220:223], a[128:131], v[228:231]
ds_read_b64_tr_b16 a[240:241], v16 offset:36864
v_mfma_f32_16x16x32_bf16 v[228:231], a[224:227], a[132:135], v[228:231]
buffer_load_dwordx4 v11, s[28:31], s53 offen offset:1024  lds
v_mfma_f32_16x16x32_bf16 v[224:227], a[224:227], a[128:131], v[224:227]
ds_read_b64_tr_b16 a[242:243], v16 offset:37376
v_mfma_f32_16x16x32_bf16 v[224:227], a[220:223], a[124:127], v[224:227]
ds_read_b128 a[168:171], v34 offset:12288
v_mfma_f32_16x16x32_bf16 v[224:227], a[216:219], a[120:123], v[224:227]
ds_read_b128 a[164:167], v34 offset:10240
v_mfma_f32_16x16x32_bf16 v[220:223], a[216:219], a[116:119], v[220:223]
buffer_load_dwordx4 v12, s[28:31], s53 offen offset:2048  lds
v_mfma_f32_16x16x32_bf16 v[220:223], a[220:223], a[120:123], v[220:223]
v_and_b32 v57, 0xffff0000, v66
v_mfma_f32_16x16x32_bf16 v[220:223], a[224:227], a[124:127], v[220:223]
v_mul_f32 v56, v56, v58
v_mfma_f32_16x16x32_bf16 v[216:219], a[224:227], a[120:123], v[216:219]
s_addk_i32 m0, 12288
ds_read_b128 a[160:163], v34 offset:8192
v_mfma_f32_16x16x32_bf16 v[216:219], a[220:223], a[116:119], v[216:219]
buffer_load_dwordx4 v13, s[28:31], s53 offen offset:0  lds
v_mfma_f32_16x16x32_bf16 v[216:219], a[216:219], a[112:115], v[216:219]
ds_read_b128 a[156:159], v34 offset:6144
v_mfma_f32_16x16x32_bf16 v[212:215], a[216:219], a[108:111], v[212:215]
v_mul_f32 v57, v57, v59
v_mfma_f32_16x16x32_bf16 v[212:215], a[220:223], a[112:115], v[212:215]
v_lshlrev_b32 v62, 16, v55
v_mfma_f32_16x16x32_bf16 v[212:215], a[224:227], a[116:119], v[212:215]
buffer_load_dwordx4 v14, s[28:31], s53 offen offset:1024  lds
v_mfma_f32_16x16x32_bf16 v[208:211], a[224:227], a[112:115], v[208:211]
v_and_b32 v63, 0xffff0000, v55
v_mfma_f32_16x16x32_bf16 v[208:211], a[220:223], a[108:111], v[208:211]
ds_read_b128 a[152:155], v34 offset:4096
s_waitcnt lgkmcnt(3)
v_mfma_f32_16x16x32_bf16 v[240:243], a[232:235], a[108:111], v[240:243]
ds_read_b128 a[148:151], v34 offset:2048
v_mfma_f32_16x16x32_bf16 v[240:243], a[236:239], a[112:115], v[240:243]
buffer_load_dwordx4 v15, s[28:31], s53 offen offset:2048  lds
v_mfma_f32_16x16x32_bf16 v[244:247], a[236:239], a[116:119], v[244:247]
v_cvt_pk_bf16_f32 v66, v56, v57
v_mfma_f32_16x16x32_bf16 v[244:247], a[232:235], a[112:115], v[244:247]
ds_read_b128 a[144:147], v34 offset:0
v_mfma_f32_16x16x32_bf16 v[244:247], a[228:231], a[108:111], v[244:247]
s_mov_b32 s55, 172032
ds_read_b64_tr_b16 v[100:101], v20 offset:36864
v_mfma_f32_16x16x32_bf16 v[248:251], a[228:231], a[112:115], v[248:251]
buffer_load_dword v3, v50, s[28:31], s55 offen
v_mfma_f32_16x16x32_bf16 v[248:251], a[232:235], a[116:119], v[248:251]
ds_read_b64_tr_b16 v[102:103], v20 offset:37376
v_mfma_f32_16x16x32_bf16 v[248:251], a[236:239], a[120:123], v[248:251]
s_addk_i32 s48, 128
ds_read_b64_tr_b16 v[104:105], v21 offset:36864
v_mfma_f32_16x16x32_bf16 v[252:255], a[236:239], a[124:127], v[252:255]
s_add_u32 m0, s20, 32768
ds_read_b64_tr_b16 v[106:107], v21 offset:37376
v_mfma_f32_16x16x32_bf16 v[252:255], a[232:235], a[120:123], v[252:255]
buffer_load_dwordx4 v6, s[24:27], s48 offen offset:0 nt lds
v_mfma_f32_16x16x32_bf16 v[252:255], a[228:231], a[116:119], v[252:255]
v_lshlrev_b32 v56, 16, v66
v_mfma_f32_16x16x32_bf16 v[200:203], a[248:251], a[176:179], v[200:203]
ds_read_b64_tr_b16 a[252:253], v19 offset:36864
v_mfma_f32_16x16x32_bf16 v[200:203], a[244:247], a[172:175], v[200:203]
ds_read_b64_tr_b16 a[254:255], v19 offset:37376
v_mfma_f32_16x16x32_bf16 v[200:203], a[240:243], a[168:171], v[200:203]
buffer_load_dwordx4 v8, s[24:27], s48 offen offset:2048 nt lds
v_mfma_f32_16x16x32_bf16 v[192:195], a[240:243], a[164:167], v[192:195]
v_and_b32 v57, 0xffff0000, v66
v_mfma_f32_16x16x32_bf16 v[192:195], a[244:247], a[168:171], v[192:195]
v_fma_f32 v62, -v60, v56, v62
v_mfma_f32_16x16x32_bf16 v[192:195], a[248:251], a[172:175], v[192:195]
v_fma_f32 v63, -v61, v57, v63
v_mfma_f32_16x16x32_bf16 v[184:187], a[248:251], a[168:171], v[184:187]
buffer_load_dwordx4 v7, s[24:27], s48 offen offset:1024 nt lds
v_mfma_f32_16x16x32_bf16 v[184:187], a[244:247], a[164:167], v[184:187]
v_mul_f32 v56, s50, v56
s_waitcnt lgkmcnt(2)
v_mfma_f32_16x16x32_bf16 v[184:187], a[240:243], a[160:163], v[184:187]
v_mul_f32 v57, s50, v57
v_mfma_f32_16x16x32_bf16 v[176:179], a[240:243], a[156:159], v[176:179]
v_mul_f32 v62, s50, v62
v_mfma_f32_16x16x32_bf16 v[176:179], a[244:247], a[160:163], v[176:179]
buffer_load_dwordx4 v9, s[24:27], s48 offen offset:3072 nt lds
v_mfma_f32_16x16x32_bf16 v[176:179], a[248:251], a[164:167], v[176:179]
v_mul_f32 v63, s50, v63
v_mfma_f32_16x16x32_bf16 v[168:171], a[248:251], a[160:163], v[168:171]
s_addk_i32 s49, 128
ds_write_b64 v49, v[56:57]
v_mfma_f32_16x16x32_bf16 v[168:171], a[244:247], a[156:159], v[168:171]
s_waitcnt vmcnt(11) lgkmcnt(1)
s_barrier
s_add_u32 m0, s100, 32768
v_mfma_f32_16x16x32_bf16 v[168:171], a[240:243], a[152:155], v[168:171]
buffer_load_dwordx4 v6, s[24:27], s49 offen offset:0 nt lds
v_mfma_f32_16x16x32_bf16 v[160:163], a[240:243], a[148:151], v[160:163]
ds_read_b64_tr_b16 v[108:109], v22 offset:49152
v_mfma_f32_16x16x32_bf16 v[160:163], a[244:247], a[152:155], v[160:163]
ds_read_b64_tr_b16 v[110:111], v22 offset:49664
v_mfma_f32_16x16x32_bf16 v[160:163], a[248:251], a[156:159], v[160:163]
ds_read_b64_tr_b16 v[112:113], v23 offset:49152
v_mfma_f32_16x16x32_bf16 v[152:155], a[248:251], a[152:155], v[152:155]
buffer_load_dwordx4 v8, s[24:27], s49 offen offset:2048 nt lds
v_mfma_f32_16x16x32_bf16 v[152:155], a[244:247], a[148:151], v[152:155]
ds_read_b64_tr_b16 v[114:115], v23 offset:49664
v_mfma_f32_16x16x32_bf16 v[152:155], a[240:243], a[144:147], v[152:155]
ds_read_b64_tr_b16 v[116:117], v24 offset:49152
v_mfma_f32_16x16x32_bf16 v[144:147], a[244:247], a[144:147], v[144:147]
ds_read_b64_tr_b16 v[118:119], v24 offset:49664
v_mfma_f32_16x16x32_bf16 v[144:147], a[248:251], a[148:151], v[144:147]
buffer_load_dwordx4 v7, s[24:27], s49 offen offset:1024 nt lds
v_mfma_f32_16x16x32_bf16 v[148:151], v[100:103], a[144:147], v[148:151]
ds_write_b64 v49, v[62:63] offset:512
v_mfma_f32_16x16x32_bf16 v[148:151], v[104:107], a[148:151], v[148:151]
v_mfma_f32_16x16x32_bf16 v[156:159], v[104:107], a[152:155], v[156:159]
v_mfma_f32_16x16x32_bf16 v[156:159], v[100:103], a[148:151], v[156:159]
buffer_load_dwordx4 v9, s[24:27], s49 offen offset:3072 nt lds
v_mfma_f32_16x16x32_bf16 v[156:159], a[252:255], a[144:147], v[156:159]
v_mfma_f32_16x16x32_bf16 v[164:167], a[252:255], a[148:151], v[164:167]
v_mfma_f32_16x16x32_bf16 v[164:167], v[100:103], a[152:155], v[164:167]
v_mfma_f32_16x16x32_bf16 v[164:167], v[104:107], a[156:159], v[164:167]
v_mfma_f32_16x16x32_bf16 v[172:175], v[104:107], a[160:163], v[172:175]
v_mfma_f32_16x16x32_bf16 v[172:175], v[100:103], a[156:159], v[172:175]
v_mfma_f32_16x16x32_bf16 v[172:175], a[252:255], a[152:155], v[172:175]
v_mfma_f32_16x16x32_bf16 v[180:183], a[252:255], a[156:159], v[180:183]
v_mfma_f32_16x16x32_bf16 v[180:183], v[100:103], a[160:163], v[180:183]
v_mfma_f32_16x16x32_bf16 v[180:183], v[104:107], a[164:167], v[180:183]
v_mfma_f32_16x16x32_bf16 v[188:191], v[104:107], a[168:171], v[188:191]
v_mfma_f32_16x16x32_bf16 v[188:191], v[100:103], a[164:167], v[188:191]
v_mfma_f32_16x16x32_bf16 v[188:191], a[252:255], a[160:163], v[188:191]
v_mfma_f32_16x16x32_bf16 v[196:199], a[252:255], a[164:167], v[196:199]
v_mfma_f32_16x16x32_bf16 v[196:199], v[100:103], a[168:171], v[196:199]
ds_read_b64_tr_b16 v[124:125], v26 offset:49152
v_mfma_f32_16x16x32_bf16 v[196:199], v[104:107], a[172:175], v[196:199]
ds_read_b64_tr_b16 v[126:127], v26 offset:49664
v_mfma_f32_16x16x32_bf16 v[204:207], v[104:107], a[176:179], v[204:207]
ds_read_b64_tr_b16 v[128:129], v27 offset:49152
v_mfma_f32_16x16x32_bf16 v[204:207], v[100:103], a[172:175], v[204:207]
ds_read_b64_tr_b16 v[130:131], v27 offset:49664
v_mfma_f32_16x16x32_bf16 v[204:207], a[252:255], a[168:171], v[204:207]
ds_read_b64_tr_b16 v[120:121], v25 offset:49152
s_waitcnt lgkmcnt(5)
v_mfma_f32_16x16x32_bf16 v[236:239], v[108:111], a[168:171], v[236:239]
ds_read_b64_tr_b16 v[122:123], v25 offset:49664
v_mfma_f32_16x16x32_bf16 v[236:239], v[112:115], a[172:175], v[236:239]
s_waitcnt vmcnt(9)
s_barrier
ds_read_b64_tr_b16 v[140:141], v18 offset:0
v_mfma_f32_16x16x32_bf16 v[236:239], v[116:119], a[176:179], v[236:239]
s_addk_i32 s53, 28672
ds_read_b64_tr_b16 v[142:143], v18 offset:512
v_mfma_f32_16x16x32_bf16 v[232:235], v[116:119], a[172:175], v[232:235]
s_add_u32 m0, s21, 122880
ds_read_b128 a[212:215], v39 offset:0
v_mfma_f32_16x16x32_bf16 v[232:235], v[112:115], a[168:171], v[232:235]
buffer_load_dwordx4 v10, s[28:31], s53 offen offset:0  lds
v_mfma_f32_16x16x32_bf16 v[232:235], v[108:111], a[164:167], v[232:235]
ds_read_b64_tr_b16 v[136:137], v17 offset:0
v_mfma_f32_16x16x32_bf16 v[228:231], v[108:111], a[160:163], v[228:231]
ds_read_b64_tr_b16 v[138:139], v17 offset:512
v_mfma_f32_16x16x32_bf16 v[228:231], v[112:115], a[164:167], v[228:231]
ds_read_b128 a[208:211], v35 offset:14336
v_mfma_f32_16x16x32_bf16 v[228:231], v[116:119], a[168:171], v[228:231]
ds_read_b64_tr_b16 v[132:133], v16 offset:0
v_mfma_f32_16x16x32_bf16 v[224:227], v[116:119], a[164:167], v[224:227]
ds_read_b64_tr_b16 v[134:135], v16 offset:512
v_mfma_f32_16x16x32_bf16 v[224:227], v[112:115], a[160:163], v[224:227]
ds_read_b128 a[204:207], v35 offset:12288
v_mfma_f32_16x16x32_bf16 v[224:227], v[108:111], a[156:159], v[224:227]
ds_read_b128 a[200:203], v35 offset:10240
v_mfma_f32_16x16x32_bf16 v[220:223], v[108:111], a[152:155], v[220:223]
v_mfma_f32_16x16x32_bf16 v[220:223], v[112:115], a[156:159], v[220:223]
v_mfma_f32_16x16x32_bf16 v[220:223], v[116:119], a[160:163], v[220:223]
v_mfma_f32_16x16x32_bf16 v[216:219], v[116:119], a[156:159], v[216:219]
v_mfma_f32_16x16x32_bf16 v[216:219], v[112:115], a[152:155], v[216:219]
ds_read_b128 a[196:199], v35 offset:8192
v_mfma_f32_16x16x32_bf16 v[216:219], v[108:111], a[148:151], v[216:219]
ds_read_b128 a[192:195], v35 offset:6144
v_mfma_f32_16x16x32_bf16 v[212:215], v[108:111], a[144:147], v[212:215]
v_mfma_f32_16x16x32_bf16 v[212:215], v[112:115], a[148:151], v[212:215]
v_mfma_f32_16x16x32_bf16 v[212:215], v[116:119], a[152:155], v[212:215]
v_mfma_f32_16x16x32_bf16 v[208:211], v[116:119], a[148:151], v[208:211]
v_mfma_f32_16x16x32_bf16 v[208:211], v[112:115], a[144:147], v[208:211]
ds_read_b128 a[188:191], v35 offset:4096
s_waitcnt lgkmcnt(3)
v_mfma_f32_16x16x32_bf16 v[240:243], v[124:127], a[144:147], v[240:243]
ds_read_b128 a[184:187], v35 offset:2048
v_mfma_f32_16x16x32_bf16 v[240:243], v[128:131], a[148:151], v[240:243]
buffer_load_dwordx4 v11, s[28:31], s53 offen offset:1024  lds
v_mfma_f32_16x16x32_bf16 v[244:247], v[128:131], a[152:155], v[244:247]
v_mfma_f32_16x16x32_bf16 v[244:247], v[124:127], a[148:151], v[244:247]
ds_read_b128 a[180:183], v35 offset:0
v_mfma_f32_16x16x32_bf16 v[244:247], v[120:123], a[144:147], v[244:247]
ds_read_b64_tr_b16 a[220:221], v20 offset:0
v_mfma_f32_16x16x32_bf16 v[248:251], v[120:123], a[148:151], v[248:251]
buffer_load_dwordx4 v12, s[28:31], s53 offen offset:2048  lds
v_mfma_f32_16x16x32_bf16 v[248:251], v[124:127], a[152:155], v[248:251]
ds_read_b64_tr_b16 a[222:223], v20 offset:512
v_mfma_f32_16x16x32_bf16 v[248:251], v[128:131], a[156:159], v[248:251]
ds_read_b64_tr_b16 a[224:225], v21 offset:0
v_mfma_f32_16x16x32_bf16 v[252:255], v[128:131], a[160:163], v[252:255]
s_addk_i32 m0, 12288
ds_read_b64_tr_b16 a[226:227], v21 offset:512
v_mfma_f32_16x16x32_bf16 v[252:255], v[124:127], a[156:159], v[252:255]
buffer_load_dwordx4 v13, s[28:31], s53 offen offset:0  lds
v_mfma_f32_16x16x32_bf16 v[252:255], v[120:123], a[152:155], v[252:255]
v_mfma_f32_16x16x32_bf16 v[200:203], v[140:143], a[212:215], v[200:203]
ds_read_b64_tr_b16 a[216:217], v19 offset:0
v_mfma_f32_16x16x32_bf16 v[200:203], v[136:139], a[208:211], v[200:203]
ds_read_b64_tr_b16 a[218:219], v19 offset:512
v_mfma_f32_16x16x32_bf16 v[200:203], v[132:135], a[204:207], v[200:203]
buffer_load_dwordx4 v14, s[28:31], s53 offen offset:1024  lds
v_mfma_f32_16x16x32_bf16 v[192:195], v[132:135], a[200:203], v[192:195]
v_mfma_f32_16x16x32_bf16 v[192:195], v[136:139], a[204:207], v[192:195]
v_mfma_f32_16x16x32_bf16 v[192:195], v[140:143], a[208:211], v[192:195]
v_mfma_f32_16x16x32_bf16 v[184:187], v[140:143], a[204:207], v[184:187]
buffer_load_dwordx4 v15, s[28:31], s53 offen offset:2048  lds
v_mfma_f32_16x16x32_bf16 v[184:187], v[136:139], a[200:203], v[184:187]
s_waitcnt lgkmcnt(2)
v_mfma_f32_16x16x32_bf16 v[184:187], v[132:135], a[196:199], v[184:187]
v_mfma_f32_16x16x32_bf16 v[176:179], v[132:135], a[192:195], v[176:179]
v_mfma_f32_16x16x32_bf16 v[176:179], v[136:139], a[196:199], v[176:179]
v_mfma_f32_16x16x32_bf16 v[176:179], v[140:143], a[200:203], v[176:179]
v_mfma_f32_16x16x32_bf16 v[168:171], v[140:143], a[196:199], v[168:171]
v_mfma_f32_16x16x32_bf16 v[168:171], v[136:139], a[192:195], v[168:171]
v_mfma_f32_16x16x32_bf16 v[168:171], v[132:135], a[188:191], v[168:171]
v_mfma_f32_16x16x32_bf16 v[160:163], v[132:135], a[184:187], v[160:163]
v_mfma_f32_16x16x32_bf16 v[160:163], v[136:139], a[188:191], v[160:163]
v_mfma_f32_16x16x32_bf16 v[160:163], v[140:143], a[192:195], v[160:163]
ds_read_b64_tr_b16 a[228:229], v22 offset:12288
v_mfma_f32_16x16x32_bf16 v[152:155], v[140:143], a[188:191], v[152:155]
ds_read_b64_tr_b16 a[230:231], v22 offset:12800
v_mfma_f32_16x16x32_bf16 v[152:155], v[136:139], a[184:187], v[152:155]
ds_read_b64_tr_b16 a[232:233], v23 offset:12288
v_mfma_f32_16x16x32_bf16 v[152:155], v[132:135], a[180:183], v[152:155]
ds_read_b64_tr_b16 a[234:235], v23 offset:12800
v_mfma_f32_16x16x32_bf16 v[144:147], v[136:139], a[180:183], v[144:147]
ds_read_b64_tr_b16 a[236:237], v24 offset:12288
v_mfma_f32_16x16x32_bf16 v[144:147], v[140:143], a[184:187], v[144:147]
ds_read_b64_tr_b16 a[238:239], v24 offset:12800
v_mfma_f32_16x16x32_bf16 v[148:151], a[220:223], a[180:183], v[148:151]
v_mfma_f32_16x16x32_bf16 v[148:151], a[224:227], a[184:187], v[148:151]
v_mfma_f32_16x16x32_bf16 v[156:159], a[224:227], a[188:191], v[156:159]
v_mfma_f32_16x16x32_bf16 v[156:159], a[220:223], a[184:187], v[156:159]
s_waitcnt lgkmcnt(5)
v_mfma_f32_16x16x32_bf16 v[156:159], a[216:219], a[180:183], v[156:159]
v_mfma_f32_16x16x32_bf16 v[164:167], a[216:219], a[184:187], v[164:167]
v_mfma_f32_16x16x32_bf16 v[164:167], a[220:223], a[188:191], v[164:167]
v_mfma_f32_16x16x32_bf16 v[164:167], a[224:227], a[192:195], v[164:167]
v_mfma_f32_16x16x32_bf16 v[172:175], a[224:227], a[196:199], v[172:175]
v_mfma_f32_16x16x32_bf16 v[172:175], a[220:223], a[192:195], v[172:175]
v_mfma_f32_16x16x32_bf16 v[172:175], a[216:219], a[188:191], v[172:175]
v_mfma_f32_16x16x32_bf16 v[180:183], a[216:219], a[192:195], v[180:183]
v_mfma_f32_16x16x32_bf16 v[180:183], a[220:223], a[196:199], v[180:183]
v_mfma_f32_16x16x32_bf16 v[180:183], a[224:227], a[200:203], v[180:183]
v_mfma_f32_16x16x32_bf16 v[188:191], a[224:227], a[204:207], v[188:191]
v_mfma_f32_16x16x32_bf16 v[188:191], a[220:223], a[200:203], v[188:191]
v_mfma_f32_16x16x32_bf16 v[188:191], a[216:219], a[196:199], v[188:191]
v_mfma_f32_16x16x32_bf16 v[196:199], a[216:219], a[200:203], v[196:199]
ds_read_b64_tr_b16 a[244:245], v26 offset:12288
v_mfma_f32_16x16x32_bf16 v[196:199], a[220:223], a[204:207], v[196:199]
ds_read_b64_tr_b16 a[246:247], v26 offset:12800
v_mfma_f32_16x16x32_bf16 v[196:199], a[224:227], a[208:211], v[196:199]
ds_read_b64_tr_b16 a[248:249], v27 offset:12288
v_mfma_f32_16x16x32_bf16 v[204:207], a[224:227], a[212:215], v[204:207]
ds_read_b64_tr_b16 a[250:251], v27 offset:12800
v_mfma_f32_16x16x32_bf16 v[204:207], a[220:223], a[208:211], v[204:207]
ds_read_b64_tr_b16 a[240:241], v25 offset:12288
v_mfma_f32_16x16x32_bf16 v[204:207], a[216:219], a[204:207], v[204:207]
ds_read_b64_tr_b16 a[242:243], v25 offset:12800
s_waitcnt lgkmcnt(6)
v_mfma_f32_16x16x32_bf16 v[236:239], a[228:231], a[204:207], v[236:239]
v_mfma_f32_16x16x32_bf16 v[236:239], a[232:235], a[208:211], v[236:239]
s_waitcnt vmcnt(0)
s_barrier
ds_read_b64_tr_b16 v[104:105], v18 offset:24576
ds_read_b64_tr_b16 v[106:107], v18 offset:25088
v_mfma_f32_16x16x32_bf16 v[236:239], a[236:239], a[212:215], v[236:239]
s_addk_i32 s53, 28672
ds_read_b128 a[32:35], v38 offset:32768
v_mfma_f32_16x16x32_bf16 v[232:235], a[236:239], a[208:211], v[232:235]
s_addk_i32 m0, 12288
ds_read_b64_tr_b16 v[100:101], v17 offset:24576
v_mfma_f32_16x16x32_bf16 v[232:235], a[232:235], a[204:207], v[232:235]
buffer_load_dwordx4 v10, s[28:31], s53 offen offset:0  lds
v_mfma_f32_16x16x32_bf16 v[232:235], a[228:231], a[200:203], v[232:235]
ds_read_b64_tr_b16 v[102:103], v17 offset:25088
v_mfma_f32_16x16x32_bf16 v[228:231], a[228:231], a[196:199], v[228:231]
ds_read_b128 a[28:31], v34 offset:47104
v_mfma_f32_16x16x32_bf16 v[228:231], a[232:235], a[200:203], v[228:231]
ds_read_b64_tr_b16 a[252:253], v16 offset:24576
v_mfma_f32_16x16x32_bf16 v[228:231], a[236:239], a[204:207], v[228:231]
buffer_load_dwordx4 v11, s[28:31], s53 offen offset:1024  lds
v_mfma_f32_16x16x32_bf16 v[224:227], a[236:239], a[200:203], v[224:227]
ds_read_b64_tr_b16 a[254:255], v16 offset:25088
v_mfma_f32_16x16x32_bf16 v[224:227], a[232:235], a[196:199], v[224:227]
ds_read_b128 a[24:27], v34 offset:45056
v_mfma_f32_16x16x32_bf16 v[224:227], a[228:231], a[192:195], v[224:227]
ds_read_b128 a[20:23], v34 offset:43008
v_mfma_f32_16x16x32_bf16 v[220:223], a[228:231], a[188:191], v[220:223]
buffer_load_dwordx4 v12, s[28:31], s53 offen offset:2048  lds
v_mfma_f32_16x16x32_bf16 v[220:223], a[232:235], a[192:195], v[220:223]
v_mfma_f32_16x16x32_bf16 v[220:223], a[236:239], a[196:199], v[220:223]
v_mfma_f32_16x16x32_bf16 v[216:219], a[236:239], a[192:195], v[216:219]
s_add_u32 m0, s21, 98304
ds_read_b128 a[16:19], v34 offset:40960
v_mfma_f32_16x16x32_bf16 v[216:219], a[232:235], a[188:191], v[216:219]
buffer_load_dwordx4 v13, s[28:31], s53 offen offset:0  lds
v_mfma_f32_16x16x32_bf16 v[216:219], a[228:231], a[184:187], v[216:219]
ds_read_b128 a[12:15], v34 offset:38912
v_mfma_f32_16x16x32_bf16 v[212:215], a[228:231], a[180:183], v[212:215]
v_mfma_f32_16x16x32_bf16 v[212:215], a[232:235], a[184:187], v[212:215]
v_mfma_f32_16x16x32_bf16 v[212:215], a[236:239], a[188:191], v[212:215]
buffer_load_dwordx4 v14, s[28:31], s53 offen offset:1024  lds
v_mfma_f32_16x16x32_bf16 v[208:211], a[236:239], a[184:187], v[208:211]
v_mfma_f32_16x16x32_bf16 v[208:211], a[232:235], a[180:183], v[208:211]
ds_read_b128 a[8:11], v34 offset:36864
s_waitcnt lgkmcnt(3)
v_mfma_f32_16x16x32_bf16 v[240:243], a[244:247], a[180:183], v[240:243]
ds_read_b128 a[4:7], v34 offset:34816
v_mfma_f32_16x16x32_bf16 v[240:243], a[248:251], a[184:187], v[240:243]
buffer_load_dwordx4 v15, s[28:31], s53 offen offset:2048  lds
v_mfma_f32_16x16x32_bf16 v[244:247], a[248:251], a[188:191], v[244:247]
v_mfma_f32_16x16x32_bf16 v[244:247], a[244:247], a[184:187], v[244:247]
ds_read_b128 a[0:3], v34 offset:32768
v_mfma_f32_16x16x32_bf16 v[244:247], a[240:243], a[180:183], v[244:247]
s_mov_b32 s55, 229376
ds_read_b64_tr_b16 v[112:113], v20 offset:24576
v_mfma_f32_16x16x32_bf16 v[248:251], a[240:243], a[184:187], v[248:251]
buffer_load_dword v2, v50, s[28:31], s55 offen
v_mfma_f32_16x16x32_bf16 v[248:251], a[244:247], a[188:191], v[248:251]
ds_read_b64_tr_b16 v[114:115], v20 offset:25088
v_mfma_f32_16x16x32_bf16 v[248:251], a[248:251], a[192:195], v[248:251]
s_addk_i32 s48, 128
ds_read_b64_tr_b16 v[116:117], v21 offset:24576
v_mfma_f32_16x16x32_bf16 v[252:255], a[248:251], a[196:199], v[252:255]
s_add_u32 m0, s20, 65536
ds_read_b64_tr_b16 v[118:119], v21 offset:25088
v_mfma_f32_16x16x32_bf16 v[252:255], a[244:247], a[192:195], v[252:255]
buffer_load_dwordx4 v6, s[24:27], s48 offen offset:0 nt lds
v_mfma_f32_16x16x32_bf16 v[252:255], a[240:243], a[188:191], v[252:255]
v_mfma_f32_16x16x32_bf16 v[200:203], v[104:107], a[32:35], v[200:203]
ds_read_b64_tr_b16 v[108:109], v19 offset:24576
v_mfma_f32_16x16x32_bf16 v[200:203], v[100:103], a[28:31], v[200:203]
ds_read_b64_tr_b16 v[110:111], v19 offset:25088
v_mfma_f32_16x16x32_bf16 v[200:203], a[252:255], a[24:27], v[200:203]
buffer_load_dwordx4 v8, s[24:27], s48 offen offset:2048 nt lds
v_mfma_f32_16x16x32_bf16 v[192:195], a[252:255], a[20:23], v[192:195]
v_mfma_f32_16x16x32_bf16 v[192:195], v[100:103], a[24:27], v[192:195]
v_mfma_f32_16x16x32_bf16 v[192:195], v[104:107], a[28:31], v[192:195]
v_mfma_f32_16x16x32_bf16 v[184:187], v[104:107], a[24:27], v[184:187]
buffer_load_dwordx4 v7, s[24:27], s48 offen offset:1024 nt lds
v_mfma_f32_16x16x32_bf16 v[184:187], v[100:103], a[20:23], v[184:187]
s_waitcnt lgkmcnt(2)
v_mfma_f32_16x16x32_bf16 v[184:187], a[252:255], a[16:19], v[184:187]
v_mfma_f32_16x16x32_bf16 v[176:179], a[252:255], a[12:15], v[176:179]
v_mfma_f32_16x16x32_bf16 v[176:179], v[100:103], a[16:19], v[176:179]
buffer_load_dwordx4 v9, s[24:27], s48 offen offset:3072 nt lds
v_mfma_f32_16x16x32_bf16 v[176:179], v[104:107], a[20:23], v[176:179]
v_mfma_f32_16x16x32_bf16 v[168:171], v[104:107], a[16:19], v[168:171]
s_addk_i32 s49, 128
v_mfma_f32_16x16x32_bf16 v[168:171], v[100:103], a[12:15], v[168:171]
s_add_u32 m0, s100, 65536
v_mfma_f32_16x16x32_bf16 v[168:171], a[252:255], a[8:11], v[168:171]
buffer_load_dwordx4 v6, s[24:27], s49 offen offset:0 nt lds
v_mfma_f32_16x16x32_bf16 v[160:163], a[252:255], a[4:7], v[160:163]
ds_read_b64_tr_b16 v[120:121], v22 offset:36864
v_mfma_f32_16x16x32_bf16 v[160:163], v[100:103], a[8:11], v[160:163]
ds_read_b64_tr_b16 v[122:123], v22 offset:37376
v_mfma_f32_16x16x32_bf16 v[160:163], v[104:107], a[12:15], v[160:163]
ds_read_b64_tr_b16 v[124:125], v23 offset:36864
v_mfma_f32_16x16x32_bf16 v[152:155], v[104:107], a[8:11], v[152:155]
buffer_load_dwordx4 v8, s[24:27], s49 offen offset:2048 nt lds
v_mfma_f32_16x16x32_bf16 v[152:155], v[100:103], a[4:7], v[152:155]
ds_read_b64_tr_b16 v[126:127], v23 offset:37376
v_mfma_f32_16x16x32_bf16 v[152:155], a[252:255], a[0:3], v[152:155]
ds_read_b64_tr_b16 v[128:129], v24 offset:36864
v_mfma_f32_16x16x32_bf16 v[144:147], v[100:103], a[0:3], v[144:147]
ds_read_b64_tr_b16 v[130:131], v24 offset:37376
v_mfma_f32_16x16x32_bf16 v[144:147], v[104:107], a[4:7], v[144:147]
buffer_load_dwordx4 v7, s[24:27], s49 offen offset:1024 nt lds
v_mfma_f32_16x16x32_bf16 v[148:151], v[112:115], a[0:3], v[148:151]
v_mfma_f32_16x16x32_bf16 v[148:151], v[116:119], a[4:7], v[148:151]
v_mfma_f32_16x16x32_bf16 v[156:159], v[116:119], a[8:11], v[156:159]
v_mfma_f32_16x16x32_bf16 v[156:159], v[112:115], a[4:7], v[156:159]
buffer_load_dwordx4 v9, s[24:27], s49 offen offset:3072 nt lds
s_waitcnt lgkmcnt(3)
v_mfma_f32_16x16x32_bf16 v[156:159], v[108:111], a[0:3], v[156:159]
v_mfma_f32_16x16x32_bf16 v[164:167], v[108:111], a[4:7], v[164:167]
v_mfma_f32_16x16x32_bf16 v[164:167], v[112:115], a[8:11], v[164:167]
v_mfma_f32_16x16x32_bf16 v[164:167], v[116:119], a[12:15], v[164:167]
v_mfma_f32_16x16x32_bf16 v[172:175], v[116:119], a[16:19], v[172:175]
v_mfma_f32_16x16x32_bf16 v[172:175], v[112:115], a[12:15], v[172:175]
v_mfma_f32_16x16x32_bf16 v[172:175], v[108:111], a[8:11], v[172:175]
v_mfma_f32_16x16x32_bf16 v[180:183], v[108:111], a[12:15], v[180:183]
v_mfma_f32_16x16x32_bf16 v[180:183], v[112:115], a[16:19], v[180:183]
v_mfma_f32_16x16x32_bf16 v[180:183], v[116:119], a[20:23], v[180:183]
v_mfma_f32_16x16x32_bf16 v[188:191], v[116:119], a[24:27], v[188:191]
v_mfma_f32_16x16x32_bf16 v[188:191], v[112:115], a[20:23], v[188:191]
v_mfma_f32_16x16x32_bf16 v[188:191], v[108:111], a[16:19], v[188:191]
v_mfma_f32_16x16x32_bf16 v[196:199], v[108:111], a[20:23], v[196:199]
v_mfma_f32_16x16x32_bf16 v[196:199], v[112:115], a[24:27], v[196:199]
ds_read_b64_tr_b16 v[136:137], v26 offset:36864
v_mfma_f32_16x16x32_bf16 v[196:199], v[116:119], a[28:31], v[196:199]
ds_read_b64_tr_b16 v[138:139], v26 offset:37376
v_mfma_f32_16x16x32_bf16 v[204:207], v[116:119], a[32:35], v[204:207]
ds_read_b64_tr_b16 v[140:141], v27 offset:36864
v_mfma_f32_16x16x32_bf16 v[204:207], v[112:115], a[28:31], v[204:207]
ds_read_b64_tr_b16 v[142:143], v27 offset:37376
v_mfma_f32_16x16x32_bf16 v[204:207], v[108:111], a[24:27], v[204:207]
ds_read_b64_tr_b16 v[132:133], v25 offset:36864
v_mfma_f32_16x16x32_bf16 v[236:239], v[120:123], a[24:27], v[236:239]
ds_read_b64_tr_b16 v[134:135], v25 offset:37376
s_waitcnt lgkmcnt(6)
v_mfma_f32_16x16x32_bf16 v[236:239], v[124:127], a[28:31], v[236:239]
s_waitcnt vmcnt(9)
s_barrier
ds_read_b64_tr_b16 a[224:225], v18 offset:49152
v_mfma_f32_16x16x32_bf16 v[236:239], v[128:131], a[32:35], v[236:239]
s_addk_i32 s53, 28672
ds_read_b64_tr_b16 a[226:227], v18 offset:49664
v_mfma_f32_16x16x32_bf16 v[232:235], v[128:131], a[28:31], v[232:235]
s_add_u32 m0, s21, 110592
ds_read_b128 a[68:71], v39 offset:32768
v_mfma_f32_16x16x32_bf16 v[232:235], v[124:127], a[24:27], v[232:235]
buffer_load_dwordx4 v10, s[28:31], s53 offen offset:0  lds
v_mfma_f32_16x16x32_bf16 v[232:235], v[120:123], a[20:23], v[232:235]
ds_read_b64_tr_b16 a[220:221], v17 offset:49152
v_mfma_f32_16x16x32_bf16 v[228:231], v[120:123], a[16:19], v[228:231]
ds_read_b64_tr_b16 a[222:223], v17 offset:49664
v_mfma_f32_16x16x32_bf16 v[228:231], v[124:127], a[20:23], v[228:231]
ds_read_b128 a[64:67], v35 offset:47104
v_mfma_f32_16x16x32_bf16 v[228:231], v[128:131], a[24:27], v[228:231]
ds_read_b64_tr_b16 a[216:217], v16 offset:49152
v_mfma_f32_16x16x32_bf16 v[224:227], v[128:131], a[20:23], v[224:227]
ds_read_b64_tr_b16 a[218:219], v16 offset:49664
v_mfma_f32_16x16x32_bf16 v[224:227], v[124:127], a[16:19], v[224:227]
ds_read_b128 a[60:63], v35 offset:45056
v_mfma_f32_16x16x32_bf16 v[224:227], v[120:123], a[12:15], v[224:227]
ds_read_b128 a[56:59], v35 offset:43008
v_mfma_f32_16x16x32_bf16 v[220:223], v[120:123], a[8:11], v[220:223]
v_mfma_f32_16x16x32_bf16 v[220:223], v[124:127], a[12:15], v[220:223]
v_mfma_f32_16x16x32_bf16 v[220:223], v[128:131], a[16:19], v[220:223]
v_mfma_f32_16x16x32_bf16 v[216:219], v[128:131], a[12:15], v[216:219]
v_mfma_f32_16x16x32_bf16 v[216:219], v[124:127], a[8:11], v[216:219]
ds_read_b128 a[52:55], v35 offset:40960
v_mfma_f32_16x16x32_bf16 v[216:219], v[120:123], a[4:7], v[216:219]
ds_read_b128 a[48:51], v35 offset:38912
v_mfma_f32_16x16x32_bf16 v[212:215], v[120:123], a[0:3], v[212:215]
v_mfma_f32_16x16x32_bf16 v[212:215], v[124:127], a[4:7], v[212:215]
v_mfma_f32_16x16x32_bf16 v[212:215], v[128:131], a[8:11], v[212:215]
v_mfma_f32_16x16x32_bf16 v[208:211], v[128:131], a[4:7], v[208:211]
v_mfma_f32_16x16x32_bf16 v[208:211], v[124:127], a[0:3], v[208:211]
ds_read_b128 a[44:47], v35 offset:36864
s_waitcnt lgkmcnt(3)
v_mfma_f32_16x16x32_bf16 v[240:243], v[136:139], a[0:3], v[240:243]
ds_read_b128 a[40:43], v35 offset:34816
v_mfma_f32_16x16x32_bf16 v[240:243], v[140:143], a[4:7], v[240:243]
buffer_load_dwordx4 v11, s[28:31], s53 offen offset:1024  lds
v_mfma_f32_16x16x32_bf16 v[244:247], v[140:143], a[8:11], v[244:247]
v_mfma_f32_16x16x32_bf16 v[244:247], v[136:139], a[4:7], v[244:247]
ds_read_b128 a[36:39], v35 offset:32768
v_mfma_f32_16x16x32_bf16 v[244:247], v[132:135], a[0:3], v[244:247]
ds_read_b64_tr_b16 a[232:233], v20 offset:49152
v_mfma_f32_16x16x32_bf16 v[248:251], v[132:135], a[4:7], v[248:251]
buffer_load_dwordx4 v12, s[28:31], s53 offen offset:2048  lds
v_mfma_f32_16x16x32_bf16 v[248:251], v[136:139], a[8:11], v[248:251]
ds_read_b64_tr_b16 a[234:235], v20 offset:49664
v_mfma_f32_16x16x32_bf16 v[248:251], v[140:143], a[12:15], v[248:251]
s_addk_i32 s53, 28672
ds_read_b64_tr_b16 a[236:237], v21 offset:49152
v_mfma_f32_16x16x32_bf16 v[252:255], v[140:143], a[16:19], v[252:255]
s_addk_i32 m0, 12288
ds_read_b64_tr_b16 a[238:239], v21 offset:49664
v_mfma_f32_16x16x32_bf16 v[252:255], v[136:139], a[12:15], v[252:255]
buffer_load_dwordx4 v10, s[28:31], s53 offen offset:0  lds
v_mfma_f32_16x16x32_bf16 v[252:255], v[132:135], a[8:11], v[252:255]
v_mfma_f32_16x16x32_bf16 v[200:203], a[224:227], a[68:71], v[200:203]
ds_read_b64_tr_b16 a[228:229], v19 offset:49152
v_mfma_f32_16x16x32_bf16 v[200:203], a[220:223], a[64:67], v[200:203]
ds_read_b64_tr_b16 a[230:231], v19 offset:49664
v_mfma_f32_16x16x32_bf16 v[200:203], a[216:219], a[60:63], v[200:203]
buffer_load_dwordx4 v11, s[28:31], s53 offen offset:1024  lds
v_mfma_f32_16x16x32_bf16 v[192:195], a[216:219], a[56:59], v[192:195]
v_mfma_f32_16x16x32_bf16 v[192:195], a[220:223], a[60:63], v[192:195]
v_mfma_f32_16x16x32_bf16 v[192:195], a[224:227], a[64:67], v[192:195]
v_mfma_f32_16x16x32_bf16 v[184:187], a[224:227], a[60:63], v[184:187]
buffer_load_dwordx4 v12, s[28:31], s53 offen offset:2048  lds
v_mfma_f32_16x16x32_bf16 v[184:187], a[220:223], a[56:59], v[184:187]
s_waitcnt lgkmcnt(2)
v_mfma_f32_16x16x32_bf16 v[184:187], a[216:219], a[52:55], v[184:187]
v_mfma_f32_16x16x32_bf16 v[176:179], a[216:219], a[48:51], v[176:179]
s_mov_b32 s55, 286720
v_mfma_f32_16x16x32_bf16 v[176:179], a[220:223], a[52:55], v[176:179]
buffer_load_dword v3, v50, s[28:31], s55 offen
v_mfma_f32_16x16x32_bf16 v[176:179], a[224:227], a[56:59], v[176:179]
v_mfma_f32_16x16x32_bf16 v[168:171], a[224:227], a[52:55], v[168:171]
s_addk_i32 s48, 128
v_mfma_f32_16x16x32_bf16 v[168:171], a[220:223], a[48:51], v[168:171]
s_mov_b32 m0, s20
v_mfma_f32_16x16x32_bf16 v[168:171], a[216:219], a[44:47], v[168:171]
buffer_load_dwordx4 v6, s[24:27], s48 offen offset:0 nt lds
v_mfma_f32_16x16x32_bf16 v[160:163], a[216:219], a[40:43], v[160:163]
ds_read_b64_tr_b16 a[240:241], v22 offset:0
v_mfma_f32_16x16x32_bf16 v[160:163], a[220:223], a[44:47], v[160:163]
ds_read_b64_tr_b16 a[242:243], v22 offset:512
v_mfma_f32_16x16x32_bf16 v[160:163], a[224:227], a[48:51], v[160:163]
ds_read_b64_tr_b16 a[244:245], v23 offset:0
v_mfma_f32_16x16x32_bf16 v[152:155], a[224:227], a[44:47], v[152:155]
buffer_load_dwordx4 v8, s[24:27], s48 offen offset:2048 nt lds
v_mfma_f32_16x16x32_bf16 v[152:155], a[220:223], a[40:43], v[152:155]
ds_read_b64_tr_b16 a[246:247], v23 offset:512
v_mfma_f32_16x16x32_bf16 v[152:155], a[216:219], a[36:39], v[152:155]
ds_read_b64_tr_b16 a[248:249], v24 offset:0
v_mfma_f32_16x16x32_bf16 v[144:147], a[220:223], a[36:39], v[144:147]
ds_read_b64_tr_b16 a[250:251], v24 offset:512
v_mfma_f32_16x16x32_bf16 v[144:147], a[224:227], a[40:43], v[144:147]
buffer_load_dwordx4 v7, s[24:27], s48 offen offset:1024 nt lds
v_mfma_f32_16x16x32_bf16 v[148:151], a[232:235], a[36:39], v[148:151]
L_pad0_2:
s_cbranch_execz L_body0
v_mfma_f32_16x16x32_bf16 v[148:151], a[236:239], a[40:43], v[148:151]
v_mfma_f32_16x16x32_bf16 v[156:159], a[236:239], a[44:47], v[156:159]
v_mfma_f32_16x16x32_bf16 v[156:159], a[232:235], a[40:43], v[156:159]
buffer_load_dwordx4 v9, s[24:27], s48 offen offset:3072 nt lds
s_waitcnt lgkmcnt(3)
v_mfma_f32_16x16x32_bf16 v[156:159], a[228:231], a[36:39], v[156:159]
v_mfma_f32_16x16x32_bf16 v[164:167], a[228:231], a[40:43], v[164:167]
s_addk_i32 s49, 128
v_mfma_f32_16x16x32_bf16 v[164:167], a[232:235], a[44:47], v[164:167]
s_mov_b32 m0, s100
v_mfma_f32_16x16x32_bf16 v[164:167], a[236:239], a[48:51], v[164:167]
buffer_load_dwordx4 v6, s[24:27], s49 offen offset:0 nt lds
v_mfma_f32_16x16x32_bf16 v[172:175], a[236:239], a[52:55], v[172:175]
v_mfma_f32_16x16x32_bf16 v[172:175], a[232:235], a[48:51], v[172:175]
v_mfma_f32_16x16x32_bf16 v[172:175], a[228:231], a[44:47], v[172:175]
v_mfma_f32_16x16x32_bf16 v[180:183], a[228:231], a[48:51], v[180:183]
buffer_load_dwordx4 v8, s[24:27], s49 offen offset:2048 nt lds
v_mfma_f32_16x16x32_bf16 v[180:183], a[232:235], a[52:55], v[180:183]
v_mfma_f32_16x16x32_bf16 v[180:183], a[236:239], a[56:59], v[180:183]
v_mfma_f32_16x16x32_bf16 v[188:191], a[236:239], a[60:63], v[188:191]
v_mfma_f32_16x16x32_bf16 v[188:191], a[232:235], a[56:59], v[188:191]
buffer_load_dwordx4 v7, s[24:27], s49 offen offset:1024 nt lds
v_mfma_f32_16x16x32_bf16 v[188:191], a[228:231], a[52:55], v[188:191]
v_mfma_f32_16x16x32_bf16 v[196:199], a[228:231], a[56:59], v[196:199]
ds_read_b64_tr_b16 v[100:101], v26 offset:0
v_mfma_f32_16x16x32_bf16 v[196:199], a[232:235], a[60:63], v[196:199]
ds_read_b64_tr_b16 v[102:103], v26 offset:512
v_mfma_f32_16x16x32_bf16 v[196:199], a[236:239], a[64:67], v[196:199]
buffer_load_dwordx4 v9, s[24:27], s49 offen offset:3072 nt lds
v_mfma_f32_16x16x32_bf16 v[204:207], a[236:239], a[68:71], v[204:207]
ds_read_b64_tr_b16 v[104:105], v27 offset:0
v_mfma_f32_16x16x32_bf16 v[204:207], a[232:235], a[64:67], v[204:207]
ds_read_b64_tr_b16 v[106:107], v27 offset:512
v_mfma_f32_16x16x32_bf16 v[204:207], a[228:231], a[60:63], v[204:207]
ds_read_b64_tr_b16 a[252:253], v25 offset:0
v_mfma_f32_16x16x32_bf16 v[236:239], a[240:243], a[60:63], v[236:239]
ds_read_b64_tr_b16 a[254:255], v25 offset:512
s_waitcnt lgkmcnt(6)
v_mfma_f32_16x16x32_bf16 v[236:239], a[244:247], a[64:67], v[236:239]
s_waitcnt vmcnt(9)
s_barrier
ds_read_b64_tr_b16 v[116:117], v18 offset:12288
v_mfma_f32_16x16x32_bf16 v[236:239], a[248:251], a[68:71], v[236:239]
s_addk_i32 s53, 28672
ds_read_b64_tr_b16 v[118:119], v18 offset:12800
v_mfma_f32_16x16x32_bf16 v[232:235], a[248:251], a[64:67], v[232:235]
s_add_u32 m0, s21, 135168
ds_read_b128 a[104:107], v40 offset:0
v_mfma_f32_16x16x32_bf16 v[232:235], a[244:247], a[60:63], v[232:235]
buffer_load_dwordx4 v10, s[28:31], s53 offen offset:0  lds
v_mfma_f32_16x16x32_bf16 v[232:235], a[240:243], a[56:59], v[232:235]
ds_read_b64_tr_b16 v[112:113], v17 offset:12288
v_mfma_f32_16x16x32_bf16 v[228:231], a[240:243], a[52:55], v[228:231]
ds_read_b64_tr_b16 v[114:115], v17 offset:12800
v_mfma_f32_16x16x32_bf16 v[228:231], a[244:247], a[56:59], v[228:231]
ds_read_b128 a[100:103], v36 offset:14336
v_mfma_f32_16x16x32_bf16 v[228:231], a[248:251], a[60:63], v[228:231]
ds_read_b64_tr_b16 v[108:109], v16 offset:12288
v_mfma_f32_16x16x32_bf16 v[224:227], a[248:251], a[56:59], v[224:227]
ds_read_b64_tr_b16 v[110:111], v16 offset:12800
v_mfma_f32_16x16x32_bf16 v[224:227], a[244:247], a[52:55], v[224:227]
ds_read_b128 a[96:99], v36 offset:12288
v_mfma_f32_16x16x32_bf16 v[224:227], a[240:243], a[48:51], v[224:227]
ds_read_b128 a[92:95], v36 offset:10240
v_mfma_f32_16x16x32_bf16 v[220:223], a[240:243], a[44:47], v[220:223]
v_mfma_f32_16x16x32_bf16 v[220:223], a[244:247], a[48:51], v[220:223]
v_mfma_f32_16x16x32_bf16 v[220:223], a[248:251], a[52:55], v[220:223]
v_mfma_f32_16x16x32_bf16 v[216:219], a[248:251], a[48:51], v[216:219]
v_mfma_f32_16x16x32_bf16 v[216:219], a[244:247], a[44:47], v[216:219]
ds_read_b128 a[88:91], v36 offset:8192
v_mfma_f32_16x16x32_bf16 v[216:219], a[240:243], a[40:43], v[216:219]
ds_read_b128 a[84:87], v36 offset:6144
v_mfma_f32_16x16x32_bf16 v[212:215], a[240:243], a[36:39], v[212:215]
v_mfma_f32_16x16x32_bf16 v[212:215], a[244:247], a[40:43], v[212:215]
v_mfma_f32_16x16x32_bf16 v[212:215], a[248:251], a[44:47], v[212:215]
v_mfma_f32_16x16x32_bf16 v[208:211], a[248:251], a[40:43], v[208:211]
v_mfma_f32_16x16x32_bf16 v[208:211], a[244:247], a[36:39], v[208:211]
ds_read_b128 a[80:83], v36 offset:4096
s_waitcnt lgkmcnt(3)
v_mfma_f32_16x16x32_bf16 v[240:243], v[100:103], a[36:39], v[240:243]
ds_read_b128 a[76:79], v36 offset:2048
v_mfma_f32_16x16x32_bf16 v[240:243], v[104:107], a[40:43], v[240:243]
v_mfma_f32_16x16x32_bf16 v[244:247], v[104:107], a[44:47], v[244:247]
v_mfma_f32_16x16x32_bf16 v[244:247], v[100:103], a[40:43], v[244:247]
v_mfma_f32_16x16x32_bf16 v[244:247], a[252:255], a[36:39], v[244:247]
v_mfma_f32_16x16x32_bf16 v[248:251], a[252:255], a[40:43], v[248:251]
ds_read_b128 a[72:75], v36 offset:0
v_mfma_f32_16x16x32_bf16 v[248:251], v[100:103], a[44:47], v[248:251]
ds_read_b64_tr_b16 v[124:125], v20 offset:12288
v_mfma_f32_16x16x32_bf16 v[248:251], v[104:107], a[48:51], v[248:251]
ds_read_b64_tr_b16 v[126:127], v20 offset:12800
v_mfma_f32_16x16x32_bf16 v[252:255], v[104:107], a[52:55], v[252:255]
ds_read_b64_tr_b16 v[128:129], v21 offset:12288
v_mfma_f32_16x16x32_bf16 v[252:255], v[100:103], a[48:51], v[252:255]
ds_read_b64_tr_b16 v[130:131], v21 offset:12800
v_mfma_f32_16x16x32_bf16 v[252:255], a[252:255], a[44:47], v[252:255]
v_mfma_f32_16x16x32_bf16 v[200:203], v[116:119], a[104:107], v[200:203]
ds_read_b64_tr_b16 v[120:121], v19 offset:12288
v_mfma_f32_16x16x32_bf16 v[200:203], v[112:115], a[100:103], v[200:203]
ds_read_b64_tr_b16 v[122:123], v19 offset:12800
v_mfma_f32_16x16x32_bf16 v[200:203], v[108:111], a[96:99], v[200:203]
v_mfma_f32_16x16x32_bf16 v[192:195], v[108:111], a[92:95], v[192:195]
v_mfma_f32_16x16x32_bf16 v[192:195], v[112:115], a[96:99], v[192:195]
v_mfma_f32_16x16x32_bf16 v[192:195], v[116:119], a[100:103], v[192:195]
v_mfma_f32_16x16x32_bf16 v[184:187], v[116:119], a[96:99], v[184:187]
buffer_load_dwordx4 v11, s[28:31], s53 offen offset:1024  lds
v_mfma_f32_16x16x32_bf16 v[184:187], v[112:115], a[92:95], v[184:187]
s_waitcnt lgkmcnt(2)
v_mfma_f32_16x16x32_bf16 v[184:187], v[108:111], a[88:91], v[184:187]
v_mfma_f32_16x16x32_bf16 v[176:179], v[108:111], a[84:87], v[176:179]
v_mfma_f32_16x16x32_bf16 v[176:179], v[112:115], a[88:91], v[176:179]
buffer_load_dwordx4 v12, s[28:31], s53 offen offset:2048  lds
v_mfma_f32_16x16x32_bf16 v[176:179], v[116:119], a[92:95], v[176:179]
ds_read_b64_tr_b16 v[140:141], v21 offset:24576
v_mfma_f32_16x16x32_bf16 v[168:171], v[116:119], a[88:91], v[168:171]
s_addk_i32 s53, 28672
ds_read_b64_tr_b16 v[142:143], v21 offset:25088
v_mfma_f32_16x16x32_bf16 v[168:171], v[112:115], a[84:87], v[168:171]
s_addk_i32 m0, 12288
ds_read_b128 a[140:143], v41 offset:0
v_mfma_f32_16x16x32_bf16 v[168:171], v[108:111], a[80:83], v[168:171]
buffer_load_dwordx4 v10, s[28:31], s53 offen offset:0  lds
v_mfma_f32_16x16x32_bf16 v[160:163], v[108:111], a[76:79], v[160:163]
ds_read_b64_tr_b16 v[136:137], v20 offset:24576
v_mfma_f32_16x16x32_bf16 v[160:163], v[112:115], a[80:83], v[160:163]
ds_read_b64_tr_b16 v[138:139], v20 offset:25088
v_mfma_f32_16x16x32_bf16 v[160:163], v[116:119], a[84:87], v[160:163]
ds_read_b128 a[136:139], v37 offset:14336
v_mfma_f32_16x16x32_bf16 v[152:155], v[116:119], a[80:83], v[152:155]
buffer_load_dwordx4 v11, s[28:31], s53 offen offset:1024  lds
v_mfma_f32_16x16x32_bf16 v[152:155], v[112:115], a[76:79], v[152:155]
ds_read_b64_tr_b16 v[132:133], v19 offset:24576
v_mfma_f32_16x16x32_bf16 v[152:155], v[108:111], a[72:75], v[152:155]
ds_read_b64_tr_b16 v[134:135], v19 offset:25088
v_mfma_f32_16x16x32_bf16 v[144:147], v[112:115], a[72:75], v[144:147]
ds_read_b128 a[132:135], v37 offset:12288
v_mfma_f32_16x16x32_bf16 v[144:147], v[116:119], a[76:79], v[144:147]
buffer_load_dwordx4 v12, s[28:31], s53 offen offset:2048  lds
v_mfma_f32_16x16x32_bf16 v[148:151], v[124:127], a[72:75], v[148:151]
ds_read_b128 a[128:131], v37 offset:10240
v_mfma_f32_16x16x32_bf16 v[148:151], v[128:131], a[76:79], v[148:151]
v_mfma_f32_16x16x32_bf16 v[156:159], v[128:131], a[80:83], v[156:159]
s_mov_b32 s55, 344064
v_mfma_f32_16x16x32_bf16 v[156:159], v[124:127], a[76:79], v[156:159]
buffer_load_dword v2, v50, s[28:31], s55 offen
s_waitcnt lgkmcnt(4)
v_mfma_f32_16x16x32_bf16 v[156:159], v[120:123], a[72:75], v[156:159]
v_mfma_f32_16x16x32_bf16 v[164:167], v[120:123], a[76:79], v[164:167]
s_addk_i32 s48, 128
ds_read_b128 a[124:127], v37 offset:8192
v_mfma_f32_16x16x32_bf16 v[164:167], v[124:127], a[80:83], v[164:167]
s_add_u32 m0, s20, 32768
ds_read_b128 a[120:123], v37 offset:6144
v_mfma_f32_16x16x32_bf16 v[164:167], v[128:131], a[84:87], v[164:167]
buffer_load_dwordx4 v6, s[24:27], s48 offen offset:0 nt lds
v_mfma_f32_16x16x32_bf16 v[172:175], v[128:131], a[88:91], v[172:175]
v_mfma_f32_16x16x32_bf16 v[172:175], v[124:127], a[84:87], v[172:175]
v_mfma_f32_16x16x32_bf16 v[172:175], v[120:123], a[80:83], v[172:175]
ds_read_b128 a[116:119], v37 offset:4096
v_mfma_f32_16x16x32_bf16 v[180:183], v[120:123], a[84:87], v[180:183]
buffer_load_dwordx4 v8, s[24:27], s48 offen offset:2048 nt lds
v_mfma_f32_16x16x32_bf16 v[180:183], v[124:127], a[88:91], v[180:183]
ds_read_b128 a[112:115], v37 offset:2048
v_mfma_f32_16x16x32_bf16 v[180:183], v[128:131], a[92:95], v[180:183]
v_mfma_f32_16x16x32_bf16 v[188:191], v[128:131], a[96:99], v[188:191]
v_mfma_f32_16x16x32_bf16 v[188:191], v[124:127], a[92:95], v[188:191]
buffer_load_dwordx4 v7, s[24:27], s48 offen offset:1024 nt lds
v_mfma_f32_16x16x32_bf16 v[188:191], v[120:123], a[88:91], v[188:191]
ds_read_b128 a[108:111], v37 offset:0
v_mfma_f32_16x16x32_bf16 v[196:199], v[120:123], a[92:95], v[196:199]
ds_read_b64_tr_b16 a[220:221], v17 offset:24576
v_mfma_f32_16x16x32_bf16 v[196:199], v[124:127], a[96:99], v[196:199]
ds_read_b64_tr_b16 a[222:223], v17 offset:25088
v_mfma_f32_16x16x32_bf16 v[196:199], v[128:131], a[100:103], v[196:199]
buffer_load_dwordx4 v9, s[24:27], s48 offen offset:3072 nt lds
v_mfma_f32_16x16x32_bf16 v[204:207], v[128:131], a[104:107], v[204:207]
ds_read_b64_tr_b16 a[224:225], v18 offset:24576
v_mfma_f32_16x16x32_bf16 v[204:207], v[124:127], a[100:103], v[204:207]
s_addk_i32 s49, 128
ds_read_b64_tr_b16 a[226:227], v18 offset:25088
v_mfma_f32_16x16x32_bf16 v[204:207], v[120:123], a[96:99], v[204:207]
s_add_u32 m0, s100, 32768
ds_read_b64_tr_b16 a[216:217], v16 offset:24576
v_mfma_f32_16x16x32_bf16 v[204:207], v[140:143], a[140:143], v[204:207]
buffer_load_dwordx4 v6, s[24:27], s49 offen offset:0 nt lds
v_mfma_f32_16x16x32_bf16 v[204:207], v[136:139], a[136:139], v[204:207]
ds_read_b64_tr_b16 a[218:219], v16 offset:25088
s_waitcnt lgkmcnt(7)
v_mfma_f32_16x16x32_bf16 v[204:207], v[132:135], a[132:135], v[204:207]
v_mfma_f32_16x16x32_bf16 v[196:199], v[132:135], a[128:131], v[196:199]
v_mfma_f32_16x16x32_bf16 v[196:199], v[136:139], a[132:135], v[196:199]
buffer_load_dwordx4 v8, s[24:27], s49 offen offset:2048 nt lds
v_mfma_f32_16x16x32_bf16 v[196:199], v[140:143], a[136:139], v[196:199]
v_mfma_f32_16x16x32_bf16 v[188:191], v[140:143], a[132:135], v[188:191]
v_mfma_f32_16x16x32_bf16 v[188:191], v[136:139], a[128:131], v[188:191]
v_mfma_f32_16x16x32_bf16 v[188:191], v[132:135], a[124:127], v[188:191]
buffer_load_dwordx4 v7, s[24:27], s49 offen offset:1024 nt lds
v_mfma_f32_16x16x32_bf16 v[180:183], v[132:135], a[120:123], v[180:183]
v_mfma_f32_16x16x32_bf16 v[180:183], v[136:139], a[124:127], v[180:183]
v_mfma_f32_16x16x32_bf16 v[180:183], v[140:143], a[128:131], v[180:183]
v_mfma_f32_16x16x32_bf16 v[172:175], v[140:143], a[124:127], v[172:175]
buffer_load_dwordx4 v9, s[24:27], s49 offen offset:3072 nt lds
v_mfma_f32_16x16x32_bf16 v[172:175], v[136:139], a[120:123], v[172:175]
s_waitcnt vmcnt(12) lgkmcnt(0)
s_barrier
ds_read_b64_tr_b16 a[236:237], v18 offset:36864
v_mfma_f32_16x16x32_bf16 v[172:175], v[132:135], a[116:119], v[172:175]
s_addk_i32 s53, 28672
ds_read_b64_tr_b16 a[238:239], v18 offset:37376
v_mfma_f32_16x16x32_bf16 v[164:167], v[132:135], a[112:115], v[164:167]
s_add_u32 m0, s21, 98304
ds_read_b128 a[176:179], v38 offset:0
v_mfma_f32_16x16x32_bf16 v[164:167], v[136:139], a[116:119], v[164:167]
buffer_load_dwordx4 v10, s[28:31], s53 offen offset:0  lds
v_mfma_f32_16x16x32_bf16 v[164:167], v[140:143], a[120:123], v[164:167]
ds_read_b64_tr_b16 a[232:233], v17 offset:36864
v_mfma_f32_16x16x32_bf16 v[156:159], v[140:143], a[116:119], v[156:159]
ds_read_b64_tr_b16 a[234:235], v17 offset:37376
v_mfma_f32_16x16x32_bf16 v[156:159], v[136:139], a[112:115], v[156:159]
ds_read_b128 a[172:175], v34 offset:14336
v_mfma_f32_16x16x32_bf16 v[156:159], v[132:135], a[108:111], v[156:159]
ds_read_b64_tr_b16 a[228:229], v16 offset:36864
v_mfma_f32_16x16x32_bf16 v[148:151], v[136:139], a[108:111], v[148:151]
ds_read_b64_tr_b16 a[230:231], v16 offset:37376
v_mfma_f32_16x16x32_bf16 v[148:151], v[140:143], a[112:115], v[148:151]
ds_read_b128 a[168:171], v34 offset:12288
v_mfma_f32_16x16x32_bf16 v[144:147], a[220:223], a[108:111], v[144:147]
ds_read_b128 a[164:167], v34 offset:10240
v_mfma_f32_16x16x32_bf16 v[144:147], a[224:227], a[112:115], v[144:147]
v_mfma_f32_16x16x32_bf16 v[152:155], a[224:227], a[116:119], v[152:155]
v_mfma_f32_16x16x32_bf16 v[152:155], a[220:223], a[112:115], v[152:155]
v_mfma_f32_16x16x32_bf16 v[152:155], a[216:219], a[108:111], v[152:155]
v_mfma_f32_16x16x32_bf16 v[160:163], a[216:219], a[112:115], v[160:163]
ds_read_b128 a[160:163], v34 offset:8192
v_mfma_f32_16x16x32_bf16 v[160:163], a[220:223], a[116:119], v[160:163]
ds_read_b128 a[156:159], v34 offset:6144
v_mfma_f32_16x16x32_bf16 v[160:163], a[224:227], a[120:123], v[160:163]
v_mfma_f32_16x16x32_bf16 v[168:171], a[224:227], a[124:127], v[168:171]
v_mfma_f32_16x16x32_bf16 v[168:171], a[220:223], a[120:123], v[168:171]
v_mfma_f32_16x16x32_bf16 v[168:171], a[216:219], a[116:119], v[168:171]
v_mfma_f32_16x16x32_bf16 v[176:179], a[216:219], a[120:123], v[176:179]
ds_read_b128 a[152:155], v34 offset:4096
v_mfma_f32_16x16x32_bf16 v[176:179], a[220:223], a[124:127], v[176:179]
ds_read_b128 a[148:151], v34 offset:2048
v_mfma_f32_16x16x32_bf16 v[176:179], a[224:227], a[128:131], v[176:179]
v_mfma_f32_16x16x32_bf16 v[184:187], a[224:227], a[132:135], v[184:187]
v_mfma_f32_16x16x32_bf16 v[184:187], a[220:223], a[128:131], v[184:187]
v_mfma_f32_16x16x32_bf16 v[184:187], a[216:219], a[124:127], v[184:187]
v_mfma_f32_16x16x32_bf16 v[192:195], a[216:219], a[128:131], v[192:195]
ds_read_b128 a[144:147], v34 offset:0
v_mfma_f32_16x16x32_bf16 v[192:195], a[220:223], a[132:135], v[192:195]
ds_read_b64_tr_b16 a[244:245], v20 offset:36864
v_mfma_f32_16x16x32_bf16 v[192:195], a[224:227], a[136:139], v[192:195]
ds_read_b64_tr_b16 a[246:247], v20 offset:37376
v_mfma_f32_16x16x32_bf16 v[200:203], a[224:227], a[140:143], v[200:203]
ds_read_b64_tr_b16 a[248:249], v21 offset:36864
v_mfma_f32_16x16x32_bf16 v[200:203], a[220:223], a[136:139], v[200:203]
ds_read_b64_tr_b16 a[250:251], v21 offset:37376
v_mfma_f32_16x16x32_bf16 v[200:203], a[216:219], a[132:135], v[200:203]
s_waitcnt lgkmcnt(5)
v_mfma_f32_16x16x32_bf16 v[200:203], a[236:239], a[176:179], v[200:203]
ds_read_b64_tr_b16 a[240:241], v19 offset:36864
v_mfma_f32_16x16x32_bf16 v[200:203], a[232:235], a[172:175], v[200:203]
ds_read_b64_tr_b16 a[242:243], v19 offset:37376
v_mfma_f32_16x16x32_bf16 v[200:203], a[228:231], a[168:171], v[200:203]
v_mfma_f32_16x16x32_bf16 v[192:195], a[228:231], a[164:167], v[192:195]
v_mfma_f32_16x16x32_bf16 v[192:195], a[232:235], a[168:171], v[192:195]
v_mfma_f32_16x16x32_bf16 v[192:195], a[236:239], a[172:175], v[192:195]
v_mfma_f32_16x16x32_bf16 v[184:187], a[236:239], a[168:171], v[184:187]
ds_read_b128 v[52:55], v47 offset:0
v_mfma_f32_16x16x32_bf16 v[184:187], a[232:235], a[164:167], v[184:187]
ds_read_b128 v[56:59], v47 offset:512
v_mfma_f32_16x16x32_bf16 v[184:187], a[228:231], a[160:163], v[184:187]
ds_read_b128 v[60:63], v47 offset:64
v_mfma_f32_16x16x32_bf16 v[176:179], a[228:231], a[156:159], v[176:179]
ds_read_b128 v[64:67], v47 offset:576
v_mfma_f32_16x16x32_bf16 v[176:179], a[232:235], a[160:163], v[176:179]
buffer_load_dwordx4 v11, s[28:31], s53 offen offset:1024  lds
v_mfma_f32_16x16x32_bf16 v[176:179], a[236:239], a[164:167], v[176:179]
ds_read_b128 v[68:71], v48 offset:0
v_mfma_f32_16x16x32_bf16 v[168:171], a[236:239], a[160:163], v[168:171]
ds_read_b128 v[72:75], v48 offset:512
v_mfma_f32_16x16x32_bf16 v[168:171], a[232:235], a[156:159], v[168:171]
s_waitcnt vmcnt(11) lgkmcnt(6)
s_barrier
ds_read_b64_tr_b16 v[104:105], v21 offset:49152
ds_read_b64_tr_b16 v[106:107], v21 offset:49664
v_mfma_f32_16x16x32_bf16 v[168:171], a[228:231], a[152:155], v[168:171]
buffer_load_dwordx4 v12, s[28:31], s53 offen offset:2048  lds
v_mfma_f32_16x16x32_bf16 v[160:163], a[228:231], a[148:151], v[160:163]
ds_read_b128 a[212:215], v39 offset:0
ds_read_b64_tr_b16 v[100:101], v20 offset:49152
v_mfma_f32_16x16x32_bf16 v[160:163], a[232:235], a[152:155], v[160:163]
s_addk_i32 s53, 28672
ds_read_b64_tr_b16 v[102:103], v20 offset:49664
v_mfma_f32_16x16x32_bf16 v[160:163], a[236:239], a[156:159], v[160:163]
s_addk_i32 m0, 12288
ds_read_b128 a[208:211], v35 offset:14336
v_mfma_f32_16x16x32_bf16 v[152:155], a[236:239], a[152:155], v[152:155]
buffer_load_dwordx4 v10, s[28:31], s53 offen offset:0  lds
v_mfma_f32_16x16x32_bf16 v[152:155], a[232:235], a[148:151], v[152:155]
ds_read_b64_tr_b16 a[252:253], v19 offset:49152
v_mfma_f32_16x16x32_bf16 v[152:155], a[228:231], a[144:147], v[152:155]
ds_read_b64_tr_b16 a[254:255], v19 offset:49664
v_mfma_f32_16x16x32_bf16 v[144:147], a[232:235], a[144:147], v[144:147]
ds_read_b128 a[204:207], v35 offset:12288
v_mfma_f32_16x16x32_bf16 v[144:147], a[236:239], a[148:151], v[144:147]
buffer_load_dwordx4 v11, s[28:31], s53 offen offset:1024  lds
v_mfma_f32_16x16x32_bf16 v[148:151], a[244:247], a[144:147], v[148:151]
ds_read_b128 a[200:203], v35 offset:10240
v_mfma_f32_16x16x32_bf16 v[148:151], a[248:251], a[148:151], v[148:151]
ds_read_b128 v[76:79], v48 offset:128
v_mfma_f32_16x16x32_bf16 v[156:159], a[248:251], a[152:155], v[156:159]
ds_read_b128 v[80:83], v48 offset:640
v_mfma_f32_16x16x32_bf16 v[156:159], a[244:247], a[148:151], v[156:159]
buffer_load_dwordx4 v12, s[28:31], s53 offen offset:2048  lds
v_mfma_f32_16x16x32_bf16 v[156:159], a[240:243], a[144:147], v[156:159]
v_mfma_f32_16x16x32_bf16 v[164:167], a[240:243], a[148:151], v[164:167]
s_addk_i32 s53, -28672
ds_read_b128 a[196:199], v35 offset:8192
v_mfma_f32_16x16x32_bf16 v[164:167], a[244:247], a[152:155], v[164:167]
s_add_u32 m0, s21, 69632
ds_read_b128 a[192:195], v35 offset:6144
v_mfma_f32_16x16x32_bf16 v[164:167], a[248:251], a[156:159], v[164:167]
buffer_load_dwordx4 v13, s[28:31], s53 offen offset:0  lds
v_mfma_f32_16x16x32_bf16 v[172:175], a[248:251], a[160:163], v[172:175]
v_mfma_f32_16x16x32_bf16 v[172:175], a[244:247], a[156:159], v[172:175]
v_mfma_f32_16x16x32_bf16 v[172:175], a[240:243], a[152:155], v[172:175]
ds_read_b128 a[188:191], v35 offset:4096
v_mfma_f32_16x16x32_bf16 v[180:183], a[240:243], a[156:159], v[180:183]
buffer_load_dwordx4 v14, s[28:31], s53 offen offset:1024  lds
v_mfma_f32_16x16x32_bf16 v[180:183], a[244:247], a[160:163], v[180:183]
ds_read_b128 a[184:187], v35 offset:2048
v_mfma_f32_16x16x32_bf16 v[180:183], a[248:251], a[164:167], v[180:183]
ds_read_b128 a[180:183], v35 offset:0
v_mfma_f32_16x16x32_bf16 v[188:191], a[248:251], a[168:171], v[188:191]
ds_read_b64_tr_b16 v[112:113], v17 offset:49152
v_mfma_f32_16x16x32_bf16 v[188:191], a[244:247], a[164:167], v[188:191]
buffer_load_dwordx4 v15, s[28:31], s53 offen offset:2048  lds
v_mfma_f32_16x16x32_bf16 v[188:191], a[240:243], a[160:163], v[188:191]
ds_read_b64_tr_b16 v[114:115], v17 offset:49664
v_mfma_f32_16x16x32_bf16 v[196:199], a[240:243], a[164:167], v[196:199]
s_addk_i32 s53, 28672
ds_read_b64_tr_b16 v[116:117], v18 offset:49152
v_mfma_f32_16x16x32_bf16 v[196:199], a[244:247], a[168:171], v[196:199]
s_addk_i32 m0, 12288
ds_read_b64_tr_b16 v[118:119], v18 offset:49664
v_mfma_f32_16x16x32_bf16 v[196:199], a[248:251], a[172:175], v[196:199]
buffer_load_dwordx4 v13, s[28:31], s53 offen offset:0  lds
v_mfma_f32_16x16x32_bf16 v[204:207], a[248:251], a[176:179], v[204:207]
ds_read_b64_tr_b16 v[108:109], v16 offset:49152
v_mfma_f32_16x16x32_bf16 v[204:207], a[244:247], a[172:175], v[204:207]
ds_read_b64_tr_b16 v[110:111], v16 offset:49664
v_mfma_f32_16x16x32_bf16 v[204:207], a[240:243], a[168:171], v[204:207]
s_waitcnt lgkmcnt(6)
v_mfma_f32_16x16x32_bf16 v[204:207], v[104:107], a[212:215], v[204:207]
buffer_load_dwordx4 v14, s[28:31], s53 offen offset:1024  lds
v_mfma_f32_16x16x32_bf16 v[204:207], v[100:103], a[208:211], v[204:207]
v_mfma_f32_16x16x32_bf16 v[204:207], a[252:255], a[204:207], v[204:207]
v_mfma_f32_16x16x32_bf16 v[196:199], a[252:255], a[200:203], v[196:199]
v_mfma_f32_16x16x32_bf16 v[196:199], v[100:103], a[204:207], v[196:199]
buffer_load_dwordx4 v15, s[28:31], s53 offen offset:2048  lds
v_mfma_f32_16x16x32_bf16 v[196:199], v[104:107], a[208:211], v[196:199]
v_mfma_f32_16x16x32_bf16 v[188:191], v[104:107], a[204:207], v[188:191]
s_mov_b32 s53, 229376
v_mfma_f32_16x16x32_bf16 v[188:191], v[100:103], a[200:203], v[188:191]
s_waitcnt vmcnt(6) lgkmcnt(1)
s_barrier
s_add_u32 m0, s21, 122880
ds_read_b64_tr_b16 v[124:125], v17 offset:0
v_mfma_f32_16x16x32_bf16 v[188:191], a[252:255], a[196:199], v[188:191]
buffer_load_dwordx4 v13, s[28:31], s53 offen offset:0  lds
v_mfma_f32_16x16x32_bf16 v[180:183], a[252:255], a[192:195], v[180:183]
ds_read_b64_tr_b16 v[126:127], v17 offset:512
ds_read_b128 a[0:3], v34 offset:32768
v_mfma_f32_16x16x32_bf16 v[180:183], v[100:103], a[196:199], v[180:183]
ds_read_b64_tr_b16 v[128:129], v18 offset:0
ds_read_b64_tr_b16 v[130:131], v18 offset:512
v_mfma_f32_16x16x32_bf16 v[180:183], v[104:107], a[200:203], v[180:183]
ds_read_b128 a[4:7], v34 offset:34816
ds_read_b64_tr_b16 v[136:137], v17 offset:12288
v_mfma_f32_16x16x32_bf16 v[172:175], v[104:107], a[196:199], v[172:175]
buffer_load_dwordx4 v14, s[28:31], s53 offen offset:1024  lds
v_mfma_f32_16x16x32_bf16 v[172:175], v[100:103], a[192:195], v[172:175]
ds_read_b64_tr_b16 v[138:139], v17 offset:12800
ds_read_b128 a[36:39], v35 offset:32768
v_mfma_f32_16x16x32_bf16 v[172:175], a[252:255], a[188:191], v[172:175]
ds_read_b64_tr_b16 v[140:141], v18 offset:12288
ds_read_b64_tr_b16 v[142:143], v18 offset:12800
v_mfma_f32_16x16x32_bf16 v[164:167], a[252:255], a[184:187], v[164:167]
ds_read_b128 a[40:43], v35 offset:34816
ds_read_b64_tr_b16 a[236:237], v21 offset:12288
v_mfma_f32_16x16x32_bf16 v[164:167], v[100:103], a[188:191], v[164:167]
buffer_load_dwordx4 v15, s[28:31], s53 offen offset:2048  lds
v_mfma_f32_16x16x32_bf16 v[164:167], v[104:107], a[192:195], v[164:167]
ds_read_b64_tr_b16 a[238:239], v21 offset:12800
v_mfma_f32_16x16x32_bf16 v[156:159], v[104:107], a[188:191], v[156:159]
s_addk_i32 s53, 28672
ds_read_b64_tr_b16 a[232:233], v20 offset:12288
v_mfma_f32_16x16x32_bf16 v[156:159], v[100:103], a[184:187], v[156:159]
s_addk_i32 m0, 12288
ds_read_b64_tr_b16 a[234:235], v20 offset:12800
v_mfma_f32_16x16x32_bf16 v[156:159], a[252:255], a[180:183], v[156:159]
buffer_load_dwordx4 v13, s[28:31], s53 offen offset:0  lds
v_mfma_f32_16x16x32_bf16 v[148:151], v[100:103], a[180:183], v[148:151]
ds_read_b64_tr_b16 a[224:225], v21 offset:0
v_mfma_f32_16x16x32_bf16 v[148:151], v[104:107], a[184:187], v[148:151]
ds_read_b64_tr_b16 a[226:227], v21 offset:512
v_mfma_f32_16x16x32_bf16 v[144:147], v[112:115], a[180:183], v[144:147]
ds_read_b64_tr_b16 a[220:221], v20 offset:0
v_mfma_f32_16x16x32_bf16 v[144:147], v[116:119], a[184:187], v[144:147]
buffer_load_dwordx4 v14, s[28:31], s53 offen offset:1024  lds
v_mfma_f32_16x16x32_bf16 v[152:155], v[116:119], a[188:191], v[152:155]
ds_read_b64_tr_b16 a[222:223], v20 offset:512
v_mfma_f32_16x16x32_bf16 v[152:155], v[112:115], a[184:187], v[152:155]
ds_read_b64_tr_b16 a[216:217], v19 offset:0
s_waitcnt lgkmcnt(7)
v_mfma_f32_16x16x32_bf16 v[152:155], v[108:111], a[180:183], v[152:155]
ds_read_b64_tr_b16 a[218:219], v19 offset:512
v_mfma_f32_16x16x32_bf16 v[160:163], v[108:111], a[184:187], v[160:163]
buffer_load_dwordx4 v15, s[28:31], s53 offen offset:2048  lds
v_mfma_f32_16x16x32_bf16 v[160:163], v[112:115], a[188:191], v[160:163]
ds_read_b128 a[8:11], v34 offset:36864
v_mfma_f32_16x16x32_bf16 v[160:163], v[116:119], a[192:195], v[160:163]
ds_read_b64_tr_b16 a[228:229], v19 offset:12288
v_mfma_f32_16x16x32_bf16 v[168:171], v[116:119], a[196:199], v[168:171]
ds_read_b64_tr_b16 a[230:231], v19 offset:12800
v_mfma_f32_16x16x32_bf16 v[168:171], v[112:115], a[192:195], v[168:171]
v_mfma_f32_16x16x32_bf16 v[168:171], v[108:111], a[188:191], v[168:171]
ds_read_b128 a[44:47], v35 offset:36864
v_mfma_f32_16x16x32_bf16 v[176:179], v[108:111], a[192:195], v[176:179]
ds_read_b64_tr_b16 v[132:133], v16 offset:12288
v_mfma_f32_16x16x32_bf16 v[176:179], v[112:115], a[196:199], v[176:179]
ds_read_b64_tr_b16 v[134:135], v16 offset:12800
v_mfma_f32_16x16x32_bf16 v[176:179], v[116:119], a[200:203], v[176:179]
ds_read_b128 a[12:15], v34 offset:38912
v_mfma_f32_16x16x32_bf16 v[184:187], v[116:119], a[204:207], v[184:187]
ds_read_b128 a[16:19], v34 offset:40960
v_mfma_f32_16x16x32_bf16 v[184:187], v[112:115], a[200:203], v[184:187]
ds_read_b64_tr_b16 v[120:121], v16 offset:0
v_mfma_f32_16x16x32_bf16 v[184:187], v[108:111], a[196:199], v[184:187]
ds_read_b64_tr_b16 v[122:123], v16 offset:512
v_mfma_f32_16x16x32_bf16 v[192:195], v[108:111], a[200:203], v[192:195]
ds_read_b128 a[20:23], v34 offset:43008
v_mfma_f32_16x16x32_bf16 v[192:195], v[112:115], a[204:207], v[192:195]
v_mfma_f32_16x16x32_bf16 v[192:195], v[116:119], a[208:211], v[192:195]
ds_read_b128 a[24:27], v34 offset:45056
v_mfma_f32_16x16x32_bf16 v[200:203], v[116:119], a[212:215], v[200:203]
v_mfma_f32_16x16x32_bf16 v[200:203], v[112:115], a[208:211], v[200:203]
ds_read_b128 a[28:31], v34 offset:47104
v_mfma_f32_16x16x32_bf16 v[200:203], v[108:111], a[204:207], v[200:203]
ds_read_b128 a[48:51], v35 offset:38912
v_mfma_f32_16x16x32_bf16 v[144:147], v[124:127], a[0:3], v[144:147]
ds_read_b128 a[32:35], v38 offset:32768
v_mfma_f32_16x16x32_bf16 v[144:147], v[128:131], a[4:7], v[144:147]
v_mfma_f32_16x16x32_bf16 v[144:147], v[136:139], a[36:39], v[144:147]
v_mfma_f32_16x16x32_bf16 v[144:147], v[140:143], a[40:43], v[144:147]
v_mfma_f32_16x16x32_bf16 v[148:151], a[236:239], a[40:43], v[148:151]
s_waitcnt lgkmcnt(4)
v_mfma_f32_16x16x32_bf16 v[148:151], a[232:235], a[36:39], v[148:151]
v_mfma_f32_16x16x32_bf16 v[148:151], a[224:227], a[4:7], v[148:151]
s_nop 3
v_fma_f32 v144, v144, v52, v56
v_fma_f32 v145, v145, v53, v57
v_mfma_f32_16x16x32_bf16 v[148:151], a[220:223], a[0:3], v[148:151]
v_exp_f32 v84, v144
v_mfma_f32_16x16x32_bf16 v[156:159], a[216:219], a[0:3], v[156:159]
ds_read_b128 a[52:55], v35 offset:40960
v_fma_f32 v146, v146, v54, v58
v_mfma_f32_16x16x32_bf16 v[156:159], a[220:223], a[4:7], v[156:159]
v_exp_f32 v85, v145
v_mfma_f32_16x16x32_bf16 v[156:159], a[224:227], a[8:11], v[156:159]
v_fma_f32 v147, v147, v55, v59
v_fma_f32 v84, v84, s50, s50
v_mfma_f32_16x16x32_bf16 v[156:159], a[228:231], a[36:39], v[156:159]
v_exp_f32 v86, v146
v_exp_f32 v87, v147
v_fma_f32 v85, v85, s50, s50
v_pk_fma_f32 v[148:149], v[148:149], v[60:61], v[64:65]
v_pk_fma_f32 v[150:151], v[150:151], v[62:63], v[66:67]
v_mfma_f32_16x16x32_bf16 v[156:159], a[232:235], a[40:43], v[156:159]
ds_read_b128 a[56:59], v35 offset:43008
ds_read_b128 a[60:63], v35 offset:45056
v_mfma_f32_16x16x32_bf16 v[156:159], a[236:239], a[44:47], v[156:159]
v_rcp_f32 v84, v84
v_mfma_f32_16x16x32_bf16 v[152:155], v[140:143], a[44:47], v[152:155]
v_rcp_f32 v85, v85
v_mfma_f32_16x16x32_bf16 v[152:155], v[136:139], a[40:43], v[152:155]
v_exp_f32 v88, v148
v_mfma_f32_16x16x32_bf16 v[152:155], v[132:135], a[36:39], v[152:155]
s_waitcnt lgkmcnt(3)
s_barrier
ds_read_b128 a[64:67], v35 offset:47104
ds_read_b128 a[68:71], v39 offset:32768
v_mfma_f32_16x16x32_bf16 v[152:155], v[128:131], a[8:11], v[152:155]
s_addk_i32 s53, 28672
v_exp_f32 v89, v149
v_mfma_f32_16x16x32_bf16 v[152:155], v[124:127], a[4:7], v[152:155]
s_add_u32 m0, s21, 98304
v_fma_f32 v86, v86, s50, s50
v_mfma_f32_16x16x32_bf16 v[152:155], v[120:123], a[0:3], v[152:155]
buffer_load_dwordx4 v13, s[28:31], s53 offen offset:0  lds
v_mfma_f32_16x16x32_bf16 v[160:163], v[120:123], a[4:7], v[160:163]
v_exp_f32 v90, v150
v_mfma_f32_16x16x32_bf16 v[160:163], v[124:127], a[8:11], v[160:163]
v_exp_f32 v91, v151
v_mfma_f32_16x16x32_bf16 v[160:163], v[128:131], a[12:15], v[160:163]
v_fma_f32 v87, v87, s50, s50
v_fma_f32 v88, v88, s50, s50
v_mfma_f32_16x16x32_bf16 v[160:163], v[132:135], a[40:43], v[160:163]
buffer_load_dwordx4 v14, s[28:31], s53 offen offset:1024  lds
v_mfma_f32_16x16x32_bf16 v[160:163], v[136:139], a[44:47], v[160:163]
v_rcp_f32 v86, v86
v_rcp_f32 v87, v87
v_pk_mul_f32 v[84:85], v[144:145], v[84:85]
v_fma_f32 v89, v89, s50, s50
v_pk_fma_f32 v[90:91], v[90:91], s[50:51], s[50:51]
v_pk_fma_f32 v[156:157], v[156:157], v[60:61], v[64:65]
v_pk_fma_f32 v[158:159], v[158:159], v[62:63], v[66:67]
v_pk_fma_f32 v[152:153], v[152:153], v[52:53], v[56:57]
v_pk_fma_f32 v[154:155], v[154:155], v[54:55], v[58:59]
v_mfma_f32_16x16x32_bf16 v[160:163], v[140:143], a[48:51], v[160:163]
v_rcp_f32 v88, v88
v_mfma_f32_16x16x32_bf16 v[164:167], a[236:239], a[48:51], v[164:167]
v_rcp_f32 v89, v89
v_mfma_f32_16x16x32_bf16 v[164:167], a[232:235], a[44:47], v[164:167]
buffer_load_dwordx4 v15, s[28:31], s53 offen offset:2048  lds
v_mfma_f32_16x16x32_bf16 v[164:167], a[228:231], a[40:43], v[164:167]
v_rcp_f32 v90, v90
v_mfma_f32_16x16x32_bf16 v[164:167], a[224:227], a[12:15], v[164:167]
s_addk_i32 s53, 28672
v_rcp_f32 v91, v91
v_mfma_f32_16x16x32_bf16 v[164:167], a[220:223], a[8:11], v[164:167]
s_addk_i32 m0, 12288
v_exp_f32 v92, v156
v_mfma_f32_16x16x32_bf16 v[164:167], a[216:219], a[4:7], v[164:167]
buffer_load_dwordx4 v13, s[28:31], s53 offen offset:0  lds
v_mfma_f32_16x16x32_bf16 v[172:175], a[216:219], a[8:11], v[172:175]
L_pad0_3:
s_cbranch_execz L_body0
v_exp_f32 v93, v157
v_mfma_f32_16x16x32_bf16 v[172:175], a[220:223], a[12:15], v[172:175]
v_exp_f32 v94, v158
v_mfma_f32_16x16x32_bf16 v[172:175], a[224:227], a[16:19], v[172:175]
v_exp_f32 v95, v159
v_mfma_f32_16x16x32_bf16 v[172:175], a[228:231], a[44:47], v[172:175]
buffer_load_dwordx4 v14, s[28:31], s53 offen offset:1024  lds
v_mfma_f32_16x16x32_bf16 v[172:175], a[232:235], a[48:51], v[172:175]
v_exp_f32 v96, v152
s_waitcnt lgkmcnt(0)
v_mfma_f32_16x16x32_bf16 v[172:175], a[236:239], a[52:55], v[172:175]
v_exp_f32 v97, v153
v_mfma_f32_16x16x32_bf16 v[168:171], v[140:143], a[52:55], v[168:171]
v_exp_f32 v98, v154
v_exp_f32 v99, v155
v_cvt_pk_bf16_f32 v144, v84, v85
v_pk_mul_f32 v[86:87], v[146:147], v[86:87]
v_pk_mul_f32 v[88:89], v[148:149], v[88:89]
v_pk_mul_f32 v[90:91], v[150:151], v[90:91]
v_pk_fma_f32 v[92:93], v[92:93], s[50:51], s[50:51]
v_pk_fma_f32 v[94:95], v[94:95], s[50:51], s[50:51]
v_pk_fma_f32 v[96:97], v[96:97], s[50:51], s[50:51]
v_pk_fma_f32 v[160:161], v[160:161], v[52:53], v[56:57]
v_pk_fma_f32 v[162:163], v[162:163], v[54:55], v[58:59]
v_mfma_f32_16x16x32_bf16 v[168:171], v[136:139], a[48:51], v[168:171]
buffer_load_dwordx4 v15, s[28:31], s53 offen offset:2048  lds
v_mfma_f32_16x16x32_bf16 v[168:171], v[132:135], a[44:47], v[168:171]
v_cvt_pk_bf16_f32 v145, v86, v87
v_cvt_pk_bf16_f32 v146, v88, v89
v_mfma_f32_16x16x32_bf16 v[168:171], v[128:131], a[16:19], v[168:171]
v_rcp_f32 v92, v92
v_mfma_f32_16x16x32_bf16 v[168:171], v[124:127], a[12:15], v[168:171]
v_rcp_f32 v93, v93
v_mfma_f32_16x16x32_bf16 v[168:171], v[120:123], a[8:11], v[168:171]
v_rcp_f32 v94, v94
v_mfma_f32_16x16x32_bf16 v[176:179], v[120:123], a[12:15], v[176:179]
v_rcp_f32 v95, v95
v_mfma_f32_16x16x32_bf16 v[176:179], v[124:127], a[16:19], v[176:179]
v_rcp_f32 v96, v96
v_mfma_f32_16x16x32_bf16 v[176:179], v[128:131], a[20:23], v[176:179]
v_rcp_f32 v97, v97
v_mfma_f32_16x16x32_bf16 v[176:179], v[132:135], a[48:51], v[176:179]
v_exp_f32 v84, v160
v_mfma_f32_16x16x32_bf16 v[176:179], v[136:139], a[52:55], v[176:179]
v_exp_f32 v85, v161
v_mfma_f32_16x16x32_bf16 v[176:179], v[140:143], a[56:59], v[176:179]
v_exp_f32 v86, v162
v_exp_f32 v87, v163
v_cvt_pk_bf16_f32 v147, v90, v91
v_pk_mul_f32 v[92:93], v[156:157], v[92:93]
v_pk_mul_f32 v[94:95], v[158:159], v[94:95]
v_pk_mul_f32 v[96:97], v[152:153], v[96:97]
v_pk_fma_f32 v[98:99], v[98:99], s[50:51], s[50:51]
v_pk_fma_f32 v[84:85], v[84:85], s[50:51], s[50:51]
v_pk_fma_f32 v[164:165], v[164:165], v[60:61], v[64:65]
v_pk_fma_f32 v[166:167], v[166:167], v[62:63], v[66:67]
v_pk_fma_f32 v[172:173], v[172:173], v[60:61], v[64:65]
v_mfma_f32_16x16x32_bf16 v[180:183], a[236:239], a[56:59], v[180:183]
v_permlane16_swap_b32 v144, v146
v_mfma_f32_16x16x32_bf16 v[180:183], a[232:235], a[52:55], v[180:183]
v_permlane16_swap_b32 v145, v147
v_mfma_f32_16x16x32_bf16 v[180:183], a[228:231], a[48:51], v[180:183]
v_cvt_pk_bf16_f32 v158, v92, v93
v_cvt_pk_bf16_f32 v159, v94, v95
v_mfma_f32_16x16x32_bf16 v[180:183], a[224:227], a[20:23], v[180:183]
v_rcp_f32 v98, v98
v_mfma_f32_16x16x32_bf16 v[180:183], a[220:223], a[16:19], v[180:183]
v_rcp_f32 v99, v99
v_mfma_f32_16x16x32_bf16 v[180:183], a[216:219], a[12:15], v[180:183]
v_rcp_f32 v84, v84
v_mfma_f32_16x16x32_bf16 v[188:191], a[216:219], a[16:19], v[188:191]
v_rcp_f32 v85, v85
v_mfma_f32_16x16x32_bf16 v[188:191], a[220:223], a[20:23], v[188:191]
v_exp_f32 v88, v164
v_mfma_f32_16x16x32_bf16 v[188:191], a[224:227], a[24:27], v[188:191]
v_exp_f32 v89, v165
v_mfma_f32_16x16x32_bf16 v[188:191], a[228:231], a[52:55], v[188:191]
s_waitcnt vmcnt(12)
s_barrier
v_exp_f32 v90, v166
v_mfma_f32_16x16x32_bf16 v[188:191], a[232:235], a[56:59], v[188:191]
v_exp_f32 v91, v167
v_mfma_f32_16x16x32_bf16 v[188:191], a[236:239], a[60:63], v[188:191]
v_exp_f32 v92, v172
v_exp_f32 v93, v173
v_cvt_pk_bf16_f32 v156, v96, v97
v_pk_mul_f32 v[98:99], v[154:155], v[98:99]
v_pk_mul_f32 v[84:85], v[160:161], v[84:85]
v_pk_fma_f32 v[86:87], v[86:87], s[50:51], s[50:51]
v_pk_fma_f32 v[88:89], v[88:89], s[50:51], s[50:51]
v_pk_fma_f32 v[90:91], v[90:91], s[50:51], s[50:51]
v_pk_fma_f32 v[174:175], v[174:175], v[62:63], v[66:67]
v_pk_fma_f32 v[168:169], v[168:169], v[52:53], v[56:57]
v_pk_fma_f32 v[170:171], v[170:171], v[54:55], v[58:59]
v_mfma_f32_16x16x32_bf16 v[184:187], v[140:143], a[60:63], v[184:187]
v_rcp_f32 v86, v86
v_mfma_f32_16x16x32_bf16 v[184:187], v[136:139], a[56:59], v[184:187]
v_rcp_f32 v87, v87
v_mfma_f32_16x16x32_bf16 v[184:187], v[132:135], a[52:55], v[184:187]
ds_read_b64_tr_b16 a[248:249], v30 offset:36864
ds_read_b64_tr_b16 a[250:251], v30 offset:37376
v_mfma_f32_16x16x32_bf16 v[184:187], v[128:131], a[24:27], v[184:187]
v_rcp_f32 v88, v88
v_mfma_f32_16x16x32_bf16 v[184:187], v[124:127], a[20:23], v[184:187]
ds_read_b64_tr_b16 a[244:245], v29 offset:36864
ds_read_b64_tr_b16 a[246:247], v29 offset:37376
v_mfma_f32_16x16x32_bf16 v[184:187], v[120:123], a[16:19], v[184:187]
v_rcp_f32 v89, v89
v_mfma_f32_16x16x32_bf16 v[192:195], v[120:123], a[20:23], v[192:195]
ds_read_b64_tr_b16 a[240:241], v28 offset:36864
ds_read_b64_tr_b16 a[242:243], v28 offset:37376
v_mfma_f32_16x16x32_bf16 v[192:195], v[124:127], a[24:27], v[192:195]
v_rcp_f32 v90, v90
v_mfma_f32_16x16x32_bf16 v[192:195], v[128:131], a[28:31], v[192:195]
v_rcp_f32 v91, v91
v_mfma_f32_16x16x32_bf16 v[192:195], v[132:135], a[56:59], v[192:195]
v_exp_f32 v94, v174
v_mfma_f32_16x16x32_bf16 v[192:195], v[136:139], a[60:63], v[192:195]
v_exp_f32 v95, v175
v_mfma_f32_16x16x32_bf16 v[192:195], v[140:143], a[64:67], v[192:195]
v_exp_f32 v96, v168
v_exp_f32 v97, v169
v_cvt_pk_bf16_f32 v157, v98, v99
v_pk_mul_f32 v[86:87], v[162:163], v[86:87]
v_pk_mul_f32 v[88:89], v[164:165], v[88:89]
v_pk_mul_f32 v[90:91], v[166:167], v[90:91]
v_pk_fma_f32 v[92:93], v[92:93], s[50:51], s[50:51]
v_pk_fma_f32 v[94:95], v[94:95], s[50:51], s[50:51]
v_pk_fma_f32 v[176:177], v[176:177], v[52:53], v[56:57]
v_mfma_f32_16x16x32_bf16 v[196:199], a[236:239], a[64:67], v[196:199]
v_permlane16_swap_b32 v156, v158
v_mfma_f32_16x16x32_bf16 v[196:199], a[232:235], a[60:63], v[196:199]
v_permlane16_swap_b32 v157, v159
v_mfma_f32_16x16x32_bf16 v[196:199], a[228:231], a[56:59], v[196:199]
v_cvt_pk_bf16_f32 v160, v84, v85
v_cvt_pk_bf16_f32 v161, v86, v87
v_mfma_f32_16x16x32_bf16 v[196:199], a[224:227], a[28:31], v[196:199]
v_rcp_f32 v92, v92
v_mfma_f32_16x16x32_bf16 v[196:199], a[220:223], a[24:27], v[196:199]
s_waitcnt vmcnt(0) lgkmcnt(0)
s_barrier
v_rcp_f32 v93, v93
v_mfma_f32_16x16x32_bf16 v[196:199], a[216:219], a[20:23], v[196:199]
buffer_store_dwordx4 v[144:147], v42, s[32:35], s40 offen sc0 sc1
v_rcp_f32 v94, v94
v_cvt_pk_bf16_f32 v162, v88, v89
v_mfma_f32_16x16x32_bf16 v[204:207], a[216:219], a[24:27], v[204:207]
v_rcp_f32 v95, v95
v_mfma_f32_16x16x32_bf16 v[204:207], a[220:223], a[28:31], v[204:207]
v_exp_f32 v98, v170
v_mfma_f32_16x16x32_bf16 v[204:207], a[224:227], a[32:35], v[204:207]
v_exp_f32 v99, v171
v_mfma_f32_16x16x32_bf16 v[204:207], a[228:231], a[60:63], v[204:207]
v_exp_f32 v84, v176
v_exp_f32 v85, v177
v_cvt_pk_bf16_f32 v163, v90, v91
v_pk_mul_f32 v[92:93], v[172:173], v[92:93]
v_pk_mul_f32 v[94:95], v[174:175], v[94:95]
v_pk_fma_f32 v[96:97], v[96:97], s[50:51], s[50:51]
v_pk_fma_f32 v[98:99], v[98:99], s[50:51], s[50:51]
v_pk_fma_f32 v[178:179], v[178:179], v[54:55], v[58:59]
v_pk_fma_f32 v[180:181], v[180:181], v[60:61], v[64:65]
v_pk_fma_f32 v[182:183], v[182:183], v[62:63], v[66:67]
v_mfma_f32_16x16x32_bf16 v[204:207], a[232:235], a[64:67], v[204:207]
v_permlane16_swap_b32 v160, v162
v_mfma_f32_16x16x32_bf16 v[204:207], a[236:239], a[68:71], v[204:207]
ds_read_b64_tr_b16 v[100:101], v32 offset:36864
ds_read_b64_tr_b16 v[102:103], v32 offset:37376
v_mfma_f32_16x16x32_bf16 v[200:203], v[140:143], a[68:71], v[200:203]
v_permlane16_swap_b32 v161, v163
v_mfma_f32_16x16x32_bf16 v[200:203], v[136:139], a[64:67], v[200:203]
ds_read_b64_tr_b16 v[104:105], v33 offset:36864
ds_read_b64_tr_b16 v[106:107], v33 offset:37376
v_mfma_f32_16x16x32_bf16 v[200:203], v[132:135], a[60:63], v[200:203]
v_rcp_f32 v96, v96
v_mfma_f32_16x16x32_bf16 v[200:203], v[128:131], a[32:35], v[200:203]
ds_read_b64_tr_b16 a[252:253], v31 offset:36864
ds_read_b64_tr_b16 a[254:255], v31 offset:37376
v_mfma_f32_16x16x32_bf16 v[200:203], v[124:127], a[28:31], v[200:203]
v_rcp_f32 v97, v97
v_mfma_f32_16x16x32_bf16 v[200:203], v[120:123], a[24:27], v[200:203]
ds_read_b64_tr_b16 v[112:113], v29 offset:49152
ds_read_b64_tr_b16 v[114:115], v29 offset:49664
v_mfma_f32_16x16x32_bf16 v[236:239], a[248:251], a[32:35], v[236:239]
v_rcp_f32 v98, v98
v_mfma_f32_16x16x32_bf16 v[236:239], a[244:247], a[28:31], v[236:239]
ds_read_b64_tr_b16 v[108:109], v30 offset:49152
ds_read_b64_tr_b16 v[110:111], v30 offset:49664
v_mfma_f32_16x16x32_bf16 v[236:239], a[240:243], a[24:27], v[236:239]
buffer_store_dwordx4 v[156:159], v42, s[32:35], s41 offen sc0 sc1
v_rcp_f32 v99, v99
v_cvt_pk_bf16_f32 v174, v92, v93
v_mfma_f32_16x16x32_bf16 v[232:235], a[240:243], a[20:23], v[232:235]
ds_read_b64_tr_b16 a[220:221], v23 offset:24576
ds_read_b64_tr_b16 a[222:223], v23 offset:25088
v_mfma_f32_16x16x32_bf16 v[232:235], a[244:247], a[24:27], v[232:235]
v_exp_f32 v86, v178
v_mfma_f32_16x16x32_bf16 v[232:235], a[248:251], a[28:31], v[232:235]
ds_read_b64_tr_b16 a[224:225], v24 offset:24576
ds_read_b64_tr_b16 a[226:227], v24 offset:25088
v_mfma_f32_16x16x32_bf16 v[228:231], a[248:251], a[24:27], v[228:231]
v_exp_f32 v87, v179
v_mfma_f32_16x16x32_bf16 v[228:231], a[244:247], a[20:23], v[228:231]
ds_read_b64_tr_b16 a[232:233], v23 offset:36864
ds_read_b64_tr_b16 a[234:235], v23 offset:37376
v_mfma_f32_16x16x32_bf16 v[228:231], a[240:243], a[16:19], v[228:231]
v_exp_f32 v88, v180
v_mfma_f32_16x16x32_bf16 v[224:227], a[240:243], a[12:15], v[224:227]
ds_read_b64_tr_b16 a[236:237], v24 offset:36864
ds_read_b64_tr_b16 a[238:239], v24 offset:37376
v_mfma_f32_16x16x32_bf16 v[224:227], a[244:247], a[16:19], v[224:227]
v_exp_f32 v89, v181
v_mfma_f32_16x16x32_bf16 v[224:227], a[248:251], a[20:23], v[224:227]
ds_read_b64_tr_b16 v[136:137], v23 offset:0
ds_read_b64_tr_b16 v[138:139], v23 offset:512
v_exp_f32 v90, v182
v_cvt_pk_bf16_f32 v175, v94, v95
v_pk_mul_f32 v[96:97], v[168:169], v[96:97]
v_pk_mul_f32 v[98:99], v[170:171], v[98:99]
v_pk_fma_f32 v[84:85], v[84:85], s[50:51], s[50:51]
v_pk_fma_f32 v[86:87], v[86:87], s[50:51], s[50:51]
v_pk_fma_f32 v[88:89], v[88:89], s[50:51], s[50:51]
v_pk_fma_f32 v[188:189], v[188:189], v[60:61], v[64:65]
v_pk_fma_f32 v[190:191], v[190:191], v[62:63], v[66:67]
v_mfma_f32_16x16x32_bf16 v[220:223], a[248:251], a[16:19], v[220:223]
v_rcp_f32 v84, v84
v_mfma_f32_16x16x32_bf16 v[220:223], a[244:247], a[12:15], v[220:223]
ds_read_b64_tr_b16 v[132:133], v24 offset:0
ds_read_b64_tr_b16 v[134:135], v24 offset:512
v_mfma_f32_16x16x32_bf16 v[220:223], a[240:243], a[8:11], v[220:223]
v_rcp_f32 v85, v85
v_mfma_f32_16x16x32_bf16 v[216:219], a[240:243], a[4:7], v[216:219]
ds_read_b64_tr_b16 v[124:125], v23 offset:12288
ds_read_b64_tr_b16 v[126:127], v23 offset:12800
v_mfma_f32_16x16x32_bf16 v[216:219], a[244:247], a[8:11], v[216:219]
buffer_store_dwordx4 v[160:163], v42, s[32:35], s42 offen sc0 sc1
v_rcp_f32 v86, v86
v_cvt_pk_bf16_f32 v172, v96, v97
v_mfma_f32_16x16x32_bf16 v[216:219], a[248:251], a[12:15], v[216:219]
ds_read_b64_tr_b16 v[120:121], v24 offset:12288
ds_read_b64_tr_b16 v[122:123], v24 offset:12800
v_mfma_f32_16x16x32_bf16 v[212:215], a[248:251], a[8:11], v[212:215]
v_rcp_f32 v87, v87
v_mfma_f32_16x16x32_bf16 v[212:215], a[244:247], a[4:7], v[212:215]
v_rcp_f32 v88, v88
v_mfma_f32_16x16x32_bf16 v[212:215], a[240:243], a[0:3], v[212:215]
ds_read_b64_tr_b16 v[128:129], v22 offset:12288
ds_read_b64_tr_b16 v[130:131], v22 offset:12800
v_mfma_f32_16x16x32_bf16 v[208:211], a[244:247], a[0:3], v[208:211]
v_rcp_f32 v89, v89
v_mfma_f32_16x16x32_bf16 v[208:211], a[248:251], a[4:7], v[208:211]
v_exp_f32 v91, v183
s_waitcnt lgkmcnt(6)
v_mfma_f32_16x16x32_bf16 v[240:243], v[100:103], a[0:3], v[240:243]
ds_read_b64_tr_b16 v[140:141], v22 offset:0
ds_read_b64_tr_b16 v[142:143], v22 offset:512
v_mfma_f32_16x16x32_bf16 v[240:243], v[104:107], a[4:7], v[240:243]
v_exp_f32 v92, v188
v_mfma_f32_16x16x32_bf16 v[244:247], v[104:107], a[8:11], v[244:247]
v_exp_f32 v93, v189
v_mfma_f32_16x16x32_bf16 v[244:247], v[100:103], a[4:7], v[244:247]
ds_read_b64_tr_b16 a[228:229], v22 offset:36864
ds_read_b64_tr_b16 a[230:231], v22 offset:37376
v_exp_f32 v94, v190
v_cvt_pk_bf16_f32 v173, v98, v99
v_pk_mul_f32 v[84:85], v[176:177], v[84:85]
v_pk_mul_f32 v[86:87], v[178:179], v[86:87]
v_pk_mul_f32 v[88:89], v[180:181], v[88:89]
v_pk_fma_f32 v[90:91], v[90:91], s[50:51], s[50:51]
v_pk_fma_f32 v[92:93], v[92:93], s[50:51], s[50:51]
v_pk_fma_f32 v[184:185], v[184:185], v[52:53], v[56:57]
v_pk_fma_f32 v[186:187], v[186:187], v[54:55], v[58:59]
v_pk_fma_f32 v[192:193], v[192:193], v[52:53], v[56:57]
v_mfma_f32_16x16x32_bf16 v[244:247], a[252:255], a[0:3], v[244:247]
v_permlane16_swap_b32 v172, v174
v_mfma_f32_16x16x32_bf16 v[248:251], a[252:255], a[4:7], v[248:251]
v_permlane16_swap_b32 v173, v175
v_mfma_f32_16x16x32_bf16 v[248:251], v[100:103], a[8:11], v[248:251]
ds_read_b64_tr_b16 a[216:217], v22 offset:24576
ds_read_b64_tr_b16 a[218:219], v22 offset:25088
v_mfma_f32_16x16x32_bf16 v[248:251], v[104:107], a[12:15], v[248:251]
buffer_store_dwordx4 v[172:175], v42, s[32:35], s43 offen sc0 sc1
v_cvt_pk_bf16_f32 v176, v84, v85
v_rcp_f32 v90, v90
v_mfma_f32_16x16x32_bf16 v[252:255], v[104:107], a[16:19], v[252:255]
v_rcp_f32 v91, v91
v_mfma_f32_16x16x32_bf16 v[252:255], v[100:103], a[12:15], v[252:255]
ds_read_b64_tr_b16 v[116:117], v28 offset:49152
ds_read_b64_tr_b16 v[118:119], v28 offset:49664
v_mfma_f32_16x16x32_bf16 v[252:255], a[252:255], a[8:11], v[252:255]
v_rcp_f32 v92, v92
v_mfma_f32_16x16x32_bf16 v[208:211], v[112:115], a[36:39], v[208:211]
v_rcp_f32 v93, v93
v_mfma_f32_16x16x32_bf16 v[208:211], v[108:111], a[40:43], v[208:211]
v_exp_f32 v95, v191
v_mfma_f32_16x16x32_bf16 v[208:211], a[220:223], a[72:75], v[208:211]
v_exp_f32 v96, v184
v_mfma_f32_16x16x32_bf16 v[208:211], a[224:227], a[76:79], v[208:211]
v_exp_f32 v97, v185
v_mfma_f32_16x16x32_bf16 v[208:211], a[232:235], a[108:111], v[208:211]
v_exp_f32 v98, v186
v_mfma_f32_16x16x32_bf16 v[208:211], a[236:239], a[112:115], v[208:211]
v_exp_f32 v99, v187
v_mfma_f32_16x16x32_bf16 v[208:211], v[136:139], a[144:147], v[208:211]
v_exp_f32 v84, v192
v_exp_f32 v85, v193
v_cvt_pk_bf16_f32 v177, v86, v87
v_pk_mul_f32 v[90:91], v[182:183], v[90:91]
v_pk_mul_f32 v[92:93], v[188:189], v[92:93]
v_pk_fma_f32 v[94:95], v[94:95], s[50:51], s[50:51]
v_pk_fma_f32 v[96:97], v[96:97], s[50:51], s[50:51]
v_pk_fma_f32 v[98:99], v[98:99], s[50:51], s[50:51]
v_pk_fma_f32 v[194:195], v[194:195], v[54:55], v[58:59]
v_pk_fma_f32 v[196:197], v[196:197], v[60:61], v[64:65]
v_mfma_f32_16x16x32_bf16 v[208:211], v[132:135], a[148:151], v[208:211]
v_rcp_f32 v94, v94
s_waitcnt lgkmcnt(0)
v_mfma_f32_16x16x32_bf16 v[208:211], v[124:127], a[180:183], v[208:211]
v_rcp_f32 v95, v95
v_mfma_f32_16x16x32_bf16 v[208:211], v[120:123], a[184:187], v[208:211]
v_rcp_f32 v96, v96
v_mfma_f32_16x16x32_bf16 v[212:215], v[120:123], a[188:191], v[212:215]
v_rcp_f32 v97, v97
v_mfma_f32_16x16x32_bf16 v[212:215], v[124:127], a[184:187], v[212:215]
v_rcp_f32 v98, v98
v_mfma_f32_16x16x32_bf16 v[212:215], v[128:131], a[180:183], v[212:215]
v_rcp_f32 v99, v99
v_mfma_f32_16x16x32_bf16 v[212:215], v[132:135], a[152:155], v[212:215]
v_exp_f32 v86, v194
v_exp_f32 v87, v195
v_cvt_pk_bf16_f32 v178, v88, v89
v_pk_mul_f32 v[94:95], v[190:191], v[94:95]
v_pk_mul_f32 v[96:97], v[184:185], v[96:97]
v_pk_mul_f32 v[98:99], v[186:187], v[98:99]
v_pk_fma_f32 v[84:85], v[84:85], s[50:51], s[50:51]
v_pk_fma_f32 v[198:199], v[198:199], v[62:63], v[66:67]
v_mfma_f32_16x16x32_bf16 v[212:215], v[136:139], a[148:151], v[212:215]
v_cvt_pk_bf16_f32 v179, v90, v91
v_cvt_pk_bf16_f32 v190, v92, v93
v_mfma_f32_16x16x32_bf16 v[212:215], v[140:143], a[144:147], v[212:215]
v_permlane16_swap_b32 v176, v178
v_mfma_f32_16x16x32_bf16 v[212:215], a[236:239], a[116:119], v[212:215]
v_permlane16_swap_b32 v177, v179
v_mfma_f32_16x16x32_bf16 v[212:215], a[232:235], a[112:115], v[212:215]
buffer_store_dwordx4 v[176:179], v42, s[32:35], s44 offen sc0 sc1
v_cvt_pk_bf16_f32 v191, v94, v95
v_rcp_f32 v84, v84
v_mfma_f32_16x16x32_bf16 v[212:215], a[228:231], a[108:111], v[212:215]
v_rcp_f32 v85, v85
v_mfma_f32_16x16x32_bf16 v[212:215], a[224:227], a[80:83], v[212:215]
v_exp_f32 v88, v196
v_mfma_f32_16x16x32_bf16 v[212:215], a[220:223], a[76:79], v[212:215]
v_exp_f32 v89, v197
v_exp_f32 v90, v198
v_cvt_pk_bf16_f32 v188, v96, v97
v_pk_mul_f32 v[84:85], v[192:193], v[84:85]
v_pk_fma_f32 v[86:87], v[86:87], s[50:51], s[50:51]
v_pk_fma_f32 v[204:205], v[204:205], v[60:61], v[64:65]
v_pk_fma_f32 v[206:207], v[206:207], v[62:63], v[66:67]
v_pk_fma_f32 v[200:201], v[200:201], v[52:53], v[56:57]
v_pk_fma_f32 v[202:203], v[202:203], v[54:55], v[58:59]
v_mfma_f32_16x16x32_bf16 v[212:215], a[216:219], a[72:75], v[212:215]
v_rcp_f32 v86, v86
v_mfma_f32_16x16x32_bf16 v[212:215], v[108:111], a[44:47], v[212:215]
v_rcp_f32 v87, v87
v_mfma_f32_16x16x32_bf16 v[212:215], v[112:115], a[40:43], v[212:215]
v_exp_f32 v91, v199
v_mfma_f32_16x16x32_bf16 v[212:215], v[116:119], a[36:39], v[212:215]
v_exp_f32 v92, v204
v_mfma_f32_16x16x32_bf16 v[216:219], v[116:119], a[40:43], v[216:219]
v_exp_f32 v93, v205
v_mfma_f32_16x16x32_bf16 v[216:219], v[112:115], a[44:47], v[216:219]
v_exp_f32 v94, v206
v_mfma_f32_16x16x32_bf16 v[216:219], v[108:111], a[48:51], v[216:219]
v_exp_f32 v95, v207
v_mfma_f32_16x16x32_bf16 v[216:219], a[216:219], a[76:79], v[216:219]
v_exp_f32 v96, v200
v_exp_f32 v97, v201
v_cvt_pk_bf16_f32 v189, v98, v99
v_pk_mul_f32 v[86:87], v[194:195], v[86:87]
v_pk_fma_f32 v[88:89], v[88:89], s[50:51], s[50:51]
v_pk_fma_f32 v[90:91], v[90:91], s[50:51], s[50:51]
v_pk_fma_f32 v[92:93], v[92:93], s[50:51], s[50:51]
v_pk_fma_f32 v[94:95], v[94:95], s[50:51], s[50:51]
v_pk_fma_f32 v[208:209], v[208:209], v[68:69], v[72:73]
v_mfma_f32_16x16x32_bf16 v[216:219], a[220:223], a[80:83], v[216:219]
v_permlane16_swap_b32 v188, v190
v_mfma_f32_16x16x32_bf16 v[216:219], a[224:227], a[84:87], v[216:219]
v_permlane16_swap_b32 v189, v191
v_mfma_f32_16x16x32_bf16 v[216:219], a[228:231], a[112:115], v[216:219]
buffer_store_dwordx4 v[188:191], v42, s[32:35], s45 offen sc0 sc1
v_rcp_f32 v88, v88
v_cvt_pk_bf16_f32 v192, v84, v85
v_mfma_f32_16x16x32_bf16 v[216:219], a[232:235], a[116:119], v[216:219]
v_rcp_f32 v89, v89
v_mfma_f32_16x16x32_bf16 v[216:219], a[236:239], a[120:123], v[216:219]
v_rcp_f32 v90, v90
v_mfma_f32_16x16x32_bf16 v[216:219], v[140:143], a[148:151], v[216:219]
v_rcp_f32 v91, v91
v_mfma_f32_16x16x32_bf16 v[216:219], v[136:139], a[152:155], v[216:219]
v_rcp_f32 v92, v92
v_mfma_f32_16x16x32_bf16 v[216:219], v[132:135], a[156:159], v[216:219]
v_rcp_f32 v93, v93
v_mfma_f32_16x16x32_bf16 v[216:219], v[128:131], a[184:187], v[216:219]
v_rcp_f32 v94, v94
v_mfma_f32_16x16x32_bf16 v[216:219], v[124:127], a[188:191], v[216:219]
v_rcp_f32 v95, v95
v_mfma_f32_16x16x32_bf16 v[216:219], v[120:123], a[192:195], v[216:219]
v_exp_f32 v98, v202
v_mfma_f32_16x16x32_bf16 v[220:223], v[120:123], a[196:199], v[220:223]
v_exp_f32 v99, v203
v_mfma_f32_16x16x32_bf16 v[220:223], v[124:127], a[192:195], v[220:223]
v_exp_f32 v84, v208
v_exp_f32 v85, v209
v_cvt_pk_bf16_f32 v193, v86, v87
v_pk_mul_f32 v[88:89], v[196:197], v[88:89]
v_pk_mul_f32 v[90:91], v[198:199], v[90:91]
v_pk_mul_f32 v[92:93], v[204:205], v[92:93]
v_pk_mul_f32 v[94:95], v[206:207], v[94:95]
v_pk_fma_f32 v[96:97], v[96:97], s[50:51], s[50:51]
v_pk_fma_f32 v[98:99], v[98:99], s[50:51], s[50:51]
v_pk_fma_f32 v[210:211], v[210:211], v[70:71], v[74:75]
v_pk_fma_f32 v[212:213], v[212:213], v[68:69], v[72:73]
v_mfma_f32_16x16x32_bf16 v[220:223], v[128:131], a[188:191], v[220:223]
v_cvt_pk_bf16_f32 v194, v88, v89
v_cvt_pk_bf16_f32 v195, v90, v91
v_mfma_f32_16x16x32_bf16 v[220:223], v[132:135], a[160:163], v[220:223]
v_permlane16_swap_b32 v192, v194
v_mfma_f32_16x16x32_bf16 v[220:223], v[136:139], a[156:159], v[220:223]
v_permlane16_swap_b32 v193, v195
v_mfma_f32_16x16x32_bf16 v[220:223], v[140:143], a[152:155], v[220:223]
buffer_store_dwordx4 v[192:195], v42, s[32:35], s46 offen sc0 sc1
v_rcp_f32 v96, v96
v_cvt_pk_bf16_f32 v206, v92, v93
v_mfma_f32_16x16x32_bf16 v[220:223], a[236:239], a[124:127], v[220:223]
v_rcp_f32 v97, v97
v_mfma_f32_16x16x32_bf16 v[220:223], a[232:235], a[120:123], v[220:223]
v_rcp_f32 v98, v98
v_mfma_f32_16x16x32_bf16 v[220:223], a[228:231], a[116:119], v[220:223]
v_rcp_f32 v99, v99
v_mfma_f32_16x16x32_bf16 v[220:223], a[224:227], a[88:91], v[220:223]
v_exp_f32 v86, v210
v_mfma_f32_16x16x32_bf16 v[220:223], a[220:223], a[84:87], v[220:223]
v_exp_f32 v87, v211
v_mfma_f32_16x16x32_bf16 v[220:223], a[216:219], a[80:83], v[220:223]
v_exp_f32 v88, v212
v_exp_f32 v89, v213
v_cvt_pk_bf16_f32 v207, v94, v95
v_pk_mul_f32 v[96:97], v[200:201], v[96:97]
v_pk_mul_f32 v[98:99], v[202:203], v[98:99]
v_pk_fma_f32 v[84:85], v[84:85], s[50:51], s[50:51]
v_pk_fma_f32 v[86:87], v[86:87], s[50:51], s[50:51]
v_pk_fma_f32 v[214:215], v[214:215], v[70:71], v[74:75]
v_pk_fma_f32 v[216:217], v[216:217], v[68:69], v[72:73]
v_pk_fma_f32 v[218:219], v[218:219], v[70:71], v[74:75]
v_mfma_f32_16x16x32_bf16 v[220:223], v[108:111], a[52:55], v[220:223]
v_rcp_f32 v84, v84
v_mfma_f32_16x16x32_bf16 v[220:223], v[112:115], a[48:51], v[220:223]
v_rcp_f32 v85, v85
v_mfma_f32_16x16x32_bf16 v[220:223], v[116:119], a[44:47], v[220:223]
v_rcp_f32 v86, v86
v_mfma_f32_16x16x32_bf16 v[224:227], v[116:119], a[48:51], v[224:227]
v_rcp_f32 v87, v87
v_mfma_f32_16x16x32_bf16 v[224:227], v[112:115], a[52:55], v[224:227]
v_exp_f32 v90, v214
v_mfma_f32_16x16x32_bf16 v[224:227], v[108:111], a[56:59], v[224:227]
v_exp_f32 v91, v215
v_mfma_f32_16x16x32_bf16 v[224:227], a[216:219], a[84:87], v[224:227]
v_exp_f32 v92, v216
v_mfma_f32_16x16x32_bf16 v[224:227], a[220:223], a[88:91], v[224:227]
v_exp_f32 v93, v217
v_mfma_f32_16x16x32_bf16 v[224:227], a[224:227], a[92:95], v[224:227]
v_exp_f32 v94, v218
v_exp_f32 v95, v219
v_cvt_pk_bf16_f32 v204, v96, v97
v_pk_mul_f32 v[84:85], v[208:209], v[84:85]
v_pk_mul_f32 v[86:87], v[210:211], v[86:87]
v_pk_fma_f32 v[88:89], v[88:89], s[50:51], s[50:51]
v_pk_fma_f32 v[90:91], v[90:91], s[50:51], s[50:51]
v_pk_fma_f32 v[92:93], v[92:93], s[50:51], s[50:51]
v_pk_fma_f32 v[220:221], v[220:221], v[68:69], v[72:73]
v_pk_fma_f32 v[222:223], v[222:223], v[70:71], v[74:75]
v_mfma_f32_16x16x32_bf16 v[224:227], a[228:231], a[120:123], v[224:227]
v_cvt_pk_bf16_f32 v205, v98, v99
v_cvt_pk_bf16_f32 v208, v84, v85
v_mfma_f32_16x16x32_bf16 v[224:227], a[232:235], a[124:127], v[224:227]
v_permlane16_swap_b32 v204, v206
v_mfma_f32_16x16x32_bf16 v[224:227], a[236:239], a[128:131], v[224:227]
v_permlane16_swap_b32 v205, v207
v_mfma_f32_16x16x32_bf16 v[224:227], v[140:143], a[156:159], v[224:227]
buffer_store_dwordx4 v[204:207], v42, s[32:35], s47 offen sc0 sc1
v_rcp_f32 v88, v88
v_cvt_pk_bf16_f32 v209, v86, v87
v_mfma_f32_16x16x32_bf16 v[224:227], v[136:139], a[160:163], v[224:227]
ds_write_b64 v45, v[208:209] offset:0
v_mfma_f32_16x16x32_bf16 v[224:227], v[132:135], a[164:167], v[224:227]
v_rcp_f32 v89, v89
v_mfma_f32_16x16x32_bf16 v[224:227], v[128:131], a[192:195], v[224:227]
v_rcp_f32 v90, v90
v_mfma_f32_16x16x32_bf16 v[224:227], v[124:127], a[196:199], v[224:227]
v_rcp_f32 v91, v91
v_mfma_f32_16x16x32_bf16 v[224:227], v[120:123], a[200:203], v[224:227]
v_rcp_f32 v92, v92
v_mfma_f32_16x16x32_bf16 v[228:231], v[120:123], a[204:207], v[228:231]
v_rcp_f32 v93, v93
v_mfma_f32_16x16x32_bf16 v[228:231], v[124:127], a[200:203], v[228:231]
v_exp_f32 v96, v220
v_mfma_f32_16x16x32_bf16 v[228:231], v[128:131], a[196:199], v[228:231]
v_exp_f32 v97, v221
v_mfma_f32_16x16x32_bf16 v[228:231], v[132:135], a[168:171], v[228:231]
v_exp_f32 v98, v222
v_exp_f32 v99, v223
v_pk_mul_f32 v[88:89], v[212:213], v[88:89]
v_pk_mul_f32 v[90:91], v[214:215], v[90:91]
v_pk_mul_f32 v[92:93], v[216:217], v[92:93]
v_pk_fma_f32 v[94:95], v[94:95], s[50:51], s[50:51]
v_pk_fma_f32 v[96:97], v[96:97], s[50:51], s[50:51]
v_pk_fma_f32 v[224:225], v[224:225], v[68:69], v[72:73]
v_pk_fma_f32 v[226:227], v[226:227], v[70:71], v[74:75]
v_mfma_f32_16x16x32_bf16 v[228:231], v[136:139], a[164:167], v[228:231]
v_cvt_pk_bf16_f32 v212, v88, v89
v_cvt_pk_bf16_f32 v213, v90, v91
v_mfma_f32_16x16x32_bf16 v[228:231], v[140:143], a[160:163], v[228:231]
ds_write_b64 v45, v[212:213] offset:1024
v_mfma_f32_16x16x32_bf16 v[228:231], a[236:239], a[132:135], v[228:231]
v_rcp_f32 v94, v94
v_mfma_f32_16x16x32_bf16 v[228:231], a[232:235], a[128:131], v[228:231]
v_rcp_f32 v95, v95
v_mfma_f32_16x16x32_bf16 v[228:231], a[228:231], a[124:127], v[228:231]
v_rcp_f32 v96, v96
v_mfma_f32_16x16x32_bf16 v[228:231], a[224:227], a[96:99], v[228:231]
v_rcp_f32 v97, v97
v_mfma_f32_16x16x32_bf16 v[228:231], a[220:223], a[92:95], v[228:231]
ds_read_b64_tr_b16 a[28:29], v32 offset:49152
ds_read_b64_tr_b16 a[30:31], v32 offset:49664
v_mfma_f32_16x16x32_bf16 v[228:231], a[216:219], a[88:91], v[228:231]
v_exp_f32 v84, v224
v_mfma_f32_16x16x32_bf16 v[228:231], v[108:111], a[60:63], v[228:231]
ds_read_b64_tr_b16 a[24:25], v33 offset:49152
ds_read_b64_tr_b16 a[26:27], v33 offset:49664
v_mfma_f32_16x16x32_bf16 v[228:231], v[112:115], a[56:59], v[228:231]
v_exp_f32 v85, v225
v_mfma_f32_16x16x32_bf16 v[228:231], v[116:119], a[52:55], v[228:231]
ds_read_b64_tr_b16 a[240:241], v26 offset:24576
ds_read_b64_tr_b16 a[242:243], v26 offset:25088
v_mfma_f32_16x16x32_bf16 v[232:235], v[116:119], a[56:59], v[232:235]
v_exp_f32 v86, v226
v_mfma_f32_16x16x32_bf16 v[232:235], v[112:115], a[60:63], v[232:235]
ds_read_b64_tr_b16 a[244:245], v27 offset:24576
ds_read_b64_tr_b16 a[246:247], v27 offset:25088
v_mfma_f32_16x16x32_bf16 v[232:235], v[108:111], a[64:67], v[232:235]
v_exp_f32 v87, v227
v_mfma_f32_16x16x32_bf16 v[232:235], a[216:219], a[92:95], v[232:235]
ds_read_b64_tr_b16 a[0:1], v26 offset:36864
ds_read_b64_tr_b16 a[2:3], v26 offset:37376
v_mfma_f32_16x16x32_bf16 v[232:235], a[220:223], a[96:99], v[232:235]
v_cvt_pk_bf16_f32 v216, v92, v93
v_fma_f32 v98, v98, s50, s50
v_mfma_f32_16x16x32_bf16 v[232:235], a[224:227], a[100:103], v[232:235]
ds_read_b64_tr_b16 a[4:5], v27 offset:36864
ds_read_b64_tr_b16 a[6:7], v27 offset:37376
v_mfma_f32_16x16x32_bf16 v[232:235], a[228:231], a[128:131], v[232:235]
v_fma_f32 v99, v99, s50, s50
v_fma_f32 v84, v84, s50, s50
v_mfma_f32_16x16x32_bf16 v[232:235], a[232:235], a[132:135], v[232:235]
ds_read_b64_tr_b16 v[104:105], v26 offset:0
ds_read_b64_tr_b16 v[106:107], v26 offset:512
v_rcp_f32 v98, v98
v_rcp_f32 v99, v99
v_pk_mul_f32 v[94:95], v[218:219], v[94:95]
v_pk_mul_f32 v[96:97], v[220:221], v[96:97]
v_fma_f32 v85, v85, s50, s50
v_pk_fma_f32 v[86:87], v[86:87], s[50:51], s[50:51]
v_pk_fma_f32 v[228:229], v[228:229], v[68:69], v[72:73]
v_pk_fma_f32 v[230:231], v[230:231], v[70:71], v[74:75]
v_mfma_f32_16x16x32_bf16 v[232:235], a[236:239], a[136:139], v[232:235]
v_rcp_f32 v84, v84
v_mfma_f32_16x16x32_bf16 v[232:235], v[140:143], a[164:167], v[232:235]
ds_read_b64_tr_b16 a[12:13], v27 offset:0
ds_read_b64_tr_b16 a[14:15], v27 offset:512
v_mfma_f32_16x16x32_bf16 v[232:235], v[136:139], a[168:171], v[232:235]
v_rcp_f32 v85, v85
v_mfma_f32_16x16x32_bf16 v[232:235], v[132:135], a[172:175], v[232:235]
ds_read_b64_tr_b16 a[8:9], v26 offset:12288
ds_read_b64_tr_b16 a[10:11], v26 offset:12800
v_mfma_f32_16x16x32_bf16 v[232:235], v[128:131], a[200:203], v[232:235]
v_rcp_f32 v86, v86
v_mfma_f32_16x16x32_bf16 v[232:235], v[124:127], a[204:207], v[232:235]
ds_read_b64_tr_b16 a[252:253], v27 offset:12288
ds_read_b64_tr_b16 a[254:255], v27 offset:12800
v_mfma_f32_16x16x32_bf16 v[232:235], v[120:123], a[208:211], v[232:235]
v_rcp_f32 v87, v87
v_mfma_f32_16x16x32_bf16 v[236:239], v[120:123], a[212:215], v[236:239]
v_exp_f32 v88, v228
v_mfma_f32_16x16x32_bf16 v[236:239], v[124:127], a[208:211], v[236:239]
ds_read_b64_tr_b16 v[100:101], v25 offset:12288
ds_read_b64_tr_b16 v[102:103], v25 offset:12800
v_mfma_f32_16x16x32_bf16 v[236:239], v[128:131], a[204:207], v[236:239]
L_pad0_4:
s_cbranch_execz L_body0
v_exp_f32 v89, v229
v_mfma_f32_16x16x32_bf16 v[236:239], v[132:135], a[176:179], v[236:239]
v_exp_f32 v90, v230
v_exp_f32 v91, v231
v_cvt_pk_bf16_f32 v217, v94, v95
v_pk_mul_f32 v[98:99], v[222:223], v[98:99]
v_pk_mul_f32 v[84:85], v[224:225], v[84:85]
v_pk_mul_f32 v[86:87], v[226:227], v[86:87]
v_pk_fma_f32 v[88:89], v[88:89], s[50:51], s[50:51]
v_pk_fma_f32 v[232:233], v[232:233], v[68:69], v[72:73]
v_pk_fma_f32 v[234:235], v[234:235], v[70:71], v[74:75]
v_mfma_f32_16x16x32_bf16 v[236:239], v[136:139], a[172:175], v[236:239]
ds_read_b64_tr_b16 a[16:17], v25 offset:0
ds_read_b64_tr_b16 a[18:19], v25 offset:512
v_mfma_f32_16x16x32_bf16 v[236:239], v[140:143], a[168:171], v[236:239]
ds_write_b64 v45, v[216:217] offset:2048
v_mfma_f32_16x16x32_bf16 v[236:239], a[236:239], a[140:143], v[236:239]
v_cvt_pk_bf16_f32 v220, v96, v97
v_cvt_pk_bf16_f32 v221, v98, v99
v_mfma_f32_16x16x32_bf16 v[236:239], a[232:235], a[136:139], v[236:239]
ds_read_b64_tr_b16 a[248:249], v25 offset:36864
ds_read_b64_tr_b16 a[250:251], v25 offset:37376
v_mfma_f32_16x16x32_bf16 v[236:239], a[228:231], a[132:135], v[236:239]
ds_write_b64 v45, v[220:221] offset:3072
v_mfma_f32_16x16x32_bf16 v[236:239], a[224:227], a[104:107], v[236:239]
v_rcp_f32 v88, v88
v_mfma_f32_16x16x32_bf16 v[236:239], a[220:223], a[100:103], v[236:239]
ds_read_b64_tr_b16 a[20:21], v25 offset:24576
ds_read_b64_tr_b16 a[22:23], v25 offset:25088
v_mfma_f32_16x16x32_bf16 v[236:239], a[216:219], a[96:99], v[236:239]
v_rcp_f32 v89, v89
v_mfma_f32_16x16x32_bf16 v[236:239], v[108:111], a[68:71], v[236:239]
v_exp_f32 v92, v232
v_mfma_f32_16x16x32_bf16 v[236:239], v[112:115], a[64:67], v[236:239]
ds_read_b64_tr_b16 a[32:33], v31 offset:49152
ds_read_b64_tr_b16 a[34:35], v31 offset:49664
v_mfma_f32_16x16x32_bf16 v[236:239], v[116:119], a[60:63], v[236:239]
v_exp_f32 v93, v233
s_waitcnt lgkmcnt(7)
v_mfma_f32_16x16x32_bf16 v[240:243], a[28:31], a[36:39], v[240:243]
s_waitcnt lgkmcnt(4)
s_barrier
ds_read_b128 v[208:211], v46 offset:0
v_exp_f32 v94, v234
v_exp_f32 v95, v235
v_pk_mul_f32 v[88:89], v[228:229], v[88:89]
v_pk_fma_f32 v[90:91], v[90:91], s[50:51], s[50:51]
v_pk_fma_f32 v[92:93], v[92:93], s[50:51], s[50:51]
v_mfma_f32_16x16x32_bf16 v[240:243], a[24:27], a[40:43], v[240:243]
ds_read_b128 v[216:219], v46 offset:2048
v_cvt_pk_bf16_f32 v224, v84, v85
v_mfma_f32_16x16x32_bf16 v[240:243], a[240:243], a[72:75], v[240:243]
v_rcp_f32 v90, v90
v_mfma_f32_16x16x32_bf16 v[240:243], a[244:247], a[76:79], v[240:243]
v_rcp_f32 v91, v91
v_rcp_f32 v92, v92
v_cvt_pk_bf16_f32 v225, v86, v87
v_pk_fma_f32 v[94:95], v[94:95], s[50:51], s[50:51]
v_pk_fma_f32 v[236:237], v[236:237], v[68:69], v[72:73]
v_pk_fma_f32 v[238:239], v[238:239], v[70:71], v[74:75]
v_mfma_f32_16x16x32_bf16 v[240:243], a[0:3], a[108:111], v[240:243]
ds_write_b64 v45, v[224:225] offset:4096
v_mfma_f32_16x16x32_bf16 v[240:243], a[4:7], a[112:115], v[240:243]
v_rcp_f32 v93, v93
v_mfma_f32_16x16x32_bf16 v[240:243], v[104:107], a[144:147], v[240:243]
v_rcp_f32 v94, v94
v_mfma_f32_16x16x32_bf16 v[240:243], a[12:15], a[148:151], v[240:243]
v_rcp_f32 v95, v95
v_mfma_f32_16x16x32_bf16 v[240:243], a[8:11], a[180:183], v[240:243]
v_exp_f32 v96, v236
v_mfma_f32_16x16x32_bf16 v[240:243], a[252:255], a[184:187], v[240:243]
s_waitcnt lgkmcnt(2)
buffer_store_dwordx4 v[208:211], v43, s[32:35], s56 offen sc0 sc1
v_exp_f32 v97, v237
v_cvt_pk_bf16_f32 v228, v88, v89
v_mfma_f32_16x16x32_bf16 v[244:247], a[252:255], a[188:191], v[244:247]
v_exp_f32 v98, v238
v_exp_f32 v99, v239
v_pk_mul_f32 v[90:91], v[230:231], v[90:91]
v_pk_mul_f32 v[92:93], v[232:233], v[92:93]
v_pk_mul_f32 v[94:95], v[234:235], v[94:95]
v_pk_fma_f32 v[96:97], v[96:97], s[50:51], s[50:51]
v_mfma_f32_16x16x32_bf16 v[244:247], a[8:11], a[184:187], v[244:247]
v_cvt_pk_bf16_f32 v229, v90, v91
v_cvt_pk_bf16_f32 v232, v92, v93
v_mfma_f32_16x16x32_bf16 v[244:247], v[100:103], a[180:183], v[244:247]
ds_write_b64 v45, v[228:229] offset:5120
v_rcp_f32 v96, v96
v_pk_fma_f32 v[98:99], v[98:99], s[50:51], s[50:51]
v_pk_fma_f32 v[240:241], v[240:241], v[76:77], v[80:81]
v_pk_fma_f32 v[242:243], v[242:243], v[78:79], v[82:83]
v_mfma_f32_16x16x32_bf16 v[244:247], a[12:15], a[152:155], v[244:247]
v_rcp_f32 v97, v97
v_mfma_f32_16x16x32_bf16 v[244:247], v[104:107], a[148:151], v[244:247]
v_rcp_f32 v98, v98
v_mfma_f32_16x16x32_bf16 v[244:247], a[16:19], a[144:147], v[244:247]
v_rcp_f32 v99, v99
v_mfma_f32_16x16x32_bf16 v[244:247], a[4:7], a[116:119], v[244:247]
v_exp_f32 v84, v240
v_mfma_f32_16x16x32_bf16 v[244:247], a[0:3], a[112:115], v[244:247]
v_exp_f32 v85, v241
v_mfma_f32_16x16x32_bf16 v[244:247], a[248:251], a[108:111], v[244:247]
v_exp_f32 v86, v242
v_exp_f32 v87, v243
v_cvt_pk_bf16_f32 v233, v94, v95
v_pk_mul_f32 v[96:97], v[236:237], v[96:97]
v_pk_mul_f32 v[98:99], v[238:239], v[98:99]
v_pk_fma_f32 v[84:85], v[84:85], s[50:51], s[50:51]
v_mfma_f32_16x16x32_bf16 v[244:247], a[244:247], a[80:83], v[244:247]
ds_write_b64 v45, v[232:233] offset:6144
v_mfma_f32_16x16x32_bf16 v[244:247], a[240:243], a[76:79], v[244:247]
v_rcp_f32 v84, v84
v_mfma_f32_16x16x32_bf16 v[244:247], a[20:23], a[72:75], v[244:247]
v_rcp_f32 v85, v85
v_mfma_f32_16x16x32_bf16 v[244:247], a[24:27], a[44:47], v[244:247]
v_cvt_pk_bf16_f32 v236, v96, v97
v_cvt_pk_bf16_f32 v237, v98, v99
v_mfma_f32_16x16x32_bf16 v[244:247], a[28:31], a[40:43], v[244:247]
s_waitcnt lgkmcnt(1)
buffer_store_dwordx4 v[216:219], v43, s[32:35], s57 offen sc0 sc1
v_fma_f32 v86, v86, s50, s50
v_fma_f32 v87, v87, s50, s50
v_mul_f32 v84, v240, v84
v_mfma_f32_16x16x32_bf16 v[244:247], a[32:35], a[36:39], v[244:247]
ds_write_b64 v45, v[236:237] offset:7168
v_mfma_f32_16x16x32_bf16 v[248:251], a[32:35], a[40:43], v[248:251]
v_rcp_f32 v86, v86
v_mfma_f32_16x16x32_bf16 v[248:251], a[28:31], a[44:47], v[248:251]
v_rcp_f32 v87, v87
v_mfma_f32_16x16x32_bf16 v[248:251], a[24:27], a[48:51], v[248:251]
v_mul_f32 v85, v241, v85
s_nop 0
v_fma_f32 v244, v244, v76, v80
v_mfma_f32_16x16x32_bf16 v[248:251], a[20:23], a[76:79], v[248:251]
v_cvt_pk_bf16_f32 v240, v84, v85
v_fma_f32 v245, v245, v77, v81
v_mfma_f32_16x16x32_bf16 v[248:251], a[240:243], a[80:83], v[248:251]
v_exp_f32 v88, v244
v_exp_f32 v89, v245
v_pk_mul_f32 v[86:87], v[242:243], v[86:87]
v_pk_fma_f32 v[246:247], v[246:247], v[78:79], v[82:83]
v_mfma_f32_16x16x32_bf16 v[248:251], a[244:247], a[84:87], v[248:251]
v_exp_f32 v90, v246
v_mfma_f32_16x16x32_bf16 v[248:251], a[248:251], a[112:115], v[248:251]
s_waitcnt lgkmcnt(0)
s_barrier
ds_read_b128 v[224:227], v46 offset:4096
v_cvt_pk_bf16_f32 v241, v86, v87
v_mfma_f32_16x16x32_bf16 v[248:251], a[0:3], a[116:119], v[248:251]
ds_read_b128 v[232:235], v46 offset:6144
v_fma_f32 v88, v88, s50, s50
v_mfma_f32_16x16x32_bf16 v[248:251], a[4:7], a[120:123], v[248:251]
ds_write_b64 v45, v[240:241] offset:8192
v_mfma_f32_16x16x32_bf16 v[248:251], a[16:19], a[148:151], v[248:251]
v_exp_f32 v91, v247
v_mfma_f32_16x16x32_bf16 v[248:251], v[104:107], a[152:155], v[248:251]
v_fma_f32 v89, v89, s50, s50
v_fma_f32 v90, v90, s50, s50
v_mfma_f32_16x16x32_bf16 v[248:251], a[12:15], a[156:159], v[248:251]
v_rcp_f32 v88, v88
v_mfma_f32_16x16x32_bf16 v[248:251], v[100:103], a[184:187], v[248:251]
v_rcp_f32 v89, v89
v_mfma_f32_16x16x32_bf16 v[248:251], a[8:11], a[188:191], v[248:251]
v_fma_f32 v91, v91, s50, s50
v_mul_f32 v88, v244, v88
v_mfma_f32_16x16x32_bf16 v[248:251], a[252:255], a[192:195], v[248:251]
v_rcp_f32 v90, v90
v_mfma_f32_16x16x32_bf16 v[252:255], a[252:255], a[196:199], v[252:255]
s_waitcnt lgkmcnt(2)
buffer_store_dwordx4 v[224:227], v43, s[32:35], s58 offen sc0 sc1
v_rcp_f32 v91, v91
v_mul_f32 v89, v245, v89
v_mfma_f32_16x16x32_bf16 v[252:255], a[8:11], a[192:195], v[252:255]
v_cvt_pk_bf16_f32 v244, v88, v89
v_mul_f32 v90, v246, v90
v_mfma_f32_16x16x32_bf16 v[252:255], v[100:103], a[188:191], v[252:255]
v_mul_f32 v91, v247, v91
v_fma_f32 v248, v248, v76, v80
v_mfma_f32_16x16x32_bf16 v[252:255], a[12:15], a[160:163], v[252:255]
v_cvt_pk_bf16_f32 v245, v90, v91
v_fma_f32 v249, v249, v77, v81
v_mfma_f32_16x16x32_bf16 v[252:255], v[104:107], a[156:159], v[252:255]
ds_write_b64 v45, v[244:245] offset:9216
v_mfma_f32_16x16x32_bf16 v[252:255], a[16:19], a[152:155], v[252:255]
v_exp_f32 v92, v248
v_mfma_f32_16x16x32_bf16 v[252:255], a[4:7], a[124:127], v[252:255]
v_exp_f32 v93, v249
v_mfma_f32_16x16x32_bf16 v[252:255], a[0:3], a[120:123], v[252:255]
v_fma_f32 v92, v92, s50, s50
v_fma_f32 v93, v93, s50, s50
v_mfma_f32_16x16x32_bf16 v[252:255], a[248:251], a[116:119], v[252:255]
v_rcp_f32 v92, v92
v_mfma_f32_16x16x32_bf16 v[252:255], a[244:247], a[88:91], v[252:255]
v_rcp_f32 v93, v93
v_mfma_f32_16x16x32_bf16 v[252:255], a[240:243], a[84:87], v[252:255]
v_fma_f32 v250, v250, v78, v82
v_fma_f32 v251, v251, v79, v83
v_mfma_f32_16x16x32_bf16 v[252:255], a[20:23], a[80:83], v[252:255]
s_waitcnt lgkmcnt(0)
s_barrier
ds_read_b128 v[240:243], v46 offset:8192
v_mul_f32 v92, v248, v92
v_mfma_f32_16x16x32_bf16 v[252:255], a[24:27], a[52:55], v[252:255]
v_exp_f32 v94, v250
v_mfma_f32_16x16x32_bf16 v[252:255], a[28:31], a[48:51], v[252:255]
v_exp_f32 v95, v251
v_mfma_f32_16x16x32_bf16 v[252:255], a[32:35], a[44:47], v[252:255]
buffer_store_dwordx4 v[232:235], v43, s[32:35], s59 offen sc0 sc1
v_mul_f32 v93, v249, v93
v_pk_fma_f32 v[94:95], v[94:95], s[50:51], s[50:51]
v_rcp_f32 v94, v94
v_rcp_f32 v95, v95
v_cvt_pk_bf16_f32 v248, v92, v93
v_pk_mul_f32 v[94:95], v[250:251], v[94:95]
v_cvt_pk_bf16_f32 v249, v94, v95
v_pk_fma_f32 v[252:253], v[252:253], v[76:77], v[80:81]
v_pk_fma_f32 v[254:255], v[254:255], v[78:79], v[82:83]
ds_write_b64 v45, v[248:249] offset:10240
v_exp_f32 v96, v252
v_exp_f32 v97, v253
v_exp_f32 v98, v254
v_exp_f32 v99, v255
v_pk_fma_f32 v[96:97], v[96:97], s[50:51], s[50:51]
v_pk_fma_f32 v[98:99], v[98:99], s[50:51], s[50:51]
v_rcp_f32 v96, v96
v_rcp_f32 v97, v97
v_rcp_f32 v98, v98
v_rcp_f32 v99, v99
v_pk_mul_f32 v[96:97], v[252:253], v[96:97]
v_pk_mul_f32 v[98:99], v[254:255], v[98:99]
v_cvt_pk_bf16_f32 v252, v96, v97
v_cvt_pk_bf16_f32 v253, v98, v99
ds_write_b64 v45, v[252:253] offset:11264
s_waitcnt lgkmcnt(0)
s_barrier
ds_read_b128 v[248:251], v46 offset:10240
buffer_store_dwordx4 v[240:243], v44, s[32:35], s56 offen sc0 sc1
s_waitcnt lgkmcnt(0)
buffer_store_dwordx4 v[248:251], v44, s[32:35], s57 offen sc0 sc1
s_endpgm
.p2align 12
L_body1:
s_mov_b64 exec, -1
s_addk_i32 m0, 12288
s_nop 0
buffer_load_dwordx4 v13, s[28:31], s53 offen offset:0  lds
buffer_load_dwordx4 v14, s[28:31], s53 offen offset:1024  lds
buffer_load_dwordx4 v15, s[28:31], s53 offen offset:2048  lds
s_addk_i32 s53, 28672
s_addk_i32 m0, 12288
s_nop 0
buffer_load_dwordx4 v10, s[28:31], s53 offen offset:0  lds
buffer_load_dwordx4 v11, s[28:31], s53 offen offset:1024  lds
buffer_load_dwordx4 v12, s[28:31], s53 offen offset:2048  lds
s_addk_i32 m0, 12288
s_nop 0
buffer_load_dwordx4 v13, s[28:31], s53 offen offset:0  lds
buffer_load_dwordx4 v14, s[28:31], s53 offen offset:1024  lds
buffer_load_dwordx4 v15, s[28:31], s53 offen offset:2048  lds
s_waitcnt vmcnt(9)
s_barrier
ds_read_b64_tr_b16 a[220:221], v17 offset:0
ds_read_b64_tr_b16 a[222:223], v17 offset:512
ds_read_b128 a[0:3], v34 offset:32768
ds_read_b64_tr_b16 a[224:225], v18 offset:0
ds_read_b64_tr_b16 a[226:227], v18 offset:512
ds_read_b128 a[4:7], v34 offset:34816
ds_read_b128 a[8:11], v34 offset:36864
ds_read_b64_tr_b16 a[216:217], v16 offset:0
ds_read_b64_tr_b16 a[218:219], v16 offset:512
s_waitcnt lgkmcnt(6)
v_mfma_f32_16x16x32_bf16 v[144:147], a[220:223], a[0:3], 0
ds_read_b128 a[12:15], v34 offset:38912
ds_read_b128 a[16:19], v34 offset:40960
s_waitcnt lgkmcnt(5)
v_mfma_f32_16x16x32_bf16 v[144:147], a[224:227], a[4:7], v[144:147]
ds_read_b128 a[20:23], v34 offset:43008
ds_read_b128 a[24:27], v34 offset:45056
s_waitcnt lgkmcnt(6)
v_mfma_f32_16x16x32_bf16 v[152:155], a[224:227], a[8:11], 0
ds_read_b128 a[28:31], v34 offset:47104
ds_read_b128 a[32:35], v38 offset:32768
v_mfma_f32_16x16x32_bf16 v[152:155], a[220:223], a[4:7], v[152:155]
ds_read_b64_tr_b16 a[228:229], v19 offset:0
ds_read_b64_tr_b16 a[230:231], v19 offset:512
s_waitcnt lgkmcnt(8)
v_mfma_f32_16x16x32_bf16 v[152:155], a[216:219], a[0:3], v[152:155]
ds_read_b64_tr_b16 a[232:233], v20 offset:0
ds_read_b64_tr_b16 a[234:235], v20 offset:512
v_mfma_f32_16x16x32_bf16 v[160:163], a[216:219], a[4:7], 0
ds_read_b64_tr_b16 a[236:237], v21 offset:0
ds_read_b64_tr_b16 a[238:239], v21 offset:512
v_mfma_f32_16x16x32_bf16 v[160:163], a[220:223], a[8:11], v[160:163]
s_waitcnt lgkmcnt(11)
v_mfma_f32_16x16x32_bf16 v[160:163], a[224:227], a[12:15], v[160:163]
s_waitcnt lgkmcnt(10)
v_mfma_f32_16x16x32_bf16 v[168:171], a[224:227], a[16:19], 0
v_mfma_f32_16x16x32_bf16 v[168:171], a[220:223], a[12:15], v[168:171]
v_mfma_f32_16x16x32_bf16 v[168:171], a[216:219], a[8:11], v[168:171]
v_mfma_f32_16x16x32_bf16 v[176:179], a[216:219], a[12:15], 0
v_mfma_f32_16x16x32_bf16 v[176:179], a[220:223], a[16:19], v[176:179]
s_waitcnt lgkmcnt(4)
v_mfma_f32_16x16x32_bf16 v[176:179], a[224:227], a[20:23], v[176:179]
v_mfma_f32_16x16x32_bf16 v[184:187], a[224:227], a[24:27], 0
v_mfma_f32_16x16x32_bf16 v[184:187], a[220:223], a[20:23], v[184:187]
s_mov_b32 s55, 57344
v_mfma_f32_16x16x32_bf16 v[184:187], a[216:219], a[16:19], v[184:187]
buffer_load_dword v3, v50, s[28:31], s55 offen
v_mfma_f32_16x16x32_bf16 v[192:195], a[216:219], a[20:23], 0
v_mfma_f32_16x16x32_bf16 v[192:195], a[220:223], a[24:27], v[192:195]
s_addk_i32 s48, 128
v_mfma_f32_16x16x32_bf16 v[192:195], a[224:227], a[28:31], v[192:195]
s_add_u32 m0, s20, 65536
v_mfma_f32_16x16x32_bf16 v[200:203], a[224:227], a[32:35], 0
buffer_load_dwordx4 v6, s[24:27], s48 offen offset:0 nt lds
v_mfma_f32_16x16x32_bf16 v[200:203], a[220:223], a[28:31], v[200:203]
v_mfma_f32_16x16x32_bf16 v[200:203], a[216:219], a[24:27], v[200:203]
v_mfma_f32_16x16x32_bf16 v[204:207], a[228:231], a[24:27], 0
s_waitcnt lgkmcnt(0)
v_mfma_f32_16x16x32_bf16 v[204:207], a[232:235], a[28:31], v[204:207]
buffer_load_dwordx4 v8, s[24:27], s48 offen offset:2048 nt lds
v_mfma_f32_16x16x32_bf16 v[204:207], a[236:239], a[32:35], v[204:207]
s_waitcnt vmcnt(9)
s_barrier
ds_read_b64_tr_b16 a[244:245], v23 offset:12288
ds_read_b64_tr_b16 a[246:247], v23 offset:12800
v_mfma_f32_16x16x32_bf16 v[196:199], a[236:239], a[28:31], 0
ds_read_b64_tr_b16 a[248:249], v24 offset:12288
ds_read_b64_tr_b16 a[250:251], v24 offset:12800
v_mfma_f32_16x16x32_bf16 v[196:199], a[232:235], a[24:27], v[196:199]
ds_read_b64_tr_b16 a[240:241], v22 offset:12288
ds_read_b64_tr_b16 a[242:243], v22 offset:12800
v_mfma_f32_16x16x32_bf16 v[196:199], a[228:231], a[20:23], v[196:199]
buffer_load_dwordx4 v7, s[24:27], s48 offen offset:1024 nt lds
v_mfma_f32_16x16x32_bf16 v[188:191], a[228:231], a[16:19], 0
v_mfma_f32_16x16x32_bf16 v[188:191], a[232:235], a[20:23], v[188:191]
v_mfma_f32_16x16x32_bf16 v[188:191], a[236:239], a[24:27], v[188:191]
v_mfma_f32_16x16x32_bf16 v[180:183], a[236:239], a[20:23], 0
buffer_load_dwordx4 v9, s[24:27], s48 offen offset:3072 nt lds
v_mfma_f32_16x16x32_bf16 v[180:183], a[232:235], a[16:19], v[180:183]
v_mfma_f32_16x16x32_bf16 v[180:183], a[228:231], a[12:15], v[180:183]
s_addk_i32 s49, 128
v_mfma_f32_16x16x32_bf16 v[172:175], a[228:231], a[8:11], 0
s_add_u32 m0, s100, 65536
v_mfma_f32_16x16x32_bf16 v[172:175], a[232:235], a[12:15], v[172:175]
buffer_load_dwordx4 v6, s[24:27], s49 offen offset:0 nt lds
v_mfma_f32_16x16x32_bf16 v[172:175], a[236:239], a[16:19], v[172:175]
v_mfma_f32_16x16x32_bf16 v[164:167], a[236:239], a[12:15], 0
ds_read_b64_tr_b16 a[252:253], v25 offset:12288
v_mfma_f32_16x16x32_bf16 v[164:167], a[232:235], a[8:11], v[164:167]
ds_read_b64_tr_b16 a[254:255], v25 offset:12800
v_mfma_f32_16x16x32_bf16 v[164:167], a[228:231], a[4:7], v[164:167]
buffer_load_dwordx4 v8, s[24:27], s49 offen offset:2048 nt lds
v_mfma_f32_16x16x32_bf16 v[156:159], a[228:231], a[0:3], 0
ds_read_b64_tr_b16 v[100:101], v26 offset:12288
v_mfma_f32_16x16x32_bf16 v[156:159], a[232:235], a[4:7], v[156:159]
ds_read_b64_tr_b16 v[102:103], v26 offset:12800
v_mfma_f32_16x16x32_bf16 v[156:159], a[236:239], a[8:11], v[156:159]
ds_read_b64_tr_b16 v[104:105], v27 offset:12288
v_mfma_f32_16x16x32_bf16 v[148:151], a[236:239], a[4:7], 0
buffer_load_dwordx4 v7, s[24:27], s49 offen offset:1024 nt lds
v_mfma_f32_16x16x32_bf16 v[148:151], a[232:235], a[0:3], v[148:151]
ds_read_b64_tr_b16 v[106:107], v27 offset:12800
s_waitcnt lgkmcnt(6)
v_mfma_f32_16x16x32_bf16 v[208:211], a[244:247], a[0:3], 0
v_mfma_f32_16x16x32_bf16 v[208:211], a[248:251], a[4:7], v[208:211]
v_mfma_f32_16x16x32_bf16 v[212:215], a[248:251], a[8:11], 0
buffer_load_dwordx4 v9, s[24:27], s49 offen offset:3072 nt lds
v_mfma_f32_16x16x32_bf16 v[212:215], a[244:247], a[4:7], v[212:215]
v_mfma_f32_16x16x32_bf16 v[212:215], a[240:243], a[0:3], v[212:215]
v_mfma_f32_16x16x32_bf16 v[216:219], a[240:243], a[4:7], 0
v_mfma_f32_16x16x32_bf16 v[216:219], a[244:247], a[8:11], v[216:219]
s_waitcnt vmcnt(9) lgkmcnt(2)
s_barrier
ds_read_b64_tr_b16 v[112:113], v17 offset:24576
ds_read_b64_tr_b16 v[114:115], v17 offset:25088
v_mfma_f32_16x16x32_bf16 v[216:219], a[248:251], a[12:15], v[216:219]
s_addk_i32 s53, 28672
ds_read_b128 a[36:39], v35 offset:32768
ds_read_b64_tr_b16 v[116:117], v18 offset:24576
v_mfma_f32_16x16x32_bf16 v[220:223], a[248:251], a[16:19], 0
s_add_u32 m0, s21, 147456
ds_read_b64_tr_b16 v[118:119], v18 offset:25088
v_mfma_f32_16x16x32_bf16 v[220:223], a[244:247], a[12:15], v[220:223]
buffer_load_dwordx4 v10, s[28:31], s53 offen offset:0  lds
v_mfma_f32_16x16x32_bf16 v[220:223], a[240:243], a[8:11], v[220:223]
ds_read_b128 a[40:43], v35 offset:34816
v_mfma_f32_16x16x32_bf16 v[224:227], a[240:243], a[12:15], 0
ds_read_b128 a[44:47], v35 offset:36864
v_mfma_f32_16x16x32_bf16 v[224:227], a[244:247], a[16:19], v[224:227]
ds_read_b64_tr_b16 v[108:109], v16 offset:24576
v_mfma_f32_16x16x32_bf16 v[224:227], a[248:251], a[20:23], v[224:227]
ds_read_b64_tr_b16 v[110:111], v16 offset:25088
v_mfma_f32_16x16x32_bf16 v[228:231], a[248:251], a[24:27], 0
v_mfma_f32_16x16x32_bf16 v[228:231], a[244:247], a[20:23], v[228:231]
v_mfma_f32_16x16x32_bf16 v[228:231], a[240:243], a[16:19], v[228:231]
ds_read_b128 a[48:51], v35 offset:38912
v_mfma_f32_16x16x32_bf16 v[232:235], a[240:243], a[20:23], 0
ds_read_b128 a[52:55], v35 offset:40960
v_mfma_f32_16x16x32_bf16 v[232:235], a[244:247], a[24:27], v[232:235]
v_mfma_f32_16x16x32_bf16 v[232:235], a[248:251], a[28:31], v[232:235]
v_mfma_f32_16x16x32_bf16 v[236:239], a[248:251], a[32:35], 0
v_mfma_f32_16x16x32_bf16 v[236:239], a[244:247], a[28:31], v[236:239]
v_mfma_f32_16x16x32_bf16 v[236:239], a[240:243], a[24:27], v[236:239]
ds_read_b128 a[56:59], v35 offset:43008
v_mfma_f32_16x16x32_bf16 v[252:255], a[252:255], a[24:27], 0
ds_read_b128 a[60:63], v35 offset:45056
v_mfma_f32_16x16x32_bf16 v[252:255], v[100:103], a[28:31], v[252:255]
s_waitcnt lgkmcnt(4)
v_mfma_f32_16x16x32_bf16 v[252:255], v[104:107], a[32:35], v[252:255]
v_mfma_f32_16x16x32_bf16 v[248:251], v[104:107], a[28:31], 0
v_mfma_f32_16x16x32_bf16 v[248:251], v[100:103], a[24:27], v[248:251]
ds_read_b128 a[64:67], v35 offset:47104
v_mfma_f32_16x16x32_bf16 v[248:251], a[252:255], a[20:23], v[248:251]
ds_read_b128 a[68:71], v39 offset:32768
v_mfma_f32_16x16x32_bf16 v[244:247], a[252:255], a[16:19], 0
ds_read_b64_tr_b16 v[120:121], v19 offset:24576
v_mfma_f32_16x16x32_bf16 v[244:247], v[100:103], a[20:23], v[244:247]
ds_read_b64_tr_b16 v[122:123], v19 offset:25088
v_mfma_f32_16x16x32_bf16 v[244:247], v[104:107], a[24:27], v[244:247]
ds_read_b64_tr_b16 v[124:125], v20 offset:24576
v_mfma_f32_16x16x32_bf16 v[240:243], v[104:107], a[20:23], 0
ds_read_b64_tr_b16 v[126:127], v20 offset:25088
v_mfma_f32_16x16x32_bf16 v[240:243], v[100:103], a[16:19], v[240:243]
ds_read_b64_tr_b16 v[128:129], v21 offset:24576
v_mfma_f32_16x16x32_bf16 v[240:243], a[252:255], a[12:15], v[240:243]
ds_read_b64_tr_b16 v[130:131], v21 offset:25088
v_mfma_f32_16x16x32_bf16 v[144:147], v[112:115], a[36:39], v[144:147]
v_mfma_f32_16x16x32_bf16 v[144:147], v[116:119], a[40:43], v[144:147]
v_mfma_f32_16x16x32_bf16 v[152:155], v[116:119], a[44:47], v[152:155]
v_mfma_f32_16x16x32_bf16 v[152:155], v[112:115], a[40:43], v[152:155]
v_mfma_f32_16x16x32_bf16 v[152:155], v[108:111], a[36:39], v[152:155]
v_mfma_f32_16x16x32_bf16 v[160:163], v[108:111], a[40:43], v[160:163]
v_mfma_f32_16x16x32_bf16 v[160:163], v[112:115], a[44:47], v[160:163]
s_waitcnt lgkmcnt(2)
v_mfma_f32_16x16x32_bf16 v[160:163], v[116:119], a[48:51], v[160:163]
v_mfma_f32_16x16x32_bf16 v[168:171], v[116:119], a[52:55], v[168:171]
v_mfma_f32_16x16x32_bf16 v[168:171], v[112:115], a[48:51], v[168:171]
v_mfma_f32_16x16x32_bf16 v[168:171], v[108:111], a[44:47], v[168:171]
v_mfma_f32_16x16x32_bf16 v[176:179], v[108:111], a[48:51], v[176:179]
buffer_load_dwordx4 v11, s[28:31], s53 offen offset:1024  lds
v_mfma_f32_16x16x32_bf16 v[176:179], v[112:115], a[52:55], v[176:179]
v_mfma_f32_16x16x32_bf16 v[176:179], v[116:119], a[56:59], v[176:179]
v_mfma_f32_16x16x32_bf16 v[184:187], v[116:119], a[60:63], v[184:187]
v_mfma_f32_16x16x32_bf16 v[184:187], v[112:115], a[56:59], v[184:187]
buffer_load_dwordx4 v12, s[28:31], s53 offen offset:2048  lds
v_mfma_f32_16x16x32_bf16 v[184:187], v[108:111], a[52:55], v[184:187]
v_mfma_f32_16x16x32_bf16 v[192:195], v[108:111], a[56:59], v[192:195]
ds_read_b64_tr_b16 v[136:137], v23 offset:36864
v_mfma_f32_16x16x32_bf16 v[192:195], v[112:115], a[60:63], v[192:195]
s_add_u32 m0, s21, 98304
ds_read_b64_tr_b16 v[138:139], v23 offset:37376
v_mfma_f32_16x16x32_bf16 v[192:195], v[116:119], a[64:67], v[192:195]
buffer_load_dwordx4 v13, s[28:31], s53 offen offset:0  lds
v_mfma_f32_16x16x32_bf16 v[200:203], v[116:119], a[68:71], v[200:203]
ds_read_b64_tr_b16 v[140:141], v24 offset:36864
v_mfma_f32_16x16x32_bf16 v[200:203], v[112:115], a[64:67], v[200:203]
ds_read_b64_tr_b16 v[142:143], v24 offset:37376
v_mfma_f32_16x16x32_bf16 v[200:203], v[108:111], a[60:63], v[200:203]
ds_read_b64_tr_b16 v[132:133], v22 offset:36864
v_mfma_f32_16x16x32_bf16 v[204:207], v[120:123], a[60:63], v[204:207]
buffer_load_dwordx4 v14, s[28:31], s53 offen offset:1024  lds
v_mfma_f32_16x16x32_bf16 v[204:207], v[124:127], a[64:67], v[204:207]
ds_read_b64_tr_b16 v[134:135], v22 offset:37376
s_waitcnt lgkmcnt(6)
v_mfma_f32_16x16x32_bf16 v[204:207], v[128:131], a[68:71], v[204:207]
v_mfma_f32_16x16x32_bf16 v[196:199], v[128:131], a[64:67], v[196:199]
v_mfma_f32_16x16x32_bf16 v[196:199], v[124:127], a[60:63], v[196:199]
buffer_load_dwordx4 v15, s[28:31], s53 offen offset:2048  lds
v_mfma_f32_16x16x32_bf16 v[196:199], v[120:123], a[56:59], v[196:199]
v_mfma_f32_16x16x32_bf16 v[188:191], v[120:123], a[52:55], v[188:191]
v_mfma_f32_16x16x32_bf16 v[188:191], v[124:127], a[56:59], v[188:191]
v_mfma_f32_16x16x32_bf16 v[188:191], v[128:131], a[60:63], v[188:191]
global_load_dword v52, v68, s[12:13]
v_mfma_f32_16x16x32_bf16 v[180:183], v[128:131], a[56:59], v[180:183]
v_mfma_f32_16x16x32_bf16 v[180:183], v[124:127], a[52:55], v[180:183]
global_load_dword v53, v68, s[14:15]
v_mfma_f32_16x16x32_bf16 v[180:183], v[120:123], a[48:51], v[180:183]
v_mfma_f32_16x16x32_bf16 v[172:175], v[120:123], a[44:47], v[172:175]
global_load_dword v54, v68, s[16:17]
v_mfma_f32_16x16x32_bf16 v[172:175], v[124:127], a[48:51], v[172:175]
v_mfma_f32_16x16x32_bf16 v[172:175], v[128:131], a[52:55], v[172:175]
global_load_dword v55, v68, s[18:19]
v_mfma_f32_16x16x32_bf16 v[164:167], v[128:131], a[48:51], v[164:167]
v_mfma_f32_16x16x32_bf16 v[164:167], v[124:127], a[44:47], v[164:167]
v_mfma_f32_16x16x32_bf16 v[164:167], v[120:123], a[40:43], v[164:167]
ds_read_b64_tr_b16 a[216:217], v25 offset:36864
v_mfma_f32_16x16x32_bf16 v[156:159], v[120:123], a[36:39], v[156:159]
ds_read_b64_tr_b16 a[218:219], v25 offset:37376
v_mfma_f32_16x16x32_bf16 v[156:159], v[124:127], a[40:43], v[156:159]
ds_read_b64_tr_b16 a[220:221], v26 offset:36864
v_mfma_f32_16x16x32_bf16 v[156:159], v[128:131], a[44:47], v[156:159]
ds_read_b64_tr_b16 a[222:223], v26 offset:37376
v_mfma_f32_16x16x32_bf16 v[148:151], v[128:131], a[40:43], v[148:151]
ds_read_b64_tr_b16 a[224:225], v27 offset:36864
v_mfma_f32_16x16x32_bf16 v[148:151], v[124:127], a[36:39], v[148:151]
ds_read_b64_tr_b16 a[226:227], v27 offset:37376
s_waitcnt lgkmcnt(6)
v_mfma_f32_16x16x32_bf16 v[208:211], v[136:139], a[36:39], v[208:211]
v_mfma_f32_16x16x32_bf16 v[208:211], v[140:143], a[40:43], v[208:211]
v_mfma_f32_16x16x32_bf16 v[212:215], v[140:143], a[44:47], v[212:215]
v_mfma_f32_16x16x32_bf16 v[212:215], v[136:139], a[40:43], v[212:215]
v_mfma_f32_16x16x32_bf16 v[212:215], v[132:135], a[36:39], v[212:215]
v_mfma_f32_16x16x32_bf16 v[216:219], v[132:135], a[40:43], v[216:219]
v_mfma_f32_16x16x32_bf16 v[216:219], v[136:139], a[44:47], v[216:219]
s_waitcnt vmcnt(7) lgkmcnt(3)
s_barrier
ds_read_b64_tr_b16 a[232:233], v17 offset:49152
ds_read_b64_tr_b16 a[234:235], v17 offset:49664
v_mfma_f32_16x16x32_bf16 v[216:219], v[140:143], a[48:51], v[216:219]
s_addk_i32 s53, 28672
ds_read_b128 a[72:75], v36 offset:0
ds_read_b64_tr_b16 a[236:237], v18 offset:49152
v_mfma_f32_16x16x32_bf16 v[220:223], v[140:143], a[52:55], v[220:223]
s_addk_i32 m0, 12288
ds_read_b64_tr_b16 a[238:239], v18 offset:49664
ds_read_b128 a[76:79], v36 offset:2048
v_mfma_f32_16x16x32_bf16 v[220:223], v[136:139], a[48:51], v[220:223]
buffer_load_dwordx4 v10, s[28:31], s53 offen offset:0  lds
v_mfma_f32_16x16x32_bf16 v[220:223], v[132:135], a[44:47], v[220:223]
ds_read_b128 a[80:83], v36 offset:4096
v_mfma_f32_16x16x32_bf16 v[224:227], v[132:135], a[48:51], v[224:227]
ds_read_b64_tr_b16 a[228:229], v16 offset:49152
v_mfma_f32_16x16x32_bf16 v[224:227], v[136:139], a[52:55], v[224:227]
ds_read_b64_tr_b16 a[230:231], v16 offset:49664
v_mfma_f32_16x16x32_bf16 v[224:227], v[140:143], a[56:59], v[224:227]
buffer_load_dwordx4 v11, s[28:31], s53 offen offset:1024  lds
v_mfma_f32_16x16x32_bf16 v[228:231], v[140:143], a[60:63], v[228:231]
v_mfma_f32_16x16x32_bf16 v[228:231], v[136:139], a[56:59], v[228:231]
ds_read_b128 a[84:87], v36 offset:6144
v_mfma_f32_16x16x32_bf16 v[228:231], v[132:135], a[52:55], v[228:231]
ds_read_b128 a[88:91], v36 offset:8192
v_mfma_f32_16x16x32_bf16 v[232:235], v[132:135], a[56:59], v[232:235]
buffer_load_dwordx4 v12, s[28:31], s53 offen offset:2048  lds
v_mfma_f32_16x16x32_bf16 v[232:235], v[136:139], a[60:63], v[232:235]
v_mfma_f32_16x16x32_bf16 v[232:235], v[140:143], a[64:67], v[232:235]
v_mfma_f32_16x16x32_bf16 v[236:239], v[140:143], a[68:71], v[236:239]
s_addk_i32 m0, 12288
v_mfma_f32_16x16x32_bf16 v[236:239], v[136:139], a[64:67], v[236:239]
buffer_load_dwordx4 v13, s[28:31], s53 offen offset:0  lds
v_mfma_f32_16x16x32_bf16 v[236:239], v[132:135], a[60:63], v[236:239]
ds_read_b128 a[92:95], v36 offset:10240
v_mfma_f32_16x16x32_bf16 v[252:255], a[216:219], a[60:63], v[252:255]
ds_read_b128 a[96:99], v36 offset:12288
s_waitcnt lgkmcnt(4)
v_mfma_f32_16x16x32_bf16 v[252:255], a[220:223], a[64:67], v[252:255]
ds_read_b128 a[100:103], v36 offset:14336
v_mfma_f32_16x16x32_bf16 v[252:255], a[224:227], a[68:71], v[252:255]
buffer_load_dwordx4 v14, s[28:31], s53 offen offset:1024  lds
v_mfma_f32_16x16x32_bf16 v[248:251], a[224:227], a[64:67], v[248:251]
ds_read_b128 a[104:107], v40 offset:0
v_mfma_f32_16x16x32_bf16 v[248:251], a[220:223], a[60:63], v[248:251]
ds_read_b64_tr_b16 a[240:241], v19 offset:49152
v_mfma_f32_16x16x32_bf16 v[248:251], a[216:219], a[56:59], v[248:251]
ds_read_b64_tr_b16 a[242:243], v19 offset:49664
v_mfma_f32_16x16x32_bf16 v[244:247], a[216:219], a[52:55], v[244:247]
buffer_load_dwordx4 v15, s[28:31], s53 offen offset:2048  lds
v_mfma_f32_16x16x32_bf16 v[244:247], a[220:223], a[56:59], v[244:247]
ds_read_b64_tr_b16 a[244:245], v20 offset:49152
v_mfma_f32_16x16x32_bf16 v[244:247], a[224:227], a[60:63], v[244:247]
ds_read_b64_tr_b16 a[246:247], v20 offset:49664
v_mfma_f32_16x16x32_bf16 v[240:243], a[224:227], a[56:59], v[240:243]
s_mov_b32 s55, 114688
ds_read_b64_tr_b16 a[248:249], v21 offset:49152
v_mfma_f32_16x16x32_bf16 v[240:243], a[220:223], a[52:55], v[240:243]
buffer_load_dword v2, v50, s[28:31], s55 offen
v_mfma_f32_16x16x32_bf16 v[240:243], a[216:219], a[48:51], v[240:243]
ds_read_b64_tr_b16 a[250:251], v21 offset:49664
v_mfma_f32_16x16x32_bf16 v[144:147], a[232:235], a[72:75], v[144:147]
s_addk_i32 s48, 128
v_mfma_f32_16x16x32_bf16 v[144:147], a[236:239], a[76:79], v[144:147]
s_mov_b32 m0, s20
v_mfma_f32_16x16x32_bf16 v[152:155], a[236:239], a[80:83], v[152:155]
buffer_load_dwordx4 v6, s[24:27], s48 offen offset:0 nt lds
v_mfma_f32_16x16x32_bf16 v[152:155], a[232:235], a[76:79], v[152:155]
v_mfma_f32_16x16x32_bf16 v[152:155], a[228:231], a[72:75], v[152:155]
v_mfma_f32_16x16x32_bf16 v[160:163], a[228:231], a[76:79], v[160:163]
v_mfma_f32_16x16x32_bf16 v[160:163], a[232:235], a[80:83], v[160:163]
buffer_load_dwordx4 v8, s[24:27], s48 offen offset:2048 nt lds
s_waitcnt lgkmcnt(1)
v_mfma_f32_16x16x32_bf16 v[160:163], a[236:239], a[84:87], v[160:163]
v_mfma_f32_16x16x32_bf16 v[168:171], a[236:239], a[88:91], v[168:171]
v_mfma_f32_16x16x32_bf16 v[168:171], a[232:235], a[84:87], v[168:171]
v_mfma_f32_16x16x32_bf16 v[168:171], a[228:231], a[80:83], v[168:171]
buffer_load_dwordx4 v7, s[24:27], s48 offen offset:1024 nt lds
v_mfma_f32_16x16x32_bf16 v[176:179], a[228:231], a[84:87], v[176:179]
v_mfma_f32_16x16x32_bf16 v[176:179], a[232:235], a[88:91], v[176:179]
v_mfma_f32_16x16x32_bf16 v[176:179], a[236:239], a[92:95], v[176:179]
s_waitcnt vmcnt(14) lgkmcnt(0)
s_barrier
v_mfma_f32_16x16x32_bf16 v[184:187], a[236:239], a[96:99], v[184:187]
buffer_load_dwordx4 v9, s[24:27], s48 offen offset:3072 nt lds
v_mfma_f32_16x16x32_bf16 v[184:187], a[232:235], a[92:95], v[184:187]
v_mfma_f32_16x16x32_bf16 v[184:187], a[228:231], a[88:91], v[184:187]
s_addk_i32 s49, 128
v_mfma_f32_16x16x32_bf16 v[192:195], a[228:231], a[92:95], v[192:195]
s_mov_b32 m0, s100
ds_read_b64_tr_b16 v[100:101], v23 offset:0
v_mfma_f32_16x16x32_bf16 v[192:195], a[232:235], a[96:99], v[192:195]
buffer_load_dwordx4 v6, s[24:27], s49 offen offset:0 nt lds
v_mfma_f32_16x16x32_bf16 v[192:195], a[236:239], a[100:103], v[192:195]
ds_read_b64_tr_b16 v[102:103], v23 offset:512
v_mfma_f32_16x16x32_bf16 v[200:203], a[236:239], a[104:107], v[200:203]
ds_read_b64_tr_b16 v[104:105], v24 offset:0
v_mfma_f32_16x16x32_bf16 v[200:203], a[232:235], a[100:103], v[200:203]
ds_read_b64_tr_b16 v[106:107], v24 offset:512
v_mfma_f32_16x16x32_bf16 v[200:203], a[228:231], a[96:99], v[200:203]
buffer_load_dwordx4 v8, s[24:27], s49 offen offset:2048 nt lds
v_mfma_f32_16x16x32_bf16 v[204:207], a[240:243], a[96:99], v[204:207]
ds_read_b64_tr_b16 a[252:253], v22 offset:0
v_mfma_f32_16x16x32_bf16 v[204:207], a[244:247], a[100:103], v[204:207]
ds_read_b64_tr_b16 a[254:255], v22 offset:512
v_mfma_f32_16x16x32_bf16 v[204:207], a[248:251], a[104:107], v[204:207]
v_mfma_f32_16x16x32_bf16 v[196:199], a[248:251], a[100:103], v[196:199]
buffer_load_dwordx4 v7, s[24:27], s49 offen offset:1024 nt lds
v_mfma_f32_16x16x32_bf16 v[196:199], a[244:247], a[96:99], v[196:199]
v_mfma_f32_16x16x32_bf16 v[196:199], a[240:243], a[92:95], v[196:199]
v_mfma_f32_16x16x32_bf16 v[188:191], a[240:243], a[88:91], v[188:191]
v_mfma_f32_16x16x32_bf16 v[188:191], a[244:247], a[92:95], v[188:191]
buffer_load_dwordx4 v9, s[24:27], s49 offen offset:3072 nt lds
v_mfma_f32_16x16x32_bf16 v[188:191], a[248:251], a[96:99], v[188:191]
v_mfma_f32_16x16x32_bf16 v[180:183], a[248:251], a[92:95], v[180:183]
v_mfma_f32_16x16x32_bf16 v[180:183], a[244:247], a[88:91], v[180:183]
v_mfma_f32_16x16x32_bf16 v[180:183], a[240:243], a[84:87], v[180:183]
v_mfma_f32_16x16x32_bf16 v[172:175], a[240:243], a[80:83], v[172:175]
v_mfma_f32_16x16x32_bf16 v[172:175], a[244:247], a[84:87], v[172:175]
v_mfma_f32_16x16x32_bf16 v[172:175], a[248:251], a[88:91], v[172:175]
v_mfma_f32_16x16x32_bf16 v[164:167], a[248:251], a[84:87], v[164:167]
v_mfma_f32_16x16x32_bf16 v[164:167], a[244:247], a[80:83], v[164:167]
v_mfma_f32_16x16x32_bf16 v[164:167], a[240:243], a[76:79], v[164:167]
ds_read_b64_tr_b16 v[108:109], v25 offset:0
v_mfma_f32_16x16x32_bf16 v[156:159], a[240:243], a[72:75], v[156:159]
ds_read_b64_tr_b16 v[110:111], v25 offset:512
v_mfma_f32_16x16x32_bf16 v[156:159], a[244:247], a[76:79], v[156:159]
ds_read_b64_tr_b16 v[112:113], v26 offset:0
v_mfma_f32_16x16x32_bf16 v[156:159], a[248:251], a[80:83], v[156:159]
ds_read_b64_tr_b16 v[114:115], v26 offset:512
v_mfma_f32_16x16x32_bf16 v[148:151], a[248:251], a[76:79], v[148:151]
ds_read_b64_tr_b16 v[116:117], v27 offset:0
v_mfma_f32_16x16x32_bf16 v[148:151], a[244:247], a[72:75], v[148:151]
ds_read_b64_tr_b16 v[118:119], v27 offset:512
s_waitcnt lgkmcnt(6)
v_mfma_f32_16x16x32_bf16 v[208:211], v[100:103], a[72:75], v[208:211]
v_mfma_f32_16x16x32_bf16 v[208:211], v[104:107], a[76:79], v[208:211]
v_mfma_f32_16x16x32_bf16 v[212:215], v[104:107], a[80:83], v[212:215]
s_waitcnt vmcnt(9)
s_barrier
v_mfma_f32_16x16x32_bf16 v[212:215], v[100:103], a[76:79], v[212:215]
s_addk_i32 s53, 28672
v_mfma_f32_16x16x32_bf16 v[212:215], a[252:255], a[72:75], v[212:215]
s_add_u32 m0, s21, 135168
ds_read_b64_tr_b16 v[124:125], v17 offset:12288
v_mfma_f32_16x16x32_bf16 v[216:219], a[252:255], a[76:79], v[216:219]
buffer_load_dwordx4 v10, s[28:31], s53 offen offset:0  lds
v_mfma_f32_16x16x32_bf16 v[216:219], v[100:103], a[80:83], v[216:219]
ds_read_b64_tr_b16 v[126:127], v17 offset:12800
v_mfma_f32_16x16x32_bf16 v[216:219], v[104:107], a[84:87], v[216:219]
ds_read_b128 a[108:111], v37 offset:0
v_mfma_f32_16x16x32_bf16 v[220:223], v[104:107], a[88:91], v[220:223]
ds_read_b64_tr_b16 v[128:129], v18 offset:12288
v_mfma_f32_16x16x32_bf16 v[220:223], v[100:103], a[84:87], v[220:223]
ds_read_b64_tr_b16 v[130:131], v18 offset:12800
v_mfma_f32_16x16x32_bf16 v[220:223], a[252:255], a[80:83], v[220:223]
ds_read_b128 a[112:115], v37 offset:2048
v_mfma_f32_16x16x32_bf16 v[224:227], a[252:255], a[84:87], v[224:227]
ds_read_b128 a[116:119], v37 offset:4096
v_mfma_f32_16x16x32_bf16 v[224:227], v[100:103], a[88:91], v[224:227]
ds_read_b64_tr_b16 v[120:121], v16 offset:12288
v_mfma_f32_16x16x32_bf16 v[224:227], v[104:107], a[92:95], v[224:227]
ds_read_b64_tr_b16 v[122:123], v16 offset:12800
v_mfma_f32_16x16x32_bf16 v[228:231], v[104:107], a[96:99], v[228:231]
v_mfma_f32_16x16x32_bf16 v[228:231], v[100:103], a[92:95], v[228:231]
v_mfma_f32_16x16x32_bf16 v[228:231], a[252:255], a[88:91], v[228:231]
ds_read_b128 a[120:123], v37 offset:6144
v_mfma_f32_16x16x32_bf16 v[232:235], a[252:255], a[92:95], v[232:235]
ds_read_b128 a[124:127], v37 offset:8192
v_mfma_f32_16x16x32_bf16 v[232:235], v[100:103], a[96:99], v[232:235]
v_mfma_f32_16x16x32_bf16 v[232:235], v[104:107], a[100:103], v[232:235]
v_mfma_f32_16x16x32_bf16 v[236:239], v[104:107], a[104:107], v[236:239]
v_mfma_f32_16x16x32_bf16 v[236:239], v[100:103], a[100:103], v[236:239]
v_mfma_f32_16x16x32_bf16 v[236:239], a[252:255], a[96:99], v[236:239]
ds_read_b128 a[128:131], v37 offset:10240
s_waitcnt lgkmcnt(3)
v_mfma_f32_16x16x32_bf16 v[252:255], v[108:111], a[96:99], v[252:255]
ds_read_b128 a[132:135], v37 offset:12288
v_mfma_f32_16x16x32_bf16 v[252:255], v[112:115], a[100:103], v[252:255]
v_mfma_f32_16x16x32_bf16 v[252:255], v[116:119], a[104:107], v[252:255]
ds_read_b128 a[136:139], v37 offset:14336
v_mfma_f32_16x16x32_bf16 v[248:251], v[116:119], a[100:103], v[248:251]
ds_read_b128 a[140:143], v41 offset:0
v_mfma_f32_16x16x32_bf16 v[248:251], v[112:115], a[96:99], v[248:251]
ds_read_b64_tr_b16 v[132:133], v19 offset:12288
v_mfma_f32_16x16x32_bf16 v[248:251], v[108:111], a[92:95], v[248:251]
buffer_load_dwordx4 v11, s[28:31], s53 offen offset:1024  lds
v_mfma_f32_16x16x32_bf16 v[244:247], v[108:111], a[88:91], v[244:247]
ds_read_b64_tr_b16 v[134:135], v19 offset:12800
v_mfma_f32_16x16x32_bf16 v[244:247], v[112:115], a[92:95], v[244:247]
ds_read_b64_tr_b16 v[136:137], v20 offset:12288
v_mfma_f32_16x16x32_bf16 v[244:247], v[116:119], a[96:99], v[244:247]
ds_read_b64_tr_b16 v[138:139], v20 offset:12800
v_mfma_f32_16x16x32_bf16 v[240:243], v[116:119], a[92:95], v[240:243]
buffer_load_dwordx4 v12, s[28:31], s53 offen offset:2048  lds
v_mfma_f32_16x16x32_bf16 v[240:243], v[112:115], a[88:91], v[240:243]
ds_read_b64_tr_b16 v[140:141], v21 offset:12288
v_mfma_f32_16x16x32_bf16 v[240:243], v[108:111], a[84:87], v[240:243]
ds_read_b64_tr_b16 v[142:143], v21 offset:12800
v_mfma_f32_16x16x32_bf16 v[144:147], v[124:127], a[108:111], v[144:147]
s_addk_i32 m0, 12288
v_mfma_f32_16x16x32_bf16 v[144:147], v[128:131], a[112:115], v[144:147]
buffer_load_dwordx4 v13, s[28:31], s53 offen offset:0  lds
v_mfma_f32_16x16x32_bf16 v[152:155], v[128:131], a[116:119], v[152:155]
v_mfma_f32_16x16x32_bf16 v[152:155], v[124:127], a[112:115], v[152:155]
v_mfma_f32_16x16x32_bf16 v[152:155], v[120:123], a[108:111], v[152:155]
v_mfma_f32_16x16x32_bf16 v[160:163], v[120:123], a[112:115], v[160:163]
buffer_load_dwordx4 v14, s[28:31], s53 offen offset:1024  lds
v_mfma_f32_16x16x32_bf16 v[160:163], v[124:127], a[116:119], v[160:163]
s_waitcnt lgkmcnt(2)
v_mfma_f32_16x16x32_bf16 v[160:163], v[128:131], a[120:123], v[160:163]
v_mfma_f32_16x16x32_bf16 v[168:171], v[128:131], a[124:127], v[168:171]
v_mfma_f32_16x16x32_bf16 v[168:171], v[124:127], a[120:123], v[168:171]
buffer_load_dwordx4 v15, s[28:31], s53 offen offset:2048  lds
v_mfma_f32_16x16x32_bf16 v[168:171], v[120:123], a[116:119], v[168:171]
v_mfma_f32_16x16x32_bf16 v[176:179], v[120:123], a[120:123], v[176:179]
v_mfma_f32_16x16x32_bf16 v[176:179], v[124:127], a[124:127], v[176:179]
v_mfma_f32_16x16x32_bf16 v[176:179], v[128:131], a[128:131], v[176:179]
v_mfma_f32_16x16x32_bf16 v[184:187], v[128:131], a[132:135], v[184:187]
v_mfma_f32_16x16x32_bf16 v[184:187], v[124:127], a[128:131], v[184:187]
v_lshlrev_b32 v56, 16, v53
v_mfma_f32_16x16x32_bf16 v[184:187], v[120:123], a[124:127], v[184:187]
v_and_b32 v57, 0xffff0000, v53
v_mfma_f32_16x16x32_bf16 v[192:195], v[120:123], a[128:131], v[192:195]
v_add_f32 v56, 0x3727c5ac, v56
v_mfma_f32_16x16x32_bf16 v[192:195], v[124:127], a[132:135], v[192:195]
ds_read_b64_tr_b16 a[220:221], v23 offset:24576
v_mfma_f32_16x16x32_bf16 v[192:195], v[128:131], a[136:139], v[192:195]
ds_read_b64_tr_b16 a[222:223], v23 offset:25088
v_mfma_f32_16x16x32_bf16 v[200:203], v[128:131], a[140:143], v[200:203]
ds_read_b64_tr_b16 a[224:225], v24 offset:24576
v_mfma_f32_16x16x32_bf16 v[200:203], v[124:127], a[136:139], v[200:203]
ds_read_b64_tr_b16 a[226:227], v24 offset:25088
v_mfma_f32_16x16x32_bf16 v[200:203], v[120:123], a[132:135], v[200:203]
v_add_f32 v57, 0x3727c5ac, v57
v_mfma_f32_16x16x32_bf16 v[204:207], v[132:135], a[132:135], v[204:207]
ds_read_b64_tr_b16 a[216:217], v22 offset:24576
v_mfma_f32_16x16x32_bf16 v[204:207], v[136:139], a[136:139], v[204:207]
ds_read_b64_tr_b16 a[218:219], v22 offset:25088
s_waitcnt lgkmcnt(6)
v_mfma_f32_16x16x32_bf16 v[204:207], v[140:143], a[140:143], v[204:207]
v_cvt_pk_bf16_f32 v66, v56, v57
v_mfma_f32_16x16x32_bf16 v[196:199], v[140:143], a[136:139], v[196:199]
v_lshlrev_b32 v56, 16, v66
v_mfma_f32_16x16x32_bf16 v[196:199], v[136:139], a[132:135], v[196:199]
v_and_b32 v57, 0xffff0000, v66
v_mfma_f32_16x16x32_bf16 v[196:199], v[132:135], a[128:131], v[196:199]
v_sqrt_f32 v56, v56
v_mfma_f32_16x16x32_bf16 v[188:191], v[132:135], a[124:127], v[188:191]
v_sqrt_f32 v57, v57
v_mfma_f32_16x16x32_bf16 v[188:191], v[136:139], a[128:131], v[188:191]
v_lshlrev_b32 v58, 16, v54
v_mfma_f32_16x16x32_bf16 v[188:191], v[140:143], a[132:135], v[188:191]
v_and_b32 v59, 0xffff0000, v54
v_mfma_f32_16x16x32_bf16 v[180:183], v[140:143], a[128:131], v[180:183]
v_cvt_pk_bf16_f32 v66, v56, v57
v_mfma_f32_16x16x32_bf16 v[180:183], v[136:139], a[124:127], v[180:183]
v_lshlrev_b32 v56, 16, v66
v_mfma_f32_16x16x32_bf16 v[180:183], v[132:135], a[120:123], v[180:183]
v_and_b32 v57, 0xffff0000, v66
v_mfma_f32_16x16x32_bf16 v[172:175], v[132:135], a[116:119], v[172:175]
v_rcp_f32 v56, v56
v_mfma_f32_16x16x32_bf16 v[172:175], v[136:139], a[120:123], v[172:175]
v_rcp_f32 v57, v57
v_mfma_f32_16x16x32_bf16 v[172:175], v[140:143], a[124:127], v[172:175]
v_lshlrev_b32 v60, 16, v52
v_mfma_f32_16x16x32_bf16 v[164:167], v[140:143], a[120:123], v[164:167]
v_and_b32 v61, 0xffff0000, v52
v_mfma_f32_16x16x32_bf16 v[164:167], v[136:139], a[116:119], v[164:167]
v_cvt_pk_bf16_f32 v66, v56, v57
v_mfma_f32_16x16x32_bf16 v[164:167], v[132:135], a[112:115], v[164:167]
ds_read_b64_tr_b16 a[228:229], v25 offset:24576
v_mfma_f32_16x16x32_bf16 v[156:159], v[132:135], a[108:111], v[156:159]
ds_read_b64_tr_b16 a[230:231], v25 offset:25088
v_mfma_f32_16x16x32_bf16 v[156:159], v[136:139], a[112:115], v[156:159]
ds_read_b64_tr_b16 a[232:233], v26 offset:24576
v_mfma_f32_16x16x32_bf16 v[156:159], v[140:143], a[116:119], v[156:159]
L_pad1_1:
s_cbranch_execz L_body1
ds_read_b64_tr_b16 a[234:235], v26 offset:25088
v_mfma_f32_16x16x32_bf16 v[148:151], v[140:143], a[112:115], v[148:151]
ds_read_b64_tr_b16 a[236:237], v27 offset:24576
v_mfma_f32_16x16x32_bf16 v[148:151], v[136:139], a[108:111], v[148:151]
ds_read_b64_tr_b16 a[238:239], v27 offset:25088
s_waitcnt lgkmcnt(6)
v_mfma_f32_16x16x32_bf16 v[208:211], a[220:223], a[108:111], v[208:211]
v_lshlrev_b32 v56, 16, v66
v_mfma_f32_16x16x32_bf16 v[208:211], a[224:227], a[112:115], v[208:211]
v_and_b32 v57, 0xffff0000, v66
v_mfma_f32_16x16x32_bf16 v[212:215], a[224:227], a[116:119], v[212:215]
s_waitcnt vmcnt(3)
s_barrier
ds_read_b64_tr_b16 a[244:245], v17 offset:36864
v_mfma_f32_16x16x32_bf16 v[212:215], a[220:223], a[112:115], v[212:215]
s_addk_i32 s53, 28672
ds_read_b64_tr_b16 a[246:247], v17 offset:37376
v_mfma_f32_16x16x32_bf16 v[212:215], a[216:219], a[108:111], v[212:215]
s_add_u32 m0, s21, 98304
ds_read_b128 a[144:147], v34 offset:0
v_mfma_f32_16x16x32_bf16 v[216:219], a[216:219], a[112:115], v[216:219]
buffer_load_dwordx4 v10, s[28:31], s53 offen offset:0  lds
v_mfma_f32_16x16x32_bf16 v[216:219], a[220:223], a[116:119], v[216:219]
ds_read_b64_tr_b16 a[248:249], v18 offset:36864
v_mfma_f32_16x16x32_bf16 v[216:219], a[224:227], a[120:123], v[216:219]
ds_read_b64_tr_b16 a[250:251], v18 offset:37376
v_mfma_f32_16x16x32_bf16 v[220:223], a[224:227], a[124:127], v[220:223]
ds_read_b128 a[148:151], v34 offset:2048
v_mfma_f32_16x16x32_bf16 v[220:223], a[220:223], a[120:123], v[220:223]
buffer_load_dwordx4 v11, s[28:31], s53 offen offset:1024  lds
v_mfma_f32_16x16x32_bf16 v[220:223], a[216:219], a[116:119], v[220:223]
ds_read_b128 a[152:155], v34 offset:4096
v_mfma_f32_16x16x32_bf16 v[224:227], a[216:219], a[120:123], v[224:227]
ds_read_b64_tr_b16 a[240:241], v16 offset:36864
v_mfma_f32_16x16x32_bf16 v[224:227], a[220:223], a[124:127], v[224:227]
ds_read_b64_tr_b16 a[242:243], v16 offset:37376
v_mfma_f32_16x16x32_bf16 v[224:227], a[224:227], a[128:131], v[224:227]
buffer_load_dwordx4 v12, s[28:31], s53 offen offset:2048  lds
v_mfma_f32_16x16x32_bf16 v[228:231], a[224:227], a[132:135], v[228:231]
v_mul_f32 v56, v56, v58
v_mfma_f32_16x16x32_bf16 v[228:231], a[220:223], a[128:131], v[228:231]
ds_read_b128 a[156:159], v34 offset:6144
v_mfma_f32_16x16x32_bf16 v[228:231], a[216:219], a[124:127], v[228:231]
s_addk_i32 m0, 12288
ds_read_b128 a[160:163], v34 offset:8192
v_mfma_f32_16x16x32_bf16 v[232:235], a[216:219], a[128:131], v[232:235]
buffer_load_dwordx4 v13, s[28:31], s53 offen offset:0  lds
v_mfma_f32_16x16x32_bf16 v[232:235], a[220:223], a[132:135], v[232:235]
v_mul_f32 v57, v57, v59
v_mfma_f32_16x16x32_bf16 v[232:235], a[224:227], a[136:139], v[232:235]
v_lshlrev_b32 v62, 16, v55
v_mfma_f32_16x16x32_bf16 v[236:239], a[224:227], a[140:143], v[236:239]
v_and_b32 v63, 0xffff0000, v55
v_mfma_f32_16x16x32_bf16 v[236:239], a[220:223], a[136:139], v[236:239]
buffer_load_dwordx4 v14, s[28:31], s53 offen offset:1024  lds
v_mfma_f32_16x16x32_bf16 v[236:239], a[216:219], a[132:135], v[236:239]
ds_read_b128 a[164:167], v34 offset:10240
s_waitcnt lgkmcnt(3)
v_mfma_f32_16x16x32_bf16 v[252:255], a[228:231], a[132:135], v[252:255]
ds_read_b128 a[168:171], v34 offset:12288
v_mfma_f32_16x16x32_bf16 v[252:255], a[232:235], a[136:139], v[252:255]
ds_read_b128 a[172:175], v34 offset:14336
v_mfma_f32_16x16x32_bf16 v[252:255], a[236:239], a[140:143], v[252:255]
buffer_load_dwordx4 v15, s[28:31], s53 offen offset:2048  lds
v_mfma_f32_16x16x32_bf16 v[248:251], a[236:239], a[136:139], v[248:251]
ds_read_b128 a[176:179], v38 offset:0
v_mfma_f32_16x16x32_bf16 v[248:251], a[232:235], a[132:135], v[248:251]
ds_read_b64_tr_b16 a[252:253], v19 offset:36864
v_mfma_f32_16x16x32_bf16 v[248:251], a[228:231], a[128:131], v[248:251]
s_mov_b32 s55, 172032
ds_read_b64_tr_b16 a[254:255], v19 offset:37376
v_mfma_f32_16x16x32_bf16 v[244:247], a[228:231], a[124:127], v[244:247]
buffer_load_dword v3, v50, s[28:31], s55 offen
v_mfma_f32_16x16x32_bf16 v[244:247], a[232:235], a[128:131], v[244:247]
ds_read_b64_tr_b16 v[100:101], v20 offset:36864
v_mfma_f32_16x16x32_bf16 v[244:247], a[236:239], a[132:135], v[244:247]
s_addk_i32 s48, 128
ds_read_b64_tr_b16 v[102:103], v20 offset:37376
v_mfma_f32_16x16x32_bf16 v[240:243], a[236:239], a[128:131], v[240:243]
s_add_u32 m0, s20, 32768
ds_read_b64_tr_b16 v[104:105], v21 offset:36864
v_mfma_f32_16x16x32_bf16 v[240:243], a[232:235], a[124:127], v[240:243]
buffer_load_dwordx4 v6, s[24:27], s48 offen offset:0 nt lds
v_mfma_f32_16x16x32_bf16 v[240:243], a[228:231], a[120:123], v[240:243]
ds_read_b64_tr_b16 v[106:107], v21 offset:37376
v_mfma_f32_16x16x32_bf16 v[144:147], a[244:247], a[144:147], v[144:147]
v_cvt_pk_bf16_f32 v66, v56, v57
v_mfma_f32_16x16x32_bf16 v[144:147], a[248:251], a[148:151], v[144:147]
v_lshlrev_b32 v56, 16, v66
v_mfma_f32_16x16x32_bf16 v[152:155], a[248:251], a[152:155], v[152:155]
buffer_load_dwordx4 v8, s[24:27], s48 offen offset:2048 nt lds
v_mfma_f32_16x16x32_bf16 v[152:155], a[244:247], a[148:151], v[152:155]
v_and_b32 v57, 0xffff0000, v66
v_mfma_f32_16x16x32_bf16 v[152:155], a[240:243], a[144:147], v[152:155]
v_fma_f32 v62, -v60, v56, v62
v_mfma_f32_16x16x32_bf16 v[160:163], a[240:243], a[148:151], v[160:163]
v_fma_f32 v63, -v61, v57, v63
v_mfma_f32_16x16x32_bf16 v[160:163], a[244:247], a[152:155], v[160:163]
buffer_load_dwordx4 v7, s[24:27], s48 offen offset:1024 nt lds
s_waitcnt lgkmcnt(1)
v_mfma_f32_16x16x32_bf16 v[160:163], a[248:251], a[156:159], v[160:163]
v_mul_f32 v56, s50, v56
v_mfma_f32_16x16x32_bf16 v[168:171], a[248:251], a[160:163], v[168:171]
v_mul_f32 v57, s50, v57
v_mfma_f32_16x16x32_bf16 v[168:171], a[244:247], a[156:159], v[168:171]
v_mul_f32 v62, s50, v62
v_mfma_f32_16x16x32_bf16 v[168:171], a[240:243], a[152:155], v[168:171]
buffer_load_dwordx4 v9, s[24:27], s48 offen offset:3072 nt lds
v_mfma_f32_16x16x32_bf16 v[176:179], a[240:243], a[156:159], v[176:179]
v_mul_f32 v63, s50, v63
v_mfma_f32_16x16x32_bf16 v[176:179], a[244:247], a[160:163], v[176:179]
s_addk_i32 s49, 128
ds_write_b64 v49, v[56:57]
v_mfma_f32_16x16x32_bf16 v[176:179], a[248:251], a[164:167], v[176:179]
s_waitcnt vmcnt(11) lgkmcnt(1)
s_barrier
s_add_u32 m0, s100, 32768
v_mfma_f32_16x16x32_bf16 v[184:187], a[248:251], a[168:171], v[184:187]
buffer_load_dwordx4 v6, s[24:27], s49 offen offset:0 nt lds
v_mfma_f32_16x16x32_bf16 v[184:187], a[244:247], a[164:167], v[184:187]
ds_write_b64 v49, v[62:63] offset:512
v_mfma_f32_16x16x32_bf16 v[184:187], a[240:243], a[160:163], v[184:187]
v_mfma_f32_16x16x32_bf16 v[192:195], a[240:243], a[164:167], v[192:195]
ds_read_b64_tr_b16 v[112:113], v23 offset:49152
v_mfma_f32_16x16x32_bf16 v[192:195], a[244:247], a[168:171], v[192:195]
buffer_load_dwordx4 v8, s[24:27], s49 offen offset:2048 nt lds
v_mfma_f32_16x16x32_bf16 v[192:195], a[248:251], a[172:175], v[192:195]
ds_read_b64_tr_b16 v[114:115], v23 offset:49664
v_mfma_f32_16x16x32_bf16 v[200:203], a[248:251], a[176:179], v[200:203]
ds_read_b64_tr_b16 v[116:117], v24 offset:49152
v_mfma_f32_16x16x32_bf16 v[200:203], a[244:247], a[172:175], v[200:203]
ds_read_b64_tr_b16 v[118:119], v24 offset:49664
v_mfma_f32_16x16x32_bf16 v[200:203], a[240:243], a[168:171], v[200:203]
buffer_load_dwordx4 v7, s[24:27], s49 offen offset:1024 nt lds
v_mfma_f32_16x16x32_bf16 v[204:207], a[252:255], a[168:171], v[204:207]
ds_read_b64_tr_b16 v[108:109], v22 offset:49152
v_mfma_f32_16x16x32_bf16 v[204:207], v[100:103], a[172:175], v[204:207]
ds_read_b64_tr_b16 v[110:111], v22 offset:49664
v_mfma_f32_16x16x32_bf16 v[204:207], v[104:107], a[176:179], v[204:207]
v_mfma_f32_16x16x32_bf16 v[196:199], v[104:107], a[172:175], v[196:199]
buffer_load_dwordx4 v9, s[24:27], s49 offen offset:3072 nt lds
v_mfma_f32_16x16x32_bf16 v[196:199], v[100:103], a[168:171], v[196:199]
v_mfma_f32_16x16x32_bf16 v[196:199], a[252:255], a[164:167], v[196:199]
v_mfma_f32_16x16x32_bf16 v[188:191], a[252:255], a[160:163], v[188:191]
v_mfma_f32_16x16x32_bf16 v[188:191], v[100:103], a[164:167], v[188:191]
v_mfma_f32_16x16x32_bf16 v[188:191], v[104:107], a[168:171], v[188:191]
v_mfma_f32_16x16x32_bf16 v[180:183], v[104:107], a[164:167], v[180:183]
v_mfma_f32_16x16x32_bf16 v[180:183], v[100:103], a[160:163], v[180:183]
v_mfma_f32_16x16x32_bf16 v[180:183], a[252:255], a[156:159], v[180:183]
v_mfma_f32_16x16x32_bf16 v[172:175], a[252:255], a[152:155], v[172:175]
v_mfma_f32_16x16x32_bf16 v[172:175], v[100:103], a[156:159], v[172:175]
v_mfma_f32_16x16x32_bf16 v[172:175], v[104:107], a[160:163], v[172:175]
v_mfma_f32_16x16x32_bf16 v[164:167], v[104:107], a[156:159], v[164:167]
v_mfma_f32_16x16x32_bf16 v[164:167], v[100:103], a[152:155], v[164:167]
v_mfma_f32_16x16x32_bf16 v[164:167], a[252:255], a[148:151], v[164:167]
ds_read_b64_tr_b16 v[120:121], v25 offset:49152
v_mfma_f32_16x16x32_bf16 v[156:159], a[252:255], a[144:147], v[156:159]
ds_read_b64_tr_b16 v[122:123], v25 offset:49664
v_mfma_f32_16x16x32_bf16 v[156:159], v[100:103], a[148:151], v[156:159]
ds_read_b64_tr_b16 v[124:125], v26 offset:49152
v_mfma_f32_16x16x32_bf16 v[156:159], v[104:107], a[152:155], v[156:159]
ds_read_b64_tr_b16 v[126:127], v26 offset:49664
v_mfma_f32_16x16x32_bf16 v[148:151], v[104:107], a[148:151], v[148:151]
ds_read_b64_tr_b16 v[128:129], v27 offset:49152
v_mfma_f32_16x16x32_bf16 v[148:151], v[100:103], a[144:147], v[148:151]
ds_read_b64_tr_b16 v[130:131], v27 offset:49664
s_waitcnt lgkmcnt(6)
v_mfma_f32_16x16x32_bf16 v[208:211], v[112:115], a[144:147], v[208:211]
v_mfma_f32_16x16x32_bf16 v[208:211], v[116:119], a[148:151], v[208:211]
v_mfma_f32_16x16x32_bf16 v[212:215], v[116:119], a[152:155], v[212:215]
s_waitcnt vmcnt(9)
s_barrier
v_mfma_f32_16x16x32_bf16 v[212:215], v[112:115], a[148:151], v[212:215]
s_addk_i32 s53, 28672
v_mfma_f32_16x16x32_bf16 v[212:215], v[108:111], a[144:147], v[212:215]
s_add_u32 m0, s21, 122880
ds_read_b64_tr_b16 v[136:137], v17 offset:0
v_mfma_f32_16x16x32_bf16 v[216:219], v[108:111], a[148:151], v[216:219]
buffer_load_dwordx4 v10, s[28:31], s53 offen offset:0  lds
v_mfma_f32_16x16x32_bf16 v[216:219], v[112:115], a[152:155], v[216:219]
ds_read_b64_tr_b16 v[138:139], v17 offset:512
v_mfma_f32_16x16x32_bf16 v[216:219], v[116:119], a[156:159], v[216:219]
ds_read_b128 a[180:183], v35 offset:0
v_mfma_f32_16x16x32_bf16 v[220:223], v[116:119], a[160:163], v[220:223]
ds_read_b64_tr_b16 v[140:141], v18 offset:0
v_mfma_f32_16x16x32_bf16 v[220:223], v[112:115], a[156:159], v[220:223]
ds_read_b64_tr_b16 v[142:143], v18 offset:512
v_mfma_f32_16x16x32_bf16 v[220:223], v[108:111], a[152:155], v[220:223]
ds_read_b128 a[184:187], v35 offset:2048
v_mfma_f32_16x16x32_bf16 v[224:227], v[108:111], a[156:159], v[224:227]
ds_read_b128 a[188:191], v35 offset:4096
v_mfma_f32_16x16x32_bf16 v[224:227], v[112:115], a[160:163], v[224:227]
ds_read_b64_tr_b16 v[132:133], v16 offset:0
v_mfma_f32_16x16x32_bf16 v[224:227], v[116:119], a[164:167], v[224:227]
ds_read_b64_tr_b16 v[134:135], v16 offset:512
v_mfma_f32_16x16x32_bf16 v[228:231], v[116:119], a[168:171], v[228:231]
v_mfma_f32_16x16x32_bf16 v[228:231], v[112:115], a[164:167], v[228:231]
v_mfma_f32_16x16x32_bf16 v[228:231], v[108:111], a[160:163], v[228:231]
ds_read_b128 a[192:195], v35 offset:6144
v_mfma_f32_16x16x32_bf16 v[232:235], v[108:111], a[164:167], v[232:235]
ds_read_b128 a[196:199], v35 offset:8192
v_mfma_f32_16x16x32_bf16 v[232:235], v[112:115], a[168:171], v[232:235]
v_mfma_f32_16x16x32_bf16 v[232:235], v[116:119], a[172:175], v[232:235]
v_mfma_f32_16x16x32_bf16 v[236:239], v[116:119], a[176:179], v[236:239]
v_mfma_f32_16x16x32_bf16 v[236:239], v[112:115], a[172:175], v[236:239]
v_mfma_f32_16x16x32_bf16 v[236:239], v[108:111], a[168:171], v[236:239]
ds_read_b128 a[200:203], v35 offset:10240
s_waitcnt lgkmcnt(3)
v_mfma_f32_16x16x32_bf16 v[252:255], v[120:123], a[168:171], v[252:255]
ds_read_b128 a[204:207], v35 offset:12288
v_mfma_f32_16x16x32_bf16 v[252:255], v[124:127], a[172:175], v[252:255]
buffer_load_dwordx4 v11, s[28:31], s53 offen offset:1024  lds
v_mfma_f32_16x16x32_bf16 v[252:255], v[128:131], a[176:179], v[252:255]
ds_read_b128 a[208:211], v35 offset:14336
v_mfma_f32_16x16x32_bf16 v[248:251], v[128:131], a[172:175], v[248:251]
ds_read_b128 a[212:215], v39 offset:0
v_mfma_f32_16x16x32_bf16 v[248:251], v[124:127], a[168:171], v[248:251]
ds_read_b64_tr_b16 a[216:217], v19 offset:0
v_mfma_f32_16x16x32_bf16 v[248:251], v[120:123], a[164:167], v[248:251]
buffer_load_dwordx4 v12, s[28:31], s53 offen offset:2048  lds
v_mfma_f32_16x16x32_bf16 v[244:247], v[120:123], a[160:163], v[244:247]
ds_read_b64_tr_b16 a[218:219], v19 offset:512
v_mfma_f32_16x16x32_bf16 v[244:247], v[124:127], a[164:167], v[244:247]
ds_read_b64_tr_b16 a[220:221], v20 offset:0
v_mfma_f32_16x16x32_bf16 v[244:247], v[128:131], a[168:171], v[244:247]
s_addk_i32 m0, 12288
ds_read_b64_tr_b16 a[222:223], v20 offset:512
v_mfma_f32_16x16x32_bf16 v[240:243], v[128:131], a[164:167], v[240:243]
buffer_load_dwordx4 v13, s[28:31], s53 offen offset:0  lds
v_mfma_f32_16x16x32_bf16 v[240:243], v[124:127], a[160:163], v[240:243]
ds_read_b64_tr_b16 a[224:225], v21 offset:0
v_mfma_f32_16x16x32_bf16 v[240:243], v[120:123], a[156:159], v[240:243]
ds_read_b64_tr_b16 a[226:227], v21 offset:512
v_mfma_f32_16x16x32_bf16 v[144:147], v[136:139], a[180:183], v[144:147]
v_mfma_f32_16x16x32_bf16 v[144:147], v[140:143], a[184:187], v[144:147]
buffer_load_dwordx4 v14, s[28:31], s53 offen offset:1024  lds
v_mfma_f32_16x16x32_bf16 v[152:155], v[140:143], a[188:191], v[152:155]
v_mfma_f32_16x16x32_bf16 v[152:155], v[136:139], a[184:187], v[152:155]
v_mfma_f32_16x16x32_bf16 v[152:155], v[132:135], a[180:183], v[152:155]
v_mfma_f32_16x16x32_bf16 v[160:163], v[132:135], a[184:187], v[160:163]
buffer_load_dwordx4 v15, s[28:31], s53 offen offset:2048  lds
v_mfma_f32_16x16x32_bf16 v[160:163], v[136:139], a[188:191], v[160:163]
s_waitcnt lgkmcnt(2)
v_mfma_f32_16x16x32_bf16 v[160:163], v[140:143], a[192:195], v[160:163]
v_mfma_f32_16x16x32_bf16 v[168:171], v[140:143], a[196:199], v[168:171]
v_mfma_f32_16x16x32_bf16 v[168:171], v[136:139], a[192:195], v[168:171]
v_mfma_f32_16x16x32_bf16 v[168:171], v[132:135], a[188:191], v[168:171]
v_mfma_f32_16x16x32_bf16 v[176:179], v[132:135], a[192:195], v[176:179]
v_mfma_f32_16x16x32_bf16 v[176:179], v[136:139], a[196:199], v[176:179]
v_mfma_f32_16x16x32_bf16 v[176:179], v[140:143], a[200:203], v[176:179]
v_mfma_f32_16x16x32_bf16 v[184:187], v[140:143], a[204:207], v[184:187]
v_mfma_f32_16x16x32_bf16 v[184:187], v[136:139], a[200:203], v[184:187]
v_mfma_f32_16x16x32_bf16 v[184:187], v[132:135], a[196:199], v[184:187]
v_mfma_f32_16x16x32_bf16 v[192:195], v[132:135], a[200:203], v[192:195]
v_mfma_f32_16x16x32_bf16 v[192:195], v[136:139], a[204:207], v[192:195]
ds_read_b64_tr_b16 a[232:233], v23 offset:12288
v_mfma_f32_16x16x32_bf16 v[192:195], v[140:143], a[208:211], v[192:195]
ds_read_b64_tr_b16 a[234:235], v23 offset:12800
v_mfma_f32_16x16x32_bf16 v[200:203], v[140:143], a[212:215], v[200:203]
ds_read_b64_tr_b16 a[236:237], v24 offset:12288
v_mfma_f32_16x16x32_bf16 v[200:203], v[136:139], a[208:211], v[200:203]
ds_read_b64_tr_b16 a[238:239], v24 offset:12800
v_mfma_f32_16x16x32_bf16 v[200:203], v[132:135], a[204:207], v[200:203]
v_mfma_f32_16x16x32_bf16 v[204:207], a[216:219], a[204:207], v[204:207]
ds_read_b64_tr_b16 a[228:229], v22 offset:12288
v_mfma_f32_16x16x32_bf16 v[204:207], a[220:223], a[208:211], v[204:207]
ds_read_b64_tr_b16 a[230:231], v22 offset:12800
s_waitcnt lgkmcnt(6)
v_mfma_f32_16x16x32_bf16 v[204:207], a[224:227], a[212:215], v[204:207]
v_mfma_f32_16x16x32_bf16 v[196:199], a[224:227], a[208:211], v[196:199]
v_mfma_f32_16x16x32_bf16 v[196:199], a[220:223], a[204:207], v[196:199]
v_mfma_f32_16x16x32_bf16 v[196:199], a[216:219], a[200:203], v[196:199]
v_mfma_f32_16x16x32_bf16 v[188:191], a[216:219], a[196:199], v[188:191]
v_mfma_f32_16x16x32_bf16 v[188:191], a[220:223], a[200:203], v[188:191]
v_mfma_f32_16x16x32_bf16 v[188:191], a[224:227], a[204:207], v[188:191]
v_mfma_f32_16x16x32_bf16 v[180:183], a[224:227], a[200:203], v[180:183]
v_mfma_f32_16x16x32_bf16 v[180:183], a[220:223], a[196:199], v[180:183]
v_mfma_f32_16x16x32_bf16 v[180:183], a[216:219], a[192:195], v[180:183]
v_mfma_f32_16x16x32_bf16 v[172:175], a[216:219], a[188:191], v[172:175]
v_mfma_f32_16x16x32_bf16 v[172:175], a[220:223], a[192:195], v[172:175]
v_mfma_f32_16x16x32_bf16 v[172:175], a[224:227], a[196:199], v[172:175]
v_mfma_f32_16x16x32_bf16 v[164:167], a[224:227], a[192:195], v[164:167]
v_mfma_f32_16x16x32_bf16 v[164:167], a[220:223], a[188:191], v[164:167]
v_mfma_f32_16x16x32_bf16 v[164:167], a[216:219], a[184:187], v[164:167]
ds_read_b64_tr_b16 a[240:241], v25 offset:12288
v_mfma_f32_16x16x32_bf16 v[156:159], a[216:219], a[180:183], v[156:159]
ds_read_b64_tr_b16 a[242:243], v25 offset:12800
v_mfma_f32_16x16x32_bf16 v[156:159], a[220:223], a[184:187], v[156:159]
ds_read_b64_tr_b16 a[244:245], v26 offset:12288
v_mfma_f32_16x16x32_bf16 v[156:159], a[224:227], a[188:191], v[156:159]
ds_read_b64_tr_b16 a[246:247], v26 offset:12800
v_mfma_f32_16x16x32_bf16 v[148:151], a[224:227], a[184:187], v[148:151]
ds_read_b64_tr_b16 a[248:249], v27 offset:12288
v_mfma_f32_16x16x32_bf16 v[148:151], a[220:223], a[180:183], v[148:151]
ds_read_b64_tr_b16 a[250:251], v27 offset:12800
s_waitcnt lgkmcnt(6)
v_mfma_f32_16x16x32_bf16 v[208:211], a[232:235], a[180:183], v[208:211]
v_mfma_f32_16x16x32_bf16 v[208:211], a[236:239], a[184:187], v[208:211]
v_mfma_f32_16x16x32_bf16 v[212:215], a[236:239], a[188:191], v[212:215]
s_waitcnt vmcnt(0)
s_barrier
ds_read_b64_tr_b16 v[100:101], v17 offset:24576
v_mfma_f32_16x16x32_bf16 v[212:215], a[232:235], a[184:187], v[212:215]
s_addk_i32 s53, 28672
ds_read_b64_tr_b16 v[102:103], v17 offset:25088
v_mfma_f32_16x16x32_bf16 v[212:215], a[228:231], a[180:183], v[212:215]
s_addk_i32 m0, 12288
ds_read_b128 a[0:3], v34 offset:32768
v_mfma_f32_16x16x32_bf16 v[216:219], a[228:231], a[184:187], v[216:219]
buffer_load_dwordx4 v10, s[28:31], s53 offen offset:0  lds
v_mfma_f32_16x16x32_bf16 v[216:219], a[232:235], a[188:191], v[216:219]
ds_read_b64_tr_b16 v[104:105], v18 offset:24576
v_mfma_f32_16x16x32_bf16 v[216:219], a[236:239], a[192:195], v[216:219]
ds_read_b64_tr_b16 v[106:107], v18 offset:25088
v_mfma_f32_16x16x32_bf16 v[220:223], a[236:239], a[196:199], v[220:223]
ds_read_b128 a[4:7], v34 offset:34816
v_mfma_f32_16x16x32_bf16 v[220:223], a[232:235], a[192:195], v[220:223]
buffer_load_dwordx4 v11, s[28:31], s53 offen offset:1024  lds
v_mfma_f32_16x16x32_bf16 v[220:223], a[228:231], a[188:191], v[220:223]
ds_read_b128 a[8:11], v34 offset:36864
v_mfma_f32_16x16x32_bf16 v[224:227], a[228:231], a[192:195], v[224:227]
ds_read_b64_tr_b16 a[252:253], v16 offset:24576
v_mfma_f32_16x16x32_bf16 v[224:227], a[232:235], a[196:199], v[224:227]
ds_read_b64_tr_b16 a[254:255], v16 offset:25088
v_mfma_f32_16x16x32_bf16 v[224:227], a[236:239], a[200:203], v[224:227]
buffer_load_dwordx4 v12, s[28:31], s53 offen offset:2048  lds
v_mfma_f32_16x16x32_bf16 v[228:231], a[236:239], a[204:207], v[228:231]
v_mfma_f32_16x16x32_bf16 v[228:231], a[232:235], a[200:203], v[228:231]
ds_read_b128 a[12:15], v34 offset:38912
v_mfma_f32_16x16x32_bf16 v[228:231], a[228:231], a[196:199], v[228:231]
s_add_u32 m0, s21, 98304
ds_read_b128 a[16:19], v34 offset:40960
v_mfma_f32_16x16x32_bf16 v[232:235], a[228:231], a[200:203], v[232:235]
buffer_load_dwordx4 v13, s[28:31], s53 offen offset:0  lds
v_mfma_f32_16x16x32_bf16 v[232:235], a[232:235], a[204:207], v[232:235]
v_mfma_f32_16x16x32_bf16 v[232:235], a[236:239], a[208:211], v[232:235]
v_mfma_f32_16x16x32_bf16 v[236:239], a[236:239], a[212:215], v[236:239]
v_mfma_f32_16x16x32_bf16 v[236:239], a[232:235], a[208:211], v[236:239]
buffer_load_dwordx4 v14, s[28:31], s53 offen offset:1024  lds
v_mfma_f32_16x16x32_bf16 v[236:239], a[228:231], a[204:207], v[236:239]
ds_read_b128 a[20:23], v34 offset:43008
s_waitcnt lgkmcnt(3)
v_mfma_f32_16x16x32_bf16 v[252:255], a[240:243], a[204:207], v[252:255]
ds_read_b128 a[24:27], v34 offset:45056
v_mfma_f32_16x16x32_bf16 v[252:255], a[244:247], a[208:211], v[252:255]
ds_read_b128 a[28:31], v34 offset:47104
v_mfma_f32_16x16x32_bf16 v[252:255], a[248:251], a[212:215], v[252:255]
buffer_load_dwordx4 v15, s[28:31], s53 offen offset:2048  lds
v_mfma_f32_16x16x32_bf16 v[248:251], a[248:251], a[208:211], v[248:251]
ds_read_b128 a[32:35], v38 offset:32768
v_mfma_f32_16x16x32_bf16 v[248:251], a[244:247], a[204:207], v[248:251]
ds_read_b64_tr_b16 v[108:109], v19 offset:24576
v_mfma_f32_16x16x32_bf16 v[248:251], a[240:243], a[200:203], v[248:251]
s_mov_b32 s55, 229376
ds_read_b64_tr_b16 v[110:111], v19 offset:25088
v_mfma_f32_16x16x32_bf16 v[244:247], a[240:243], a[196:199], v[244:247]
buffer_load_dword v2, v50, s[28:31], s55 offen
v_mfma_f32_16x16x32_bf16 v[244:247], a[244:247], a[200:203], v[244:247]
ds_read_b64_tr_b16 v[112:113], v20 offset:24576
v_mfma_f32_16x16x32_bf16 v[244:247], a[248:251], a[204:207], v[244:247]
s_addk_i32 s48, 128
ds_read_b64_tr_b16 v[114:115], v20 offset:25088
v_mfma_f32_16x16x32_bf16 v[240:243], a[248:251], a[200:203], v[240:243]
s_add_u32 m0, s20, 65536
ds_read_b64_tr_b16 v[116:117], v21 offset:24576
v_mfma_f32_16x16x32_bf16 v[240:243], a[244:247], a[196:199], v[240:243]
buffer_load_dwordx4 v6, s[24:27], s48 offen offset:0 nt lds
v_mfma_f32_16x16x32_bf16 v[240:243], a[240:243], a[192:195], v[240:243]
ds_read_b64_tr_b16 v[118:119], v21 offset:25088
v_mfma_f32_16x16x32_bf16 v[144:147], v[100:103], a[0:3], v[144:147]
v_mfma_f32_16x16x32_bf16 v[144:147], v[104:107], a[4:7], v[144:147]
v_mfma_f32_16x16x32_bf16 v[152:155], v[104:107], a[8:11], v[152:155]
buffer_load_dwordx4 v8, s[24:27], s48 offen offset:2048 nt lds
v_mfma_f32_16x16x32_bf16 v[152:155], v[100:103], a[4:7], v[152:155]
v_mfma_f32_16x16x32_bf16 v[152:155], a[252:255], a[0:3], v[152:155]
v_mfma_f32_16x16x32_bf16 v[160:163], a[252:255], a[4:7], v[160:163]
v_mfma_f32_16x16x32_bf16 v[160:163], v[100:103], a[8:11], v[160:163]
buffer_load_dwordx4 v7, s[24:27], s48 offen offset:1024 nt lds
s_waitcnt lgkmcnt(1)
v_mfma_f32_16x16x32_bf16 v[160:163], v[104:107], a[12:15], v[160:163]
v_mfma_f32_16x16x32_bf16 v[168:171], v[104:107], a[16:19], v[168:171]
v_mfma_f32_16x16x32_bf16 v[168:171], v[100:103], a[12:15], v[168:171]
v_mfma_f32_16x16x32_bf16 v[168:171], a[252:255], a[8:11], v[168:171]
buffer_load_dwordx4 v9, s[24:27], s48 offen offset:3072 nt lds
v_mfma_f32_16x16x32_bf16 v[176:179], a[252:255], a[12:15], v[176:179]
v_mfma_f32_16x16x32_bf16 v[176:179], v[100:103], a[16:19], v[176:179]
s_addk_i32 s49, 128
v_mfma_f32_16x16x32_bf16 v[176:179], v[104:107], a[20:23], v[176:179]
s_add_u32 m0, s100, 65536
v_mfma_f32_16x16x32_bf16 v[184:187], v[104:107], a[24:27], v[184:187]
buffer_load_dwordx4 v6, s[24:27], s49 offen offset:0 nt lds
v_mfma_f32_16x16x32_bf16 v[184:187], v[100:103], a[20:23], v[184:187]
v_mfma_f32_16x16x32_bf16 v[184:187], a[252:255], a[16:19], v[184:187]
v_mfma_f32_16x16x32_bf16 v[192:195], a[252:255], a[20:23], v[192:195]
ds_read_b64_tr_b16 v[124:125], v23 offset:36864
v_mfma_f32_16x16x32_bf16 v[192:195], v[100:103], a[24:27], v[192:195]
buffer_load_dwordx4 v8, s[24:27], s49 offen offset:2048 nt lds
v_mfma_f32_16x16x32_bf16 v[192:195], v[104:107], a[28:31], v[192:195]
ds_read_b64_tr_b16 v[126:127], v23 offset:37376
v_mfma_f32_16x16x32_bf16 v[200:203], v[104:107], a[32:35], v[200:203]
ds_read_b64_tr_b16 v[128:129], v24 offset:36864
v_mfma_f32_16x16x32_bf16 v[200:203], v[100:103], a[28:31], v[200:203]
ds_read_b64_tr_b16 v[130:131], v24 offset:37376
v_mfma_f32_16x16x32_bf16 v[200:203], a[252:255], a[24:27], v[200:203]
buffer_load_dwordx4 v7, s[24:27], s49 offen offset:1024 nt lds
v_mfma_f32_16x16x32_bf16 v[204:207], v[108:111], a[24:27], v[204:207]
ds_read_b64_tr_b16 v[120:121], v22 offset:36864
v_mfma_f32_16x16x32_bf16 v[204:207], v[112:115], a[28:31], v[204:207]
ds_read_b64_tr_b16 v[122:123], v22 offset:37376
s_waitcnt lgkmcnt(6)
v_mfma_f32_16x16x32_bf16 v[204:207], v[116:119], a[32:35], v[204:207]
v_mfma_f32_16x16x32_bf16 v[196:199], v[116:119], a[28:31], v[196:199]
buffer_load_dwordx4 v9, s[24:27], s49 offen offset:3072 nt lds
v_mfma_f32_16x16x32_bf16 v[196:199], v[112:115], a[24:27], v[196:199]
v_mfma_f32_16x16x32_bf16 v[196:199], v[108:111], a[20:23], v[196:199]
v_mfma_f32_16x16x32_bf16 v[188:191], v[108:111], a[16:19], v[188:191]
v_mfma_f32_16x16x32_bf16 v[188:191], v[112:115], a[20:23], v[188:191]
v_mfma_f32_16x16x32_bf16 v[188:191], v[116:119], a[24:27], v[188:191]
v_mfma_f32_16x16x32_bf16 v[180:183], v[116:119], a[20:23], v[180:183]
v_mfma_f32_16x16x32_bf16 v[180:183], v[112:115], a[16:19], v[180:183]
v_mfma_f32_16x16x32_bf16 v[180:183], v[108:111], a[12:15], v[180:183]
v_mfma_f32_16x16x32_bf16 v[172:175], v[108:111], a[8:11], v[172:175]
v_mfma_f32_16x16x32_bf16 v[172:175], v[112:115], a[12:15], v[172:175]
v_mfma_f32_16x16x32_bf16 v[172:175], v[116:119], a[16:19], v[172:175]
v_mfma_f32_16x16x32_bf16 v[164:167], v[116:119], a[12:15], v[164:167]
v_mfma_f32_16x16x32_bf16 v[164:167], v[112:115], a[8:11], v[164:167]
v_mfma_f32_16x16x32_bf16 v[164:167], v[108:111], a[4:7], v[164:167]
ds_read_b64_tr_b16 v[132:133], v25 offset:36864
v_mfma_f32_16x16x32_bf16 v[156:159], v[108:111], a[0:3], v[156:159]
ds_read_b64_tr_b16 v[134:135], v25 offset:37376
v_mfma_f32_16x16x32_bf16 v[156:159], v[112:115], a[4:7], v[156:159]
ds_read_b64_tr_b16 v[136:137], v26 offset:36864
v_mfma_f32_16x16x32_bf16 v[156:159], v[116:119], a[8:11], v[156:159]
ds_read_b64_tr_b16 v[138:139], v26 offset:37376
v_mfma_f32_16x16x32_bf16 v[148:151], v[116:119], a[4:7], v[148:151]
ds_read_b64_tr_b16 v[140:141], v27 offset:36864
v_mfma_f32_16x16x32_bf16 v[148:151], v[112:115], a[0:3], v[148:151]
ds_read_b64_tr_b16 v[142:143], v27 offset:37376
s_waitcnt lgkmcnt(6)
v_mfma_f32_16x16x32_bf16 v[208:211], v[124:127], a[0:3], v[208:211]
v_mfma_f32_16x16x32_bf16 v[208:211], v[128:131], a[4:7], v[208:211]
v_mfma_f32_16x16x32_bf16 v[212:215], v[128:131], a[8:11], v[212:215]
s_waitcnt vmcnt(9)
s_barrier
v_mfma_f32_16x16x32_bf16 v[212:215], v[124:127], a[4:7], v[212:215]
s_addk_i32 s53, 28672
v_mfma_f32_16x16x32_bf16 v[212:215], v[120:123], a[0:3], v[212:215]
s_add_u32 m0, s21, 110592
ds_read_b64_tr_b16 a[220:221], v17 offset:49152
v_mfma_f32_16x16x32_bf16 v[216:219], v[120:123], a[4:7], v[216:219]
buffer_load_dwordx4 v10, s[28:31], s53 offen offset:0  lds
v_mfma_f32_16x16x32_bf16 v[216:219], v[124:127], a[8:11], v[216:219]
ds_read_b64_tr_b16 a[222:223], v17 offset:49664
v_mfma_f32_16x16x32_bf16 v[216:219], v[128:131], a[12:15], v[216:219]
ds_read_b128 a[36:39], v35 offset:32768
v_mfma_f32_16x16x32_bf16 v[220:223], v[128:131], a[16:19], v[220:223]
ds_read_b64_tr_b16 a[224:225], v18 offset:49152
v_mfma_f32_16x16x32_bf16 v[220:223], v[124:127], a[12:15], v[220:223]
ds_read_b64_tr_b16 a[226:227], v18 offset:49664
v_mfma_f32_16x16x32_bf16 v[220:223], v[120:123], a[8:11], v[220:223]
ds_read_b128 a[40:43], v35 offset:34816
v_mfma_f32_16x16x32_bf16 v[224:227], v[120:123], a[12:15], v[224:227]
ds_read_b128 a[44:47], v35 offset:36864
v_mfma_f32_16x16x32_bf16 v[224:227], v[124:127], a[16:19], v[224:227]
ds_read_b64_tr_b16 a[216:217], v16 offset:49152
v_mfma_f32_16x16x32_bf16 v[224:227], v[128:131], a[20:23], v[224:227]
ds_read_b64_tr_b16 a[218:219], v16 offset:49664
v_mfma_f32_16x16x32_bf16 v[228:231], v[128:131], a[24:27], v[228:231]
v_mfma_f32_16x16x32_bf16 v[228:231], v[124:127], a[20:23], v[228:231]
v_mfma_f32_16x16x32_bf16 v[228:231], v[120:123], a[16:19], v[228:231]
ds_read_b128 a[48:51], v35 offset:38912
v_mfma_f32_16x16x32_bf16 v[232:235], v[120:123], a[20:23], v[232:235]
ds_read_b128 a[52:55], v35 offset:40960
v_mfma_f32_16x16x32_bf16 v[232:235], v[124:127], a[24:27], v[232:235]
v_mfma_f32_16x16x32_bf16 v[232:235], v[128:131], a[28:31], v[232:235]
v_mfma_f32_16x16x32_bf16 v[236:239], v[128:131], a[32:35], v[236:239]
v_mfma_f32_16x16x32_bf16 v[236:239], v[124:127], a[28:31], v[236:239]
v_mfma_f32_16x16x32_bf16 v[236:239], v[120:123], a[24:27], v[236:239]
ds_read_b128 a[56:59], v35 offset:43008
s_waitcnt lgkmcnt(3)
v_mfma_f32_16x16x32_bf16 v[252:255], v[132:135], a[24:27], v[252:255]
ds_read_b128 a[60:63], v35 offset:45056
v_mfma_f32_16x16x32_bf16 v[252:255], v[136:139], a[28:31], v[252:255]
buffer_load_dwordx4 v11, s[28:31], s53 offen offset:1024  lds
v_mfma_f32_16x16x32_bf16 v[252:255], v[140:143], a[32:35], v[252:255]
ds_read_b128 a[64:67], v35 offset:47104
v_mfma_f32_16x16x32_bf16 v[248:251], v[140:143], a[28:31], v[248:251]
ds_read_b128 a[68:71], v39 offset:32768
v_mfma_f32_16x16x32_bf16 v[248:251], v[136:139], a[24:27], v[248:251]
ds_read_b64_tr_b16 a[228:229], v19 offset:49152
v_mfma_f32_16x16x32_bf16 v[248:251], v[132:135], a[20:23], v[248:251]
buffer_load_dwordx4 v12, s[28:31], s53 offen offset:2048  lds
v_mfma_f32_16x16x32_bf16 v[244:247], v[132:135], a[16:19], v[244:247]
ds_read_b64_tr_b16 a[230:231], v19 offset:49664
v_mfma_f32_16x16x32_bf16 v[244:247], v[136:139], a[20:23], v[244:247]
s_addk_i32 s53, 28672
ds_read_b64_tr_b16 a[232:233], v20 offset:49152
v_mfma_f32_16x16x32_bf16 v[244:247], v[140:143], a[24:27], v[244:247]
s_addk_i32 m0, 12288
ds_read_b64_tr_b16 a[234:235], v20 offset:49664
v_mfma_f32_16x16x32_bf16 v[240:243], v[140:143], a[20:23], v[240:243]
buffer_load_dwordx4 v10, s[28:31], s53 offen offset:0  lds
v_mfma_f32_16x16x32_bf16 v[240:243], v[136:139], a[16:19], v[240:243]
ds_read_b64_tr_b16 a[236:237], v21 offset:49152
v_mfma_f32_16x16x32_bf16 v[240:243], v[132:135], a[12:15], v[240:243]
ds_read_b64_tr_b16 a[238:239], v21 offset:49664
v_mfma_f32_16x16x32_bf16 v[144:147], a[220:223], a[36:39], v[144:147]
v_mfma_f32_16x16x32_bf16 v[144:147], a[224:227], a[40:43], v[144:147]
buffer_load_dwordx4 v11, s[28:31], s53 offen offset:1024  lds
v_mfma_f32_16x16x32_bf16 v[152:155], a[224:227], a[44:47], v[152:155]
v_mfma_f32_16x16x32_bf16 v[152:155], a[220:223], a[40:43], v[152:155]
v_mfma_f32_16x16x32_bf16 v[152:155], a[216:219], a[36:39], v[152:155]
v_mfma_f32_16x16x32_bf16 v[160:163], a[216:219], a[40:43], v[160:163]
buffer_load_dwordx4 v12, s[28:31], s53 offen offset:2048  lds
v_mfma_f32_16x16x32_bf16 v[160:163], a[220:223], a[44:47], v[160:163]
s_waitcnt lgkmcnt(2)
v_mfma_f32_16x16x32_bf16 v[160:163], a[224:227], a[48:51], v[160:163]
v_mfma_f32_16x16x32_bf16 v[168:171], a[224:227], a[52:55], v[168:171]
s_mov_b32 s55, 286720
v_mfma_f32_16x16x32_bf16 v[168:171], a[220:223], a[48:51], v[168:171]
buffer_load_dword v3, v50, s[28:31], s55 offen
v_mfma_f32_16x16x32_bf16 v[168:171], a[216:219], a[44:47], v[168:171]
v_mfma_f32_16x16x32_bf16 v[176:179], a[216:219], a[48:51], v[176:179]
s_addk_i32 s48, 128
v_mfma_f32_16x16x32_bf16 v[176:179], a[220:223], a[52:55], v[176:179]
s_mov_b32 m0, s20
v_mfma_f32_16x16x32_bf16 v[176:179], a[224:227], a[56:59], v[176:179]
buffer_load_dwordx4 v6, s[24:27], s48 offen offset:0 nt lds
v_mfma_f32_16x16x32_bf16 v[184:187], a[224:227], a[60:63], v[184:187]
v_mfma_f32_16x16x32_bf16 v[184:187], a[220:223], a[56:59], v[184:187]
v_mfma_f32_16x16x32_bf16 v[184:187], a[216:219], a[52:55], v[184:187]
ds_read_b64_tr_b16 a[244:245], v23 offset:0
v_mfma_f32_16x16x32_bf16 v[192:195], a[216:219], a[56:59], v[192:195]
buffer_load_dwordx4 v8, s[24:27], s48 offen offset:2048 nt lds
v_mfma_f32_16x16x32_bf16 v[192:195], a[220:223], a[60:63], v[192:195]
ds_read_b64_tr_b16 a[246:247], v23 offset:512
v_mfma_f32_16x16x32_bf16 v[192:195], a[224:227], a[64:67], v[192:195]
L_pad1_2:
s_cbranch_execz L_body1
ds_read_b64_tr_b16 a[248:249], v24 offset:0
v_mfma_f32_16x16x32_bf16 v[200:203], a[224:227], a[68:71], v[200:203]
ds_read_b64_tr_b16 a[250:251], v24 offset:512
v_mfma_f32_16x16x32_bf16 v[200:203], a[220:223], a[64:67], v[200:203]
buffer_load_dwordx4 v7, s[24:27], s48 offen offset:1024 nt lds
v_mfma_f32_16x16x32_bf16 v[200:203], a[216:219], a[60:63], v[200:203]
v_mfma_f32_16x16x32_bf16 v[204:207], a[228:231], a[60:63], v[204:207]
ds_read_b64_tr_b16 a[240:241], v22 offset:0
v_mfma_f32_16x16x32_bf16 v[204:207], a[232:235], a[64:67], v[204:207]
ds_read_b64_tr_b16 a[242:243], v22 offset:512
s_waitcnt lgkmcnt(6)
v_mfma_f32_16x16x32_bf16 v[204:207], a[236:239], a[68:71], v[204:207]
buffer_load_dwordx4 v9, s[24:27], s48 offen offset:3072 nt lds
v_mfma_f32_16x16x32_bf16 v[196:199], a[236:239], a[64:67], v[196:199]
v_mfma_f32_16x16x32_bf16 v[196:199], a[232:235], a[60:63], v[196:199]
s_addk_i32 s49, 128
v_mfma_f32_16x16x32_bf16 v[196:199], a[228:231], a[56:59], v[196:199]
s_mov_b32 m0, s100
v_mfma_f32_16x16x32_bf16 v[188:191], a[228:231], a[52:55], v[188:191]
buffer_load_dwordx4 v6, s[24:27], s49 offen offset:0 nt lds
v_mfma_f32_16x16x32_bf16 v[188:191], a[232:235], a[56:59], v[188:191]
v_mfma_f32_16x16x32_bf16 v[188:191], a[236:239], a[60:63], v[188:191]
v_mfma_f32_16x16x32_bf16 v[180:183], a[236:239], a[56:59], v[180:183]
v_mfma_f32_16x16x32_bf16 v[180:183], a[232:235], a[52:55], v[180:183]
buffer_load_dwordx4 v8, s[24:27], s49 offen offset:2048 nt lds
v_mfma_f32_16x16x32_bf16 v[180:183], a[228:231], a[48:51], v[180:183]
v_mfma_f32_16x16x32_bf16 v[172:175], a[228:231], a[44:47], v[172:175]
v_mfma_f32_16x16x32_bf16 v[172:175], a[232:235], a[48:51], v[172:175]
v_mfma_f32_16x16x32_bf16 v[172:175], a[236:239], a[52:55], v[172:175]
buffer_load_dwordx4 v7, s[24:27], s49 offen offset:1024 nt lds
v_mfma_f32_16x16x32_bf16 v[164:167], a[236:239], a[48:51], v[164:167]
v_mfma_f32_16x16x32_bf16 v[164:167], a[232:235], a[44:47], v[164:167]
ds_read_b64_tr_b16 a[252:253], v25 offset:0
v_mfma_f32_16x16x32_bf16 v[164:167], a[228:231], a[40:43], v[164:167]
ds_read_b64_tr_b16 a[254:255], v25 offset:512
v_mfma_f32_16x16x32_bf16 v[156:159], a[228:231], a[36:39], v[156:159]
buffer_load_dwordx4 v9, s[24:27], s49 offen offset:3072 nt lds
v_mfma_f32_16x16x32_bf16 v[156:159], a[232:235], a[40:43], v[156:159]
ds_read_b64_tr_b16 v[100:101], v26 offset:0
v_mfma_f32_16x16x32_bf16 v[156:159], a[236:239], a[44:47], v[156:159]
ds_read_b64_tr_b16 v[102:103], v26 offset:512
v_mfma_f32_16x16x32_bf16 v[148:151], a[236:239], a[40:43], v[148:151]
ds_read_b64_tr_b16 v[104:105], v27 offset:0
v_mfma_f32_16x16x32_bf16 v[148:151], a[232:235], a[36:39], v[148:151]
ds_read_b64_tr_b16 v[106:107], v27 offset:512
s_waitcnt lgkmcnt(6)
v_mfma_f32_16x16x32_bf16 v[208:211], a[244:247], a[36:39], v[208:211]
v_mfma_f32_16x16x32_bf16 v[208:211], a[248:251], a[40:43], v[208:211]
v_mfma_f32_16x16x32_bf16 v[212:215], a[248:251], a[44:47], v[212:215]
s_waitcnt vmcnt(9)
s_barrier
ds_read_b64_tr_b16 v[116:117], v18 offset:12288
v_mfma_f32_16x16x32_bf16 v[212:215], a[244:247], a[40:43], v[212:215]
s_addk_i32 s53, 28672
ds_read_b64_tr_b16 v[118:119], v18 offset:12800
v_mfma_f32_16x16x32_bf16 v[212:215], a[240:243], a[36:39], v[212:215]
s_add_u32 m0, s21, 135168
ds_read_b128 a[104:107], v40 offset:0
v_mfma_f32_16x16x32_bf16 v[216:219], a[240:243], a[40:43], v[216:219]
buffer_load_dwordx4 v10, s[28:31], s53 offen offset:0  lds
v_mfma_f32_16x16x32_bf16 v[216:219], a[244:247], a[44:47], v[216:219]
ds_read_b64_tr_b16 v[112:113], v17 offset:12288
v_mfma_f32_16x16x32_bf16 v[216:219], a[248:251], a[48:51], v[216:219]
ds_read_b64_tr_b16 v[114:115], v17 offset:12800
v_mfma_f32_16x16x32_bf16 v[220:223], a[248:251], a[52:55], v[220:223]
ds_read_b128 a[100:103], v36 offset:14336
v_mfma_f32_16x16x32_bf16 v[220:223], a[244:247], a[48:51], v[220:223]
ds_read_b64_tr_b16 v[108:109], v16 offset:12288
v_mfma_f32_16x16x32_bf16 v[220:223], a[240:243], a[44:47], v[220:223]
ds_read_b64_tr_b16 v[110:111], v16 offset:12800
v_mfma_f32_16x16x32_bf16 v[224:227], a[240:243], a[48:51], v[224:227]
ds_read_b128 a[96:99], v36 offset:12288
v_mfma_f32_16x16x32_bf16 v[224:227], a[244:247], a[52:55], v[224:227]
ds_read_b128 a[92:95], v36 offset:10240
v_mfma_f32_16x16x32_bf16 v[224:227], a[248:251], a[56:59], v[224:227]
v_mfma_f32_16x16x32_bf16 v[228:231], a[248:251], a[60:63], v[228:231]
v_mfma_f32_16x16x32_bf16 v[228:231], a[244:247], a[56:59], v[228:231]
v_mfma_f32_16x16x32_bf16 v[228:231], a[240:243], a[52:55], v[228:231]
v_mfma_f32_16x16x32_bf16 v[232:235], a[240:243], a[56:59], v[232:235]
ds_read_b128 a[88:91], v36 offset:8192
v_mfma_f32_16x16x32_bf16 v[232:235], a[244:247], a[60:63], v[232:235]
ds_read_b128 a[84:87], v36 offset:6144
v_mfma_f32_16x16x32_bf16 v[232:235], a[248:251], a[64:67], v[232:235]
v_mfma_f32_16x16x32_bf16 v[236:239], a[248:251], a[68:71], v[236:239]
v_mfma_f32_16x16x32_bf16 v[236:239], a[244:247], a[64:67], v[236:239]
v_mfma_f32_16x16x32_bf16 v[236:239], a[240:243], a[60:63], v[236:239]
s_waitcnt lgkmcnt(2)
v_mfma_f32_16x16x32_bf16 v[252:255], a[252:255], a[60:63], v[252:255]
ds_read_b128 a[80:83], v36 offset:4096
v_mfma_f32_16x16x32_bf16 v[252:255], v[100:103], a[64:67], v[252:255]
ds_read_b128 a[76:79], v36 offset:2048
v_mfma_f32_16x16x32_bf16 v[252:255], v[104:107], a[68:71], v[252:255]
v_mfma_f32_16x16x32_bf16 v[248:251], v[104:107], a[64:67], v[248:251]
v_mfma_f32_16x16x32_bf16 v[248:251], v[100:103], a[60:63], v[248:251]
v_mfma_f32_16x16x32_bf16 v[248:251], a[252:255], a[56:59], v[248:251]
v_mfma_f32_16x16x32_bf16 v[244:247], a[252:255], a[52:55], v[244:247]
ds_read_b128 a[72:75], v36 offset:0
v_mfma_f32_16x16x32_bf16 v[244:247], v[100:103], a[56:59], v[244:247]
ds_read_b64_tr_b16 v[124:125], v20 offset:12288
v_mfma_f32_16x16x32_bf16 v[244:247], v[104:107], a[60:63], v[244:247]
ds_read_b64_tr_b16 v[126:127], v20 offset:12800
v_mfma_f32_16x16x32_bf16 v[240:243], v[104:107], a[56:59], v[240:243]
ds_read_b64_tr_b16 v[128:129], v21 offset:12288
v_mfma_f32_16x16x32_bf16 v[240:243], v[100:103], a[52:55], v[240:243]
ds_read_b64_tr_b16 v[130:131], v21 offset:12800
v_mfma_f32_16x16x32_bf16 v[240:243], a[252:255], a[48:51], v[240:243]
v_mfma_f32_16x16x32_bf16 v[200:203], v[116:119], a[104:107], v[200:203]
ds_read_b64_tr_b16 v[120:121], v19 offset:12288
v_mfma_f32_16x16x32_bf16 v[200:203], v[112:115], a[100:103], v[200:203]
ds_read_b64_tr_b16 v[122:123], v19 offset:12800
v_mfma_f32_16x16x32_bf16 v[200:203], v[108:111], a[96:99], v[200:203]
v_mfma_f32_16x16x32_bf16 v[192:195], v[108:111], a[92:95], v[192:195]
v_mfma_f32_16x16x32_bf16 v[192:195], v[112:115], a[96:99], v[192:195]
buffer_load_dwordx4 v11, s[28:31], s53 offen offset:1024  lds
v_mfma_f32_16x16x32_bf16 v[192:195], v[116:119], a[100:103], v[192:195]
v_mfma_f32_16x16x32_bf16 v[184:187], v[116:119], a[96:99], v[184:187]
v_mfma_f32_16x16x32_bf16 v[184:187], v[112:115], a[92:95], v[184:187]
s_waitcnt lgkmcnt(2)
v_mfma_f32_16x16x32_bf16 v[184:187], v[108:111], a[88:91], v[184:187]
buffer_load_dwordx4 v12, s[28:31], s53 offen offset:2048  lds
v_mfma_f32_16x16x32_bf16 v[176:179], v[108:111], a[84:87], v[176:179]
v_mfma_f32_16x16x32_bf16 v[176:179], v[112:115], a[88:91], v[176:179]
s_addk_i32 s53, 28672
v_mfma_f32_16x16x32_bf16 v[176:179], v[116:119], a[92:95], v[176:179]
s_addk_i32 m0, 12288
ds_read_b64_tr_b16 v[140:141], v21 offset:24576
v_mfma_f32_16x16x32_bf16 v[168:171], v[116:119], a[88:91], v[168:171]
buffer_load_dwordx4 v10, s[28:31], s53 offen offset:0  lds
v_mfma_f32_16x16x32_bf16 v[168:171], v[112:115], a[84:87], v[168:171]
ds_read_b64_tr_b16 v[142:143], v21 offset:25088
v_mfma_f32_16x16x32_bf16 v[168:171], v[108:111], a[80:83], v[168:171]
ds_read_b128 a[140:143], v41 offset:0
v_mfma_f32_16x16x32_bf16 v[160:163], v[108:111], a[76:79], v[160:163]
ds_read_b64_tr_b16 v[136:137], v20 offset:24576
v_mfma_f32_16x16x32_bf16 v[160:163], v[112:115], a[80:83], v[160:163]
buffer_load_dwordx4 v11, s[28:31], s53 offen offset:1024  lds
v_mfma_f32_16x16x32_bf16 v[160:163], v[116:119], a[84:87], v[160:163]
ds_read_b64_tr_b16 v[138:139], v20 offset:25088
v_mfma_f32_16x16x32_bf16 v[152:155], v[116:119], a[80:83], v[152:155]
ds_read_b128 a[136:139], v37 offset:14336
v_mfma_f32_16x16x32_bf16 v[152:155], v[112:115], a[76:79], v[152:155]
ds_read_b64_tr_b16 v[132:133], v19 offset:24576
v_mfma_f32_16x16x32_bf16 v[152:155], v[108:111], a[72:75], v[152:155]
buffer_load_dwordx4 v12, s[28:31], s53 offen offset:2048  lds
v_mfma_f32_16x16x32_bf16 v[144:147], v[112:115], a[72:75], v[144:147]
ds_read_b64_tr_b16 v[134:135], v19 offset:25088
v_mfma_f32_16x16x32_bf16 v[144:147], v[116:119], a[76:79], v[144:147]
ds_read_b128 a[132:135], v37 offset:12288
v_mfma_f32_16x16x32_bf16 v[148:151], v[124:127], a[72:75], v[148:151]
s_mov_b32 s55, 344064
ds_read_b128 a[128:131], v37 offset:10240
v_mfma_f32_16x16x32_bf16 v[148:151], v[128:131], a[76:79], v[148:151]
buffer_load_dword v2, v50, s[28:31], s55 offen
v_mfma_f32_16x16x32_bf16 v[156:159], v[128:131], a[80:83], v[156:159]
v_mfma_f32_16x16x32_bf16 v[156:159], v[124:127], a[76:79], v[156:159]
s_addk_i32 s48, 128
s_waitcnt lgkmcnt(5)
v_mfma_f32_16x16x32_bf16 v[156:159], v[120:123], a[72:75], v[156:159]
s_add_u32 m0, s20, 32768
ds_read_b128 a[124:127], v37 offset:8192
v_mfma_f32_16x16x32_bf16 v[164:167], v[120:123], a[76:79], v[164:167]
buffer_load_dwordx4 v6, s[24:27], s48 offen offset:0 nt lds
v_mfma_f32_16x16x32_bf16 v[164:167], v[124:127], a[80:83], v[164:167]
ds_read_b128 a[120:123], v37 offset:6144
v_mfma_f32_16x16x32_bf16 v[164:167], v[128:131], a[84:87], v[164:167]
v_mfma_f32_16x16x32_bf16 v[172:175], v[128:131], a[88:91], v[172:175]
v_mfma_f32_16x16x32_bf16 v[172:175], v[124:127], a[84:87], v[172:175]
buffer_load_dwordx4 v8, s[24:27], s48 offen offset:2048 nt lds
v_mfma_f32_16x16x32_bf16 v[172:175], v[120:123], a[80:83], v[172:175]
v_mfma_f32_16x16x32_bf16 v[180:183], v[120:123], a[84:87], v[180:183]
ds_read_b128 a[116:119], v37 offset:4096
v_mfma_f32_16x16x32_bf16 v[180:183], v[124:127], a[88:91], v[180:183]
ds_read_b128 a[112:115], v37 offset:2048
v_mfma_f32_16x16x32_bf16 v[180:183], v[128:131], a[92:95], v[180:183]
buffer_load_dwordx4 v7, s[24:27], s48 offen offset:1024 nt lds
v_mfma_f32_16x16x32_bf16 v[188:191], v[128:131], a[96:99], v[188:191]
v_mfma_f32_16x16x32_bf16 v[188:191], v[124:127], a[92:95], v[188:191]
ds_read_b128 a[108:111], v37 offset:0
v_mfma_f32_16x16x32_bf16 v[188:191], v[120:123], a[88:91], v[188:191]
ds_read_b64_tr_b16 a[220:221], v17 offset:24576
v_mfma_f32_16x16x32_bf16 v[196:199], v[120:123], a[92:95], v[196:199]
buffer_load_dwordx4 v9, s[24:27], s48 offen offset:3072 nt lds
v_mfma_f32_16x16x32_bf16 v[196:199], v[124:127], a[96:99], v[196:199]
ds_read_b64_tr_b16 a[222:223], v17 offset:25088
v_mfma_f32_16x16x32_bf16 v[196:199], v[128:131], a[100:103], v[196:199]
s_addk_i32 s49, 128
ds_read_b64_tr_b16 a[224:225], v18 offset:24576
v_mfma_f32_16x16x32_bf16 v[204:207], v[128:131], a[104:107], v[204:207]
s_add_u32 m0, s100, 32768
ds_read_b64_tr_b16 a[226:227], v18 offset:25088
v_mfma_f32_16x16x32_bf16 v[204:207], v[124:127], a[100:103], v[204:207]
buffer_load_dwordx4 v6, s[24:27], s49 offen offset:0 nt lds
v_mfma_f32_16x16x32_bf16 v[204:207], v[120:123], a[96:99], v[204:207]
v_mfma_f32_16x16x32_bf16 v[204:207], v[140:143], a[140:143], v[204:207]
ds_read_b64_tr_b16 a[216:217], v16 offset:24576
s_waitcnt lgkmcnt(6)
v_mfma_f32_16x16x32_bf16 v[204:207], v[136:139], a[136:139], v[204:207]
ds_read_b64_tr_b16 a[218:219], v16 offset:25088
v_mfma_f32_16x16x32_bf16 v[204:207], v[132:135], a[132:135], v[204:207]
buffer_load_dwordx4 v8, s[24:27], s49 offen offset:2048 nt lds
v_mfma_f32_16x16x32_bf16 v[196:199], v[132:135], a[128:131], v[196:199]
v_mfma_f32_16x16x32_bf16 v[196:199], v[136:139], a[132:135], v[196:199]
v_mfma_f32_16x16x32_bf16 v[196:199], v[140:143], a[136:139], v[196:199]
v_mfma_f32_16x16x32_bf16 v[188:191], v[140:143], a[132:135], v[188:191]
buffer_load_dwordx4 v7, s[24:27], s49 offen offset:1024 nt lds
v_mfma_f32_16x16x32_bf16 v[188:191], v[136:139], a[128:131], v[188:191]
v_mfma_f32_16x16x32_bf16 v[188:191], v[132:135], a[124:127], v[188:191]
v_mfma_f32_16x16x32_bf16 v[180:183], v[132:135], a[120:123], v[180:183]
v_mfma_f32_16x16x32_bf16 v[180:183], v[136:139], a[124:127], v[180:183]
buffer_load_dwordx4 v9, s[24:27], s49 offen offset:3072 nt lds
v_mfma_f32_16x16x32_bf16 v[180:183], v[140:143], a[128:131], v[180:183]
v_mfma_f32_16x16x32_bf16 v[172:175], v[140:143], a[124:127], v[172:175]
v_mfma_f32_16x16x32_bf16 v[172:175], v[136:139], a[120:123], v[172:175]
s_waitcnt vmcnt(12) lgkmcnt(0)
s_barrier
ds_read_b64_tr_b16 a[236:237], v18 offset:36864
v_mfma_f32_16x16x32_bf16 v[172:175], v[132:135], a[116:119], v[172:175]
s_addk_i32 s53, 28672
ds_read_b64_tr_b16 a[238:239], v18 offset:37376
v_mfma_f32_16x16x32_bf16 v[164:167], v[132:135], a[112:115], v[164:167]
s_add_u32 m0, s21, 98304
ds_read_b128 a[176:179], v38 offset:0
v_mfma_f32_16x16x32_bf16 v[164:167], v[136:139], a[116:119], v[164:167]
buffer_load_dwordx4 v10, s[28:31], s53 offen offset:0  lds
v_mfma_f32_16x16x32_bf16 v[164:167], v[140:143], a[120:123], v[164:167]
ds_read_b64_tr_b16 a[232:233], v17 offset:36864
v_mfma_f32_16x16x32_bf16 v[156:159], v[140:143], a[116:119], v[156:159]
ds_read_b64_tr_b16 a[234:235], v17 offset:37376
v_mfma_f32_16x16x32_bf16 v[156:159], v[136:139], a[112:115], v[156:159]
ds_read_b128 a[172:175], v34 offset:14336
v_mfma_f32_16x16x32_bf16 v[156:159], v[132:135], a[108:111], v[156:159]
ds_read_b64_tr_b16 a[228:229], v16 offset:36864
v_mfma_f32_16x16x32_bf16 v[148:151], v[136:139], a[108:111], v[148:151]
ds_read_b64_tr_b16 a[230:231], v16 offset:37376
v_mfma_f32_16x16x32_bf16 v[148:151], v[140:143], a[112:115], v[148:151]
ds_read_b128 a[168:171], v34 offset:12288
v_mfma_f32_16x16x32_bf16 v[144:147], a[220:223], a[108:111], v[144:147]
ds_read_b128 a[164:167], v34 offset:10240
v_mfma_f32_16x16x32_bf16 v[144:147], a[224:227], a[112:115], v[144:147]
v_mfma_f32_16x16x32_bf16 v[152:155], a[224:227], a[116:119], v[152:155]
v_mfma_f32_16x16x32_bf16 v[152:155], a[220:223], a[112:115], v[152:155]
v_mfma_f32_16x16x32_bf16 v[152:155], a[216:219], a[108:111], v[152:155]
v_mfma_f32_16x16x32_bf16 v[160:163], a[216:219], a[112:115], v[160:163]
ds_read_b128 a[160:163], v34 offset:8192
v_mfma_f32_16x16x32_bf16 v[160:163], a[220:223], a[116:119], v[160:163]
ds_read_b128 a[156:159], v34 offset:6144
v_mfma_f32_16x16x32_bf16 v[160:163], a[224:227], a[120:123], v[160:163]
v_mfma_f32_16x16x32_bf16 v[168:171], a[224:227], a[124:127], v[168:171]
v_mfma_f32_16x16x32_bf16 v[168:171], a[220:223], a[120:123], v[168:171]
v_mfma_f32_16x16x32_bf16 v[168:171], a[216:219], a[116:119], v[168:171]
v_mfma_f32_16x16x32_bf16 v[176:179], a[216:219], a[120:123], v[176:179]
ds_read_b128 a[152:155], v34 offset:4096
v_mfma_f32_16x16x32_bf16 v[176:179], a[220:223], a[124:127], v[176:179]
ds_read_b128 a[148:151], v34 offset:2048
v_mfma_f32_16x16x32_bf16 v[176:179], a[224:227], a[128:131], v[176:179]
v_mfma_f32_16x16x32_bf16 v[184:187], a[224:227], a[132:135], v[184:187]
v_mfma_f32_16x16x32_bf16 v[184:187], a[220:223], a[128:131], v[184:187]
v_mfma_f32_16x16x32_bf16 v[184:187], a[216:219], a[124:127], v[184:187]
v_mfma_f32_16x16x32_bf16 v[192:195], a[216:219], a[128:131], v[192:195]
ds_read_b128 a[144:147], v34 offset:0
v_mfma_f32_16x16x32_bf16 v[192:195], a[220:223], a[132:135], v[192:195]
ds_read_b64_tr_b16 a[244:245], v20 offset:36864
v_mfma_f32_16x16x32_bf16 v[192:195], a[224:227], a[136:139], v[192:195]
ds_read_b64_tr_b16 a[246:247], v20 offset:37376
v_mfma_f32_16x16x32_bf16 v[200:203], a[224:227], a[140:143], v[200:203]
ds_read_b64_tr_b16 a[248:249], v21 offset:36864
v_mfma_f32_16x16x32_bf16 v[200:203], a[220:223], a[136:139], v[200:203]
ds_read_b64_tr_b16 a[250:251], v21 offset:37376
v_mfma_f32_16x16x32_bf16 v[200:203], a[216:219], a[132:135], v[200:203]
s_waitcnt lgkmcnt(5)
v_mfma_f32_16x16x32_bf16 v[200:203], a[236:239], a[176:179], v[200:203]
ds_read_b64_tr_b16 a[240:241], v19 offset:36864
v_mfma_f32_16x16x32_bf16 v[200:203], a[232:235], a[172:175], v[200:203]
ds_read_b64_tr_b16 a[242:243], v19 offset:37376
v_mfma_f32_16x16x32_bf16 v[200:203], a[228:231], a[168:171], v[200:203]
v_mfma_f32_16x16x32_bf16 v[192:195], a[228:231], a[164:167], v[192:195]
v_mfma_f32_16x16x32_bf16 v[192:195], a[232:235], a[168:171], v[192:195]
v_mfma_f32_16x16x32_bf16 v[192:195], a[236:239], a[172:175], v[192:195]
v_mfma_f32_16x16x32_bf16 v[184:187], a[236:239], a[168:171], v[184:187]
ds_read_b128 v[52:55], v47 offset:0
v_mfma_f32_16x16x32_bf16 v[184:187], a[232:235], a[164:167], v[184:187]
ds_read_b128 v[56:59], v47 offset:512
v_mfma_f32_16x16x32_bf16 v[184:187], a[228:231], a[160:163], v[184:187]
buffer_load_dwordx4 v11, s[28:31], s53 offen offset:1024  lds
v_mfma_f32_16x16x32_bf16 v[176:179], a[228:231], a[156:159], v[176:179]
ds_read_b128 v[60:63], v47 offset:64
v_mfma_f32_16x16x32_bf16 v[176:179], a[232:235], a[160:163], v[176:179]
ds_read_b128 v[64:67], v47 offset:576
v_mfma_f32_16x16x32_bf16 v[176:179], a[236:239], a[164:167], v[176:179]
ds_read_b128 v[68:71], v48 offset:0
v_mfma_f32_16x16x32_bf16 v[168:171], a[236:239], a[160:163], v[168:171]
buffer_load_dwordx4 v12, s[28:31], s53 offen offset:2048  lds
v_mfma_f32_16x16x32_bf16 v[168:171], a[232:235], a[156:159], v[168:171]
s_waitcnt vmcnt(12) lgkmcnt(5)
s_barrier
ds_read_b64_tr_b16 v[104:105], v21 offset:49152
ds_read_b64_tr_b16 v[106:107], v21 offset:49664
v_mfma_f32_16x16x32_bf16 v[168:171], a[228:231], a[152:155], v[168:171]
s_addk_i32 s53, 28672
ds_read_b128 a[212:215], v39 offset:0
v_mfma_f32_16x16x32_bf16 v[160:163], a[228:231], a[148:151], v[160:163]
s_addk_i32 m0, 12288
ds_read_b64_tr_b16 v[100:101], v20 offset:49152
v_mfma_f32_16x16x32_bf16 v[160:163], a[232:235], a[152:155], v[160:163]
buffer_load_dwordx4 v10, s[28:31], s53 offen offset:0  lds
v_mfma_f32_16x16x32_bf16 v[160:163], a[236:239], a[156:159], v[160:163]
ds_read_b64_tr_b16 v[102:103], v20 offset:49664
v_mfma_f32_16x16x32_bf16 v[152:155], a[236:239], a[152:155], v[152:155]
ds_read_b128 a[208:211], v35 offset:14336
v_mfma_f32_16x16x32_bf16 v[152:155], a[232:235], a[148:151], v[152:155]
ds_read_b64_tr_b16 a[252:253], v19 offset:49152
v_mfma_f32_16x16x32_bf16 v[152:155], a[228:231], a[144:147], v[152:155]
buffer_load_dwordx4 v11, s[28:31], s53 offen offset:1024  lds
v_mfma_f32_16x16x32_bf16 v[144:147], a[232:235], a[144:147], v[144:147]
ds_read_b64_tr_b16 a[254:255], v19 offset:49664
v_mfma_f32_16x16x32_bf16 v[144:147], a[236:239], a[148:151], v[144:147]
ds_read_b128 a[204:207], v35 offset:12288
v_mfma_f32_16x16x32_bf16 v[148:151], a[244:247], a[144:147], v[148:151]
ds_read_b128 a[200:203], v35 offset:10240
v_mfma_f32_16x16x32_bf16 v[148:151], a[248:251], a[148:151], v[148:151]
buffer_load_dwordx4 v12, s[28:31], s53 offen offset:2048  lds
v_mfma_f32_16x16x32_bf16 v[156:159], a[248:251], a[152:155], v[156:159]
ds_read_b128 v[72:75], v48 offset:512
v_mfma_f32_16x16x32_bf16 v[156:159], a[244:247], a[148:151], v[156:159]
s_addk_i32 s53, -28672
ds_read_b128 v[76:79], v48 offset:128
v_mfma_f32_16x16x32_bf16 v[156:159], a[240:243], a[144:147], v[156:159]
s_add_u32 m0, s21, 69632
ds_read_b128 a[196:199], v35 offset:8192
v_mfma_f32_16x16x32_bf16 v[164:167], a[240:243], a[148:151], v[164:167]
buffer_load_dwordx4 v13, s[28:31], s53 offen offset:0  lds
v_mfma_f32_16x16x32_bf16 v[164:167], a[244:247], a[152:155], v[164:167]
ds_read_b128 a[192:195], v35 offset:6144
v_mfma_f32_16x16x32_bf16 v[164:167], a[248:251], a[156:159], v[164:167]
ds_read_b128 v[80:83], v48 offset:640
v_mfma_f32_16x16x32_bf16 v[172:175], a[248:251], a[160:163], v[172:175]
v_mfma_f32_16x16x32_bf16 v[172:175], a[244:247], a[156:159], v[172:175]
buffer_load_dwordx4 v14, s[28:31], s53 offen offset:1024  lds
v_mfma_f32_16x16x32_bf16 v[172:175], a[240:243], a[152:155], v[172:175]
v_mfma_f32_16x16x32_bf16 v[180:183], a[240:243], a[156:159], v[180:183]
ds_read_b128 a[188:191], v35 offset:4096
v_mfma_f32_16x16x32_bf16 v[180:183], a[244:247], a[160:163], v[180:183]
ds_read_b128 a[184:187], v35 offset:2048
v_mfma_f32_16x16x32_bf16 v[180:183], a[248:251], a[164:167], v[180:183]
buffer_load_dwordx4 v15, s[28:31], s53 offen offset:2048  lds
v_mfma_f32_16x16x32_bf16 v[188:191], a[248:251], a[168:171], v[188:191]
ds_read_b128 a[180:183], v35 offset:0
v_mfma_f32_16x16x32_bf16 v[188:191], a[244:247], a[164:167], v[188:191]
s_addk_i32 s53, 28672
ds_read_b64_tr_b16 v[112:113], v17 offset:49152
v_mfma_f32_16x16x32_bf16 v[188:191], a[240:243], a[160:163], v[188:191]
s_addk_i32 m0, 12288
ds_read_b64_tr_b16 v[114:115], v17 offset:49664
v_mfma_f32_16x16x32_bf16 v[196:199], a[240:243], a[164:167], v[196:199]
buffer_load_dwordx4 v13, s[28:31], s53 offen offset:0  lds
v_mfma_f32_16x16x32_bf16 v[196:199], a[244:247], a[168:171], v[196:199]
ds_read_b64_tr_b16 v[116:117], v18 offset:49152
v_mfma_f32_16x16x32_bf16 v[196:199], a[248:251], a[172:175], v[196:199]
ds_read_b64_tr_b16 v[118:119], v18 offset:49664
v_mfma_f32_16x16x32_bf16 v[204:207], a[248:251], a[176:179], v[204:207]
ds_read_b64_tr_b16 v[108:109], v16 offset:49152
v_mfma_f32_16x16x32_bf16 v[204:207], a[244:247], a[172:175], v[204:207]
buffer_load_dwordx4 v14, s[28:31], s53 offen offset:1024  lds
v_mfma_f32_16x16x32_bf16 v[204:207], a[240:243], a[168:171], v[204:207]
ds_read_b64_tr_b16 v[110:111], v16 offset:49664
s_waitcnt lgkmcnt(7)
v_mfma_f32_16x16x32_bf16 v[204:207], v[104:107], a[212:215], v[204:207]
v_mfma_f32_16x16x32_bf16 v[204:207], v[100:103], a[208:211], v[204:207]
v_mfma_f32_16x16x32_bf16 v[204:207], a[252:255], a[204:207], v[204:207]
buffer_load_dwordx4 v15, s[28:31], s53 offen offset:2048  lds
v_mfma_f32_16x16x32_bf16 v[196:199], a[252:255], a[200:203], v[196:199]
v_mfma_f32_16x16x32_bf16 v[196:199], v[100:103], a[204:207], v[196:199]
s_mov_b32 s53, 229376
v_mfma_f32_16x16x32_bf16 v[196:199], v[104:107], a[208:211], v[196:199]
s_add_u32 m0, s21, 122880
v_mfma_f32_16x16x32_bf16 v[188:191], v[104:107], a[204:207], v[188:191]
buffer_load_dwordx4 v13, s[28:31], s53 offen offset:0  lds
v_mfma_f32_16x16x32_bf16 v[188:191], v[100:103], a[200:203], v[188:191]
s_waitcnt vmcnt(7) lgkmcnt(1)
s_barrier
ds_read_b64_tr_b16 v[124:125], v17 offset:0
ds_read_b64_tr_b16 v[126:127], v17 offset:512
v_mfma_f32_16x16x32_bf16 v[188:191], a[252:255], a[196:199], v[188:191]
ds_read_b128 a[0:3], v34 offset:32768
ds_read_b64_tr_b16 v[128:129], v18 offset:0
v_mfma_f32_16x16x32_bf16 v[180:183], a[252:255], a[192:195], v[180:183]
ds_read_b64_tr_b16 v[130:131], v18 offset:512
ds_read_b128 a[4:7], v34 offset:34816
v_mfma_f32_16x16x32_bf16 v[180:183], v[100:103], a[196:199], v[180:183]
buffer_load_dwordx4 v14, s[28:31], s53 offen offset:1024  lds
v_mfma_f32_16x16x32_bf16 v[180:183], v[104:107], a[200:203], v[180:183]
ds_read_b64_tr_b16 v[136:137], v17 offset:12288
ds_read_b64_tr_b16 v[138:139], v17 offset:12800
v_mfma_f32_16x16x32_bf16 v[172:175], v[104:107], a[196:199], v[172:175]
ds_read_b128 a[36:39], v35 offset:32768
ds_read_b64_tr_b16 v[140:141], v18 offset:12288
v_mfma_f32_16x16x32_bf16 v[172:175], v[100:103], a[192:195], v[172:175]
ds_read_b64_tr_b16 v[142:143], v18 offset:12800
v_mfma_f32_16x16x32_bf16 v[172:175], a[252:255], a[188:191], v[172:175]
buffer_load_dwordx4 v15, s[28:31], s53 offen offset:2048  lds
v_mfma_f32_16x16x32_bf16 v[164:167], a[252:255], a[184:187], v[164:167]
ds_read_b128 a[40:43], v35 offset:34816
v_mfma_f32_16x16x32_bf16 v[164:167], v[100:103], a[188:191], v[164:167]
s_addk_i32 s53, 28672
ds_read_b64_tr_b16 a[236:237], v21 offset:12288
v_mfma_f32_16x16x32_bf16 v[164:167], v[104:107], a[192:195], v[164:167]
s_addk_i32 m0, 12288
ds_read_b64_tr_b16 a[238:239], v21 offset:12800
v_mfma_f32_16x16x32_bf16 v[156:159], v[104:107], a[188:191], v[156:159]
buffer_load_dwordx4 v13, s[28:31], s53 offen offset:0  lds
v_mfma_f32_16x16x32_bf16 v[156:159], v[100:103], a[184:187], v[156:159]
ds_read_b64_tr_b16 a[232:233], v20 offset:12288
v_mfma_f32_16x16x32_bf16 v[156:159], a[252:255], a[180:183], v[156:159]
ds_read_b64_tr_b16 a[234:235], v20 offset:12800
v_mfma_f32_16x16x32_bf16 v[148:151], v[100:103], a[180:183], v[148:151]
ds_read_b64_tr_b16 a[224:225], v21 offset:0
v_mfma_f32_16x16x32_bf16 v[148:151], v[104:107], a[184:187], v[148:151]
buffer_load_dwordx4 v14, s[28:31], s53 offen offset:1024  lds
v_mfma_f32_16x16x32_bf16 v[144:147], v[112:115], a[180:183], v[144:147]
ds_read_b64_tr_b16 a[226:227], v21 offset:512
v_mfma_f32_16x16x32_bf16 v[144:147], v[116:119], a[184:187], v[144:147]
ds_read_b64_tr_b16 a[220:221], v20 offset:0
v_mfma_f32_16x16x32_bf16 v[152:155], v[116:119], a[188:191], v[152:155]
ds_read_b64_tr_b16 a[222:223], v20 offset:512
v_mfma_f32_16x16x32_bf16 v[152:155], v[112:115], a[184:187], v[152:155]
buffer_load_dwordx4 v15, s[28:31], s53 offen offset:2048  lds
s_waitcnt lgkmcnt(6)
v_mfma_f32_16x16x32_bf16 v[152:155], v[108:111], a[180:183], v[152:155]
ds_read_b64_tr_b16 a[216:217], v19 offset:0
v_mfma_f32_16x16x32_bf16 v[160:163], v[108:111], a[184:187], v[160:163]
ds_read_b64_tr_b16 a[218:219], v19 offset:512
v_mfma_f32_16x16x32_bf16 v[160:163], v[112:115], a[188:191], v[160:163]
ds_read_b128 a[8:11], v34 offset:36864
v_mfma_f32_16x16x32_bf16 v[160:163], v[116:119], a[192:195], v[160:163]
ds_read_b64_tr_b16 a[228:229], v19 offset:12288
v_mfma_f32_16x16x32_bf16 v[168:171], v[116:119], a[196:199], v[168:171]
ds_read_b64_tr_b16 a[230:231], v19 offset:12800
v_mfma_f32_16x16x32_bf16 v[168:171], v[112:115], a[192:195], v[168:171]
v_mfma_f32_16x16x32_bf16 v[168:171], v[108:111], a[188:191], v[168:171]
ds_read_b128 a[44:47], v35 offset:36864
v_mfma_f32_16x16x32_bf16 v[176:179], v[108:111], a[192:195], v[176:179]
ds_read_b64_tr_b16 v[132:133], v16 offset:12288
v_mfma_f32_16x16x32_bf16 v[176:179], v[112:115], a[196:199], v[176:179]
ds_read_b64_tr_b16 v[134:135], v16 offset:12800
v_mfma_f32_16x16x32_bf16 v[176:179], v[116:119], a[200:203], v[176:179]
ds_read_b128 a[12:15], v34 offset:38912
v_mfma_f32_16x16x32_bf16 v[184:187], v[116:119], a[204:207], v[184:187]
ds_read_b128 a[16:19], v34 offset:40960
v_mfma_f32_16x16x32_bf16 v[184:187], v[112:115], a[200:203], v[184:187]
ds_read_b64_tr_b16 v[120:121], v16 offset:0
v_mfma_f32_16x16x32_bf16 v[184:187], v[108:111], a[196:199], v[184:187]
ds_read_b64_tr_b16 v[122:123], v16 offset:512
v_mfma_f32_16x16x32_bf16 v[192:195], v[108:111], a[200:203], v[192:195]
ds_read_b128 a[20:23], v34 offset:43008
v_mfma_f32_16x16x32_bf16 v[192:195], v[112:115], a[204:207], v[192:195]
v_mfma_f32_16x16x32_bf16 v[192:195], v[116:119], a[208:211], v[192:195]
ds_read_b128 a[24:27], v34 offset:45056
v_mfma_f32_16x16x32_bf16 v[200:203], v[116:119], a[212:215], v[200:203]
v_mfma_f32_16x16x32_bf16 v[200:203], v[112:115], a[208:211], v[200:203]
ds_read_b128 a[28:31], v34 offset:47104
v_mfma_f32_16x16x32_bf16 v[200:203], v[108:111], a[204:207], v[200:203]
ds_read_b128 a[48:51], v35 offset:38912
v_mfma_f32_16x16x32_bf16 v[144:147], v[124:127], a[0:3], v[144:147]
ds_read_b128 a[32:35], v38 offset:32768
v_mfma_f32_16x16x32_bf16 v[144:147], v[128:131], a[4:7], v[144:147]
v_mfma_f32_16x16x32_bf16 v[144:147], v[136:139], a[36:39], v[144:147]
v_mfma_f32_16x16x32_bf16 v[144:147], v[140:143], a[40:43], v[144:147]
v_mfma_f32_16x16x32_bf16 v[148:151], a[236:239], a[40:43], v[148:151]
s_waitcnt lgkmcnt(4)
v_mfma_f32_16x16x32_bf16 v[148:151], a[232:235], a[36:39], v[148:151]
v_mfma_f32_16x16x32_bf16 v[148:151], a[224:227], a[4:7], v[148:151]
s_nop 3
v_fma_f32 v144, v144, v52, v56
v_fma_f32 v145, v145, v53, v57
v_mfma_f32_16x16x32_bf16 v[148:151], a[220:223], a[0:3], v[148:151]
v_exp_f32 v84, v144
v_mfma_f32_16x16x32_bf16 v[156:159], a[216:219], a[0:3], v[156:159]
ds_read_b128 a[52:55], v35 offset:40960
v_fma_f32 v146, v146, v54, v58
v_mfma_f32_16x16x32_bf16 v[156:159], a[220:223], a[4:7], v[156:159]
v_exp_f32 v85, v145
v_mfma_f32_16x16x32_bf16 v[156:159], a[224:227], a[8:11], v[156:159]
v_fma_f32 v147, v147, v55, v59
v_fma_f32 v84, v84, s50, s50
v_mfma_f32_16x16x32_bf16 v[156:159], a[228:231], a[36:39], v[156:159]
v_exp_f32 v86, v146
v_exp_f32 v87, v147
v_fma_f32 v85, v85, s50, s50
v_pk_fma_f32 v[148:149], v[148:149], v[60:61], v[64:65]
v_pk_fma_f32 v[150:151], v[150:151], v[62:63], v[66:67]
v_mfma_f32_16x16x32_bf16 v[156:159], a[232:235], a[40:43], v[156:159]
ds_read_b128 a[56:59], v35 offset:43008
ds_read_b128 a[60:63], v35 offset:45056
v_mfma_f32_16x16x32_bf16 v[156:159], a[236:239], a[44:47], v[156:159]
v_rcp_f32 v84, v84
v_mfma_f32_16x16x32_bf16 v[152:155], v[140:143], a[44:47], v[152:155]
v_rcp_f32 v85, v85
v_mfma_f32_16x16x32_bf16 v[152:155], v[136:139], a[40:43], v[152:155]
v_exp_f32 v88, v148
v_mfma_f32_16x16x32_bf16 v[152:155], v[132:135], a[36:39], v[152:155]
s_waitcnt lgkmcnt(3)
s_barrier
ds_read_b128 a[64:67], v35 offset:47104
ds_read_b128 a[68:71], v39 offset:32768
v_mfma_f32_16x16x32_bf16 v[152:155], v[128:131], a[8:11], v[152:155]
s_addk_i32 s53, 28672
v_exp_f32 v89, v149
v_mfma_f32_16x16x32_bf16 v[152:155], v[124:127], a[4:7], v[152:155]
s_add_u32 m0, s21, 98304
v_fma_f32 v86, v86, s50, s50
v_mfma_f32_16x16x32_bf16 v[152:155], v[120:123], a[0:3], v[152:155]
buffer_load_dwordx4 v13, s[28:31], s53 offen offset:0  lds
v_mfma_f32_16x16x32_bf16 v[160:163], v[120:123], a[4:7], v[160:163]
v_exp_f32 v90, v150
v_mfma_f32_16x16x32_bf16 v[160:163], v[124:127], a[8:11], v[160:163]
v_exp_f32 v91, v151
v_mfma_f32_16x16x32_bf16 v[160:163], v[128:131], a[12:15], v[160:163]
v_fma_f32 v87, v87, s50, s50
v_fma_f32 v88, v88, s50, s50
v_mfma_f32_16x16x32_bf16 v[160:163], v[132:135], a[40:43], v[160:163]
buffer_load_dwordx4 v14, s[28:31], s53 offen offset:1024  lds
v_mfma_f32_16x16x32_bf16 v[160:163], v[136:139], a[44:47], v[160:163]
v_rcp_f32 v86, v86
v_rcp_f32 v87, v87
v_pk_mul_f32 v[84:85], v[144:145], v[84:85]
v_fma_f32 v89, v89, s50, s50
v_pk_fma_f32 v[90:91], v[90:91], s[50:51], s[50:51]
v_pk_fma_f32 v[156:157], v[156:157], v[60:61], v[64:65]
v_pk_fma_f32 v[158:159], v[158:159], v[62:63], v[66:67]
v_pk_fma_f32 v[152:153], v[152:153], v[52:53], v[56:57]
v_pk_fma_f32 v[154:155], v[154:155], v[54:55], v[58:59]
v_mfma_f32_16x16x32_bf16 v[160:163], v[140:143], a[48:51], v[160:163]
v_rcp_f32 v88, v88
v_mfma_f32_16x16x32_bf16 v[164:167], a[236:239], a[48:51], v[164:167]
v_rcp_f32 v89, v89
v_mfma_f32_16x16x32_bf16 v[164:167], a[232:235], a[44:47], v[164:167]
buffer_load_dwordx4 v15, s[28:31], s53 offen offset:2048  lds
v_mfma_f32_16x16x32_bf16 v[164:167], a[228:231], a[40:43], v[164:167]
L_pad1_3:
s_cbranch_execz L_body1
v_rcp_f32 v90, v90
v_mfma_f32_16x16x32_bf16 v[164:167], a[224:227], a[12:15], v[164:167]
s_addk_i32 s53, 28672
v_rcp_f32 v91, v91
v_mfma_f32_16x16x32_bf16 v[164:167], a[220:223], a[8:11], v[164:167]
s_addk_i32 m0, 12288
v_exp_f32 v92, v156
v_mfma_f32_16x16x32_bf16 v[164:167], a[216:219], a[4:7], v[164:167]
buffer_load_dwordx4 v13, s[28:31], s53 offen offset:0  lds
v_mfma_f32_16x16x32_bf16 v[172:175], a[216:219], a[8:11], v[172:175]
v_exp_f32 v93, v157
v_mfma_f32_16x16x32_bf16 v[172:175], a[220:223], a[12:15], v[172:175]
v_exp_f32 v94, v158
v_mfma_f32_16x16x32_bf16 v[172:175], a[224:227], a[16:19], v[172:175]
v_exp_f32 v95, v159
v_mfma_f32_16x16x32_bf16 v[172:175], a[228:231], a[44:47], v[172:175]
buffer_load_dwordx4 v14, s[28:31], s53 offen offset:1024  lds
v_mfma_f32_16x16x32_bf16 v[172:175], a[232:235], a[48:51], v[172:175]
v_exp_f32 v96, v152
s_waitcnt lgkmcnt(0)
v_mfma_f32_16x16x32_bf16 v[172:175], a[236:239], a[52:55], v[172:175]
v_exp_f32 v97, v153
v_mfma_f32_16x16x32_bf16 v[168:171], v[140:143], a[52:55], v[168:171]
v_exp_f32 v98, v154
v_exp_f32 v99, v155
v_cvt_pk_bf16_f32 v144, v84, v85
v_pk_mul_f32 v[86:87], v[146:147], v[86:87]
v_pk_mul_f32 v[88:89], v[148:149], v[88:89]
v_pk_mul_f32 v[90:91], v[150:151], v[90:91]
v_pk_fma_f32 v[92:93], v[92:93], s[50:51], s[50:51]
v_pk_fma_f32 v[94:95], v[94:95], s[50:51], s[50:51]
v_pk_fma_f32 v[96:97], v[96:97], s[50:51], s[50:51]
v_pk_fma_f32 v[160:161], v[160:161], v[52:53], v[56:57]
v_pk_fma_f32 v[162:163], v[162:163], v[54:55], v[58:59]
v_mfma_f32_16x16x32_bf16 v[168:171], v[136:139], a[48:51], v[168:171]
buffer_load_dwordx4 v15, s[28:31], s53 offen offset:2048  lds
v_mfma_f32_16x16x32_bf16 v[168:171], v[132:135], a[44:47], v[168:171]
v_cvt_pk_bf16_f32 v145, v86, v87
v_cvt_pk_bf16_f32 v146, v88, v89
v_mfma_f32_16x16x32_bf16 v[168:171], v[128:131], a[16:19], v[168:171]
v_rcp_f32 v92, v92
v_mfma_f32_16x16x32_bf16 v[168:171], v[124:127], a[12:15], v[168:171]
v_rcp_f32 v93, v93
v_mfma_f32_16x16x32_bf16 v[168:171], v[120:123], a[8:11], v[168:171]
v_rcp_f32 v94, v94
v_mfma_f32_16x16x32_bf16 v[176:179], v[120:123], a[12:15], v[176:179]
v_rcp_f32 v95, v95
v_mfma_f32_16x16x32_bf16 v[176:179], v[124:127], a[16:19], v[176:179]
v_rcp_f32 v96, v96
v_mfma_f32_16x16x32_bf16 v[176:179], v[128:131], a[20:23], v[176:179]
v_rcp_f32 v97, v97
v_mfma_f32_16x16x32_bf16 v[176:179], v[132:135], a[48:51], v[176:179]
v_exp_f32 v84, v160
v_mfma_f32_16x16x32_bf16 v[176:179], v[136:139], a[52:55], v[176:179]
v_exp_f32 v85, v161
v_mfma_f32_16x16x32_bf16 v[176:179], v[140:143], a[56:59], v[176:179]
v_exp_f32 v86, v162
v_exp_f32 v87, v163
v_cvt_pk_bf16_f32 v147, v90, v91
v_pk_mul_f32 v[92:93], v[156:157], v[92:93]
v_pk_mul_f32 v[94:95], v[158:159], v[94:95]
v_pk_mul_f32 v[96:97], v[152:153], v[96:97]
v_pk_fma_f32 v[98:99], v[98:99], s[50:51], s[50:51]
v_pk_fma_f32 v[84:85], v[84:85], s[50:51], s[50:51]
v_pk_fma_f32 v[164:165], v[164:165], v[60:61], v[64:65]
v_pk_fma_f32 v[166:167], v[166:167], v[62:63], v[66:67]
v_pk_fma_f32 v[172:173], v[172:173], v[60:61], v[64:65]
v_mfma_f32_16x16x32_bf16 v[180:183], a[236:239], a[56:59], v[180:183]
v_permlane16_swap_b32 v144, v146
v_mfma_f32_16x16x32_bf16 v[180:183], a[232:235], a[52:55], v[180:183]
v_permlane16_swap_b32 v145, v147
v_mfma_f32_16x16x32_bf16 v[180:183], a[228:231], a[48:51], v[180:183]
v_cvt_pk_bf16_f32 v158, v92, v93
v_cvt_pk_bf16_f32 v159, v94, v95
v_mfma_f32_16x16x32_bf16 v[180:183], a[224:227], a[20:23], v[180:183]
v_rcp_f32 v98, v98
v_mfma_f32_16x16x32_bf16 v[180:183], a[220:223], a[16:19], v[180:183]
v_rcp_f32 v99, v99
v_mfma_f32_16x16x32_bf16 v[180:183], a[216:219], a[12:15], v[180:183]
v_rcp_f32 v84, v84
v_mfma_f32_16x16x32_bf16 v[188:191], a[216:219], a[16:19], v[188:191]
v_rcp_f32 v85, v85
v_mfma_f32_16x16x32_bf16 v[188:191], a[220:223], a[20:23], v[188:191]
v_exp_f32 v88, v164
v_mfma_f32_16x16x32_bf16 v[188:191], a[224:227], a[24:27], v[188:191]
v_exp_f32 v89, v165
v_mfma_f32_16x16x32_bf16 v[188:191], a[228:231], a[52:55], v[188:191]
s_waitcnt vmcnt(9)
s_barrier
v_exp_f32 v90, v166
v_mfma_f32_16x16x32_bf16 v[188:191], a[232:235], a[56:59], v[188:191]
v_exp_f32 v91, v167
v_mfma_f32_16x16x32_bf16 v[188:191], a[236:239], a[60:63], v[188:191]
v_exp_f32 v92, v172
v_exp_f32 v93, v173
v_cvt_pk_bf16_f32 v156, v96, v97
v_pk_mul_f32 v[98:99], v[154:155], v[98:99]
v_pk_mul_f32 v[84:85], v[160:161], v[84:85]
v_pk_fma_f32 v[86:87], v[86:87], s[50:51], s[50:51]
v_pk_fma_f32 v[88:89], v[88:89], s[50:51], s[50:51]
v_pk_fma_f32 v[90:91], v[90:91], s[50:51], s[50:51]
v_pk_fma_f32 v[174:175], v[174:175], v[62:63], v[66:67]
v_pk_fma_f32 v[168:169], v[168:169], v[52:53], v[56:57]
v_pk_fma_f32 v[170:171], v[170:171], v[54:55], v[58:59]
v_mfma_f32_16x16x32_bf16 v[184:187], v[140:143], a[60:63], v[184:187]
v_rcp_f32 v86, v86
v_mfma_f32_16x16x32_bf16 v[184:187], v[136:139], a[56:59], v[184:187]
v_rcp_f32 v87, v87
v_mfma_f32_16x16x32_bf16 v[184:187], v[132:135], a[52:55], v[184:187]
ds_read_b64_tr_b16 a[240:241], v31 offset:36864
ds_read_b64_tr_b16 a[242:243], v31 offset:37376
v_mfma_f32_16x16x32_bf16 v[184:187], v[128:131], a[24:27], v[184:187]
v_rcp_f32 v88, v88
v_mfma_f32_16x16x32_bf16 v[184:187], v[124:127], a[20:23], v[184:187]
ds_read_b64_tr_b16 a[244:245], v32 offset:36864
ds_read_b64_tr_b16 a[246:247], v32 offset:37376
v_mfma_f32_16x16x32_bf16 v[184:187], v[120:123], a[16:19], v[184:187]
v_rcp_f32 v89, v89
v_mfma_f32_16x16x32_bf16 v[192:195], v[120:123], a[20:23], v[192:195]
ds_read_b64_tr_b16 a[248:249], v33 offset:36864
ds_read_b64_tr_b16 a[250:251], v33 offset:37376
v_mfma_f32_16x16x32_bf16 v[192:195], v[124:127], a[24:27], v[192:195]
v_rcp_f32 v90, v90
v_mfma_f32_16x16x32_bf16 v[192:195], v[128:131], a[28:31], v[192:195]
v_rcp_f32 v91, v91
v_mfma_f32_16x16x32_bf16 v[192:195], v[132:135], a[56:59], v[192:195]
v_exp_f32 v94, v174
v_mfma_f32_16x16x32_bf16 v[192:195], v[136:139], a[60:63], v[192:195]
v_exp_f32 v95, v175
v_mfma_f32_16x16x32_bf16 v[192:195], v[140:143], a[64:67], v[192:195]
v_exp_f32 v96, v168
v_exp_f32 v97, v169
v_cvt_pk_bf16_f32 v157, v98, v99
v_pk_mul_f32 v[86:87], v[162:163], v[86:87]
v_pk_mul_f32 v[88:89], v[164:165], v[88:89]
v_pk_mul_f32 v[90:91], v[166:167], v[90:91]
v_pk_fma_f32 v[92:93], v[92:93], s[50:51], s[50:51]
v_pk_fma_f32 v[94:95], v[94:95], s[50:51], s[50:51]
v_pk_fma_f32 v[176:177], v[176:177], v[52:53], v[56:57]
v_mfma_f32_16x16x32_bf16 v[196:199], a[236:239], a[64:67], v[196:199]
v_permlane16_swap_b32 v156, v158
v_mfma_f32_16x16x32_bf16 v[196:199], a[232:235], a[60:63], v[196:199]
v_permlane16_swap_b32 v157, v159
v_mfma_f32_16x16x32_bf16 v[196:199], a[228:231], a[56:59], v[196:199]
ds_read_b64_tr_b16 a[252:253], v28 offset:36864
ds_read_b64_tr_b16 a[254:255], v28 offset:37376
v_mfma_f32_16x16x32_bf16 v[196:199], a[224:227], a[28:31], v[196:199]
v_cvt_pk_bf16_f32 v160, v84, v85
v_cvt_pk_bf16_f32 v161, v86, v87
v_mfma_f32_16x16x32_bf16 v[196:199], a[220:223], a[24:27], v[196:199]
ds_read_b64_tr_b16 v[100:101], v29 offset:36864
ds_read_b64_tr_b16 v[102:103], v29 offset:37376
v_mfma_f32_16x16x32_bf16 v[196:199], a[216:219], a[20:23], v[196:199]
s_waitcnt vmcnt(0) lgkmcnt(4)
s_barrier
v_rcp_f32 v92, v92
v_mfma_f32_16x16x32_bf16 v[204:207], a[216:219], a[24:27], v[204:207]
ds_read_b64_tr_b16 v[104:105], v30 offset:36864
ds_read_b64_tr_b16 v[106:107], v30 offset:37376
v_mfma_f32_16x16x32_bf16 v[204:207], a[220:223], a[28:31], v[204:207]
buffer_store_dwordx4 v[144:147], v42, s[32:35], s40 offen sc0 sc1
v_rcp_f32 v93, v93
v_cvt_pk_bf16_f32 v162, v88, v89
v_mfma_f32_16x16x32_bf16 v[204:207], a[224:227], a[32:35], v[204:207]
v_rcp_f32 v94, v94
v_mfma_f32_16x16x32_bf16 v[204:207], a[228:231], a[60:63], v[204:207]
v_rcp_f32 v95, v95
v_mfma_f32_16x16x32_bf16 v[204:207], a[232:235], a[64:67], v[204:207]
v_exp_f32 v98, v170
v_mfma_f32_16x16x32_bf16 v[204:207], a[236:239], a[68:71], v[204:207]
v_exp_f32 v99, v171
v_mfma_f32_16x16x32_bf16 v[200:203], v[140:143], a[68:71], v[200:203]
v_exp_f32 v84, v176
v_exp_f32 v85, v177
v_cvt_pk_bf16_f32 v163, v90, v91
v_pk_mul_f32 v[92:93], v[172:173], v[92:93]
v_pk_mul_f32 v[94:95], v[174:175], v[94:95]
v_pk_fma_f32 v[96:97], v[96:97], s[50:51], s[50:51]
v_pk_fma_f32 v[98:99], v[98:99], s[50:51], s[50:51]
v_pk_fma_f32 v[178:179], v[178:179], v[54:55], v[58:59]
v_pk_fma_f32 v[180:181], v[180:181], v[60:61], v[64:65]
v_pk_fma_f32 v[182:183], v[182:183], v[62:63], v[66:67]
v_mfma_f32_16x16x32_bf16 v[200:203], v[136:139], a[64:67], v[200:203]
v_permlane16_swap_b32 v160, v162
v_mfma_f32_16x16x32_bf16 v[200:203], v[132:135], a[60:63], v[200:203]
v_permlane16_swap_b32 v161, v163
v_mfma_f32_16x16x32_bf16 v[200:203], v[128:131], a[32:35], v[200:203]
v_rcp_f32 v96, v96
v_mfma_f32_16x16x32_bf16 v[200:203], v[124:127], a[28:31], v[200:203]
v_rcp_f32 v97, v97
v_mfma_f32_16x16x32_bf16 v[200:203], v[120:123], a[24:27], v[200:203]
v_rcp_f32 v98, v98
v_mfma_f32_16x16x32_bf16 v[240:243], a[240:243], a[12:15], v[240:243]
ds_read_b64_tr_b16 v[112:113], v29 offset:49152
ds_read_b64_tr_b16 v[114:115], v29 offset:49664
v_mfma_f32_16x16x32_bf16 v[240:243], a[244:247], a[16:19], v[240:243]
v_rcp_f32 v99, v99
v_mfma_f32_16x16x32_bf16 v[240:243], a[248:251], a[20:23], v[240:243]
ds_read_b64_tr_b16 v[108:109], v30 offset:49152
ds_read_b64_tr_b16 v[110:111], v30 offset:49664
v_mfma_f32_16x16x32_bf16 v[244:247], a[248:251], a[24:27], v[244:247]
buffer_store_dwordx4 v[156:159], v42, s[32:35], s41 offen sc0 sc1
v_exp_f32 v86, v178
v_cvt_pk_bf16_f32 v174, v92, v93
v_mfma_f32_16x16x32_bf16 v[244:247], a[244:247], a[20:23], v[244:247]
ds_read_b64_tr_b16 a[220:221], v23 offset:24576
ds_read_b64_tr_b16 a[222:223], v23 offset:25088
v_mfma_f32_16x16x32_bf16 v[244:247], a[240:243], a[16:19], v[244:247]
v_exp_f32 v87, v179
v_mfma_f32_16x16x32_bf16 v[248:251], a[240:243], a[20:23], v[248:251]
ds_read_b64_tr_b16 a[224:225], v24 offset:24576
ds_read_b64_tr_b16 a[226:227], v24 offset:25088
v_mfma_f32_16x16x32_bf16 v[248:251], a[244:247], a[24:27], v[248:251]
v_exp_f32 v88, v180
v_mfma_f32_16x16x32_bf16 v[248:251], a[248:251], a[28:31], v[248:251]
ds_read_b64_tr_b16 a[232:233], v23 offset:36864
ds_read_b64_tr_b16 a[234:235], v23 offset:37376
v_mfma_f32_16x16x32_bf16 v[252:255], a[248:251], a[32:35], v[252:255]
v_exp_f32 v89, v181
v_mfma_f32_16x16x32_bf16 v[252:255], a[244:247], a[28:31], v[252:255]
ds_read_b64_tr_b16 a[236:237], v24 offset:36864
ds_read_b64_tr_b16 a[238:239], v24 offset:37376
v_exp_f32 v90, v182
v_cvt_pk_bf16_f32 v175, v94, v95
v_pk_mul_f32 v[96:97], v[168:169], v[96:97]
v_pk_mul_f32 v[98:99], v[170:171], v[98:99]
v_pk_fma_f32 v[84:85], v[84:85], s[50:51], s[50:51]
v_pk_fma_f32 v[86:87], v[86:87], s[50:51], s[50:51]
v_pk_fma_f32 v[88:89], v[88:89], s[50:51], s[50:51]
v_pk_fma_f32 v[188:189], v[188:189], v[60:61], v[64:65]
v_pk_fma_f32 v[190:191], v[190:191], v[62:63], v[66:67]
v_mfma_f32_16x16x32_bf16 v[252:255], a[240:243], a[24:27], v[252:255]
v_rcp_f32 v84, v84
s_waitcnt lgkmcnt(8)
v_mfma_f32_16x16x32_bf16 v[236:239], a[252:255], a[24:27], v[236:239]
ds_read_b64_tr_b16 v[136:137], v23 offset:0
ds_read_b64_tr_b16 v[138:139], v23 offset:512
v_mfma_f32_16x16x32_bf16 v[236:239], v[100:103], a[28:31], v[236:239]
v_rcp_f32 v85, v85
v_mfma_f32_16x16x32_bf16 v[236:239], v[104:107], a[32:35], v[236:239]
ds_read_b64_tr_b16 v[132:133], v24 offset:0
ds_read_b64_tr_b16 v[134:135], v24 offset:512
v_mfma_f32_16x16x32_bf16 v[232:235], v[104:107], a[28:31], v[232:235]
v_rcp_f32 v86, v86
v_mfma_f32_16x16x32_bf16 v[232:235], v[100:103], a[24:27], v[232:235]
ds_read_b64_tr_b16 v[124:125], v23 offset:12288
ds_read_b64_tr_b16 v[126:127], v23 offset:12800
v_mfma_f32_16x16x32_bf16 v[232:235], a[252:255], a[20:23], v[232:235]
buffer_store_dwordx4 v[160:163], v42, s[32:35], s42 offen sc0 sc1
v_rcp_f32 v87, v87
v_cvt_pk_bf16_f32 v172, v96, v97
v_mfma_f32_16x16x32_bf16 v[228:231], a[252:255], a[16:19], v[228:231]
ds_read_b64_tr_b16 v[120:121], v24 offset:12288
ds_read_b64_tr_b16 v[122:123], v24 offset:12800
v_mfma_f32_16x16x32_bf16 v[228:231], v[100:103], a[20:23], v[228:231]
v_rcp_f32 v88, v88
v_mfma_f32_16x16x32_bf16 v[228:231], v[104:107], a[24:27], v[228:231]
v_rcp_f32 v89, v89
v_mfma_f32_16x16x32_bf16 v[224:227], v[104:107], a[20:23], v[224:227]
ds_read_b64_tr_b16 v[128:129], v22 offset:12288
ds_read_b64_tr_b16 v[130:131], v22 offset:12800
v_mfma_f32_16x16x32_bf16 v[224:227], v[100:103], a[16:19], v[224:227]
v_exp_f32 v91, v183
v_mfma_f32_16x16x32_bf16 v[224:227], a[252:255], a[12:15], v[224:227]
v_exp_f32 v92, v188
v_mfma_f32_16x16x32_bf16 v[220:223], a[252:255], a[8:11], v[220:223]
ds_read_b64_tr_b16 v[140:141], v22 offset:0
ds_read_b64_tr_b16 v[142:143], v22 offset:512
v_mfma_f32_16x16x32_bf16 v[220:223], v[100:103], a[12:15], v[220:223]
v_exp_f32 v93, v189
v_mfma_f32_16x16x32_bf16 v[220:223], v[104:107], a[16:19], v[220:223]
v_exp_f32 v94, v190
v_exp_f32 v95, v191
v_cvt_pk_bf16_f32 v173, v98, v99
v_pk_mul_f32 v[84:85], v[176:177], v[84:85]
v_pk_mul_f32 v[86:87], v[178:179], v[86:87]
v_pk_mul_f32 v[88:89], v[180:181], v[88:89]
v_pk_fma_f32 v[90:91], v[90:91], s[50:51], s[50:51]
v_pk_fma_f32 v[92:93], v[92:93], s[50:51], s[50:51]
v_pk_fma_f32 v[184:185], v[184:185], v[52:53], v[56:57]
v_pk_fma_f32 v[186:187], v[186:187], v[54:55], v[58:59]
v_pk_fma_f32 v[192:193], v[192:193], v[52:53], v[56:57]
v_mfma_f32_16x16x32_bf16 v[216:219], v[104:107], a[12:15], v[216:219]
ds_read_b64_tr_b16 a[228:229], v22 offset:36864
ds_read_b64_tr_b16 a[230:231], v22 offset:37376
v_mfma_f32_16x16x32_bf16 v[216:219], v[100:103], a[8:11], v[216:219]
v_permlane16_swap_b32 v172, v174
v_mfma_f32_16x16x32_bf16 v[216:219], a[252:255], a[4:7], v[216:219]
v_permlane16_swap_b32 v173, v175
v_mfma_f32_16x16x32_bf16 v[212:215], a[252:255], a[0:3], v[212:215]
ds_read_b64_tr_b16 a[216:217], v22 offset:24576
ds_read_b64_tr_b16 a[218:219], v22 offset:25088
v_mfma_f32_16x16x32_bf16 v[212:215], v[100:103], a[4:7], v[212:215]
buffer_store_dwordx4 v[172:175], v42, s[32:35], s43 offen sc0 sc1
v_cvt_pk_bf16_f32 v176, v84, v85
v_rcp_f32 v90, v90
v_mfma_f32_16x16x32_bf16 v[212:215], v[104:107], a[8:11], v[212:215]
v_rcp_f32 v91, v91
v_mfma_f32_16x16x32_bf16 v[208:211], v[104:107], a[4:7], v[208:211]
ds_read_b64_tr_b16 v[116:117], v28 offset:49152
ds_read_b64_tr_b16 v[118:119], v28 offset:49664
v_mfma_f32_16x16x32_bf16 v[208:211], v[100:103], a[0:3], v[208:211]
v_rcp_f32 v92, v92
v_mfma_f32_16x16x32_bf16 v[208:211], v[112:115], a[36:39], v[208:211]
v_rcp_f32 v93, v93
v_mfma_f32_16x16x32_bf16 v[208:211], v[108:111], a[40:43], v[208:211]
v_exp_f32 v96, v184
s_waitcnt lgkmcnt(4)
v_mfma_f32_16x16x32_bf16 v[208:211], a[220:223], a[72:75], v[208:211]
v_exp_f32 v97, v185
v_mfma_f32_16x16x32_bf16 v[208:211], a[224:227], a[76:79], v[208:211]
v_exp_f32 v98, v186
v_mfma_f32_16x16x32_bf16 v[208:211], a[232:235], a[108:111], v[208:211]
v_exp_f32 v99, v187
v_mfma_f32_16x16x32_bf16 v[208:211], a[236:239], a[112:115], v[208:211]
v_exp_f32 v84, v192
v_exp_f32 v85, v193
v_cvt_pk_bf16_f32 v177, v86, v87
v_pk_mul_f32 v[90:91], v[182:183], v[90:91]
v_pk_mul_f32 v[92:93], v[188:189], v[92:93]
v_pk_fma_f32 v[94:95], v[94:95], s[50:51], s[50:51]
v_pk_fma_f32 v[96:97], v[96:97], s[50:51], s[50:51]
v_pk_fma_f32 v[98:99], v[98:99], s[50:51], s[50:51]
v_pk_fma_f32 v[194:195], v[194:195], v[54:55], v[58:59]
v_pk_fma_f32 v[196:197], v[196:197], v[60:61], v[64:65]
v_mfma_f32_16x16x32_bf16 v[208:211], v[136:139], a[144:147], v[208:211]
v_rcp_f32 v94, v94
v_mfma_f32_16x16x32_bf16 v[208:211], v[132:135], a[148:151], v[208:211]
v_rcp_f32 v95, v95
v_mfma_f32_16x16x32_bf16 v[208:211], v[124:127], a[180:183], v[208:211]
v_rcp_f32 v96, v96
v_mfma_f32_16x16x32_bf16 v[208:211], v[120:123], a[184:187], v[208:211]
v_rcp_f32 v97, v97
v_mfma_f32_16x16x32_bf16 v[212:215], v[120:123], a[188:191], v[212:215]
v_rcp_f32 v98, v98
v_mfma_f32_16x16x32_bf16 v[212:215], v[124:127], a[184:187], v[212:215]
v_rcp_f32 v99, v99
v_mfma_f32_16x16x32_bf16 v[212:215], v[128:131], a[180:183], v[212:215]
v_exp_f32 v86, v194
v_exp_f32 v87, v195
v_cvt_pk_bf16_f32 v178, v88, v89
v_pk_mul_f32 v[94:95], v[190:191], v[94:95]
v_pk_mul_f32 v[96:97], v[184:185], v[96:97]
v_pk_mul_f32 v[98:99], v[186:187], v[98:99]
v_pk_fma_f32 v[84:85], v[84:85], s[50:51], s[50:51]
v_pk_fma_f32 v[198:199], v[198:199], v[62:63], v[66:67]
v_mfma_f32_16x16x32_bf16 v[212:215], v[132:135], a[152:155], v[212:215]
v_cvt_pk_bf16_f32 v179, v90, v91
v_cvt_pk_bf16_f32 v190, v92, v93
v_mfma_f32_16x16x32_bf16 v[212:215], v[136:139], a[148:151], v[212:215]
v_permlane16_swap_b32 v176, v178
v_mfma_f32_16x16x32_bf16 v[212:215], v[140:143], a[144:147], v[212:215]
v_permlane16_swap_b32 v177, v179
v_mfma_f32_16x16x32_bf16 v[212:215], a[236:239], a[116:119], v[212:215]
buffer_store_dwordx4 v[176:179], v42, s[32:35], s44 offen sc0 sc1
v_cvt_pk_bf16_f32 v191, v94, v95
v_rcp_f32 v84, v84
v_mfma_f32_16x16x32_bf16 v[212:215], a[232:235], a[112:115], v[212:215]
v_rcp_f32 v85, v85
v_mfma_f32_16x16x32_bf16 v[212:215], a[228:231], a[108:111], v[212:215]
v_exp_f32 v88, v196
v_mfma_f32_16x16x32_bf16 v[212:215], a[224:227], a[80:83], v[212:215]
v_exp_f32 v89, v197
v_exp_f32 v90, v198
v_cvt_pk_bf16_f32 v188, v96, v97
v_pk_mul_f32 v[84:85], v[192:193], v[84:85]
v_pk_fma_f32 v[86:87], v[86:87], s[50:51], s[50:51]
v_pk_fma_f32 v[204:205], v[204:205], v[60:61], v[64:65]
v_pk_fma_f32 v[206:207], v[206:207], v[62:63], v[66:67]
v_pk_fma_f32 v[200:201], v[200:201], v[52:53], v[56:57]
v_pk_fma_f32 v[202:203], v[202:203], v[54:55], v[58:59]
v_mfma_f32_16x16x32_bf16 v[212:215], a[220:223], a[76:79], v[212:215]
v_rcp_f32 v86, v86
s_waitcnt lgkmcnt(0)
v_mfma_f32_16x16x32_bf16 v[212:215], a[216:219], a[72:75], v[212:215]
v_rcp_f32 v87, v87
v_mfma_f32_16x16x32_bf16 v[212:215], v[108:111], a[44:47], v[212:215]
v_exp_f32 v91, v199
v_mfma_f32_16x16x32_bf16 v[212:215], v[112:115], a[40:43], v[212:215]
v_exp_f32 v92, v204
v_mfma_f32_16x16x32_bf16 v[212:215], v[116:119], a[36:39], v[212:215]
v_exp_f32 v93, v205
v_mfma_f32_16x16x32_bf16 v[216:219], v[116:119], a[40:43], v[216:219]
v_exp_f32 v94, v206
v_mfma_f32_16x16x32_bf16 v[216:219], v[112:115], a[44:47], v[216:219]
v_exp_f32 v95, v207
v_mfma_f32_16x16x32_bf16 v[216:219], v[108:111], a[48:51], v[216:219]
v_exp_f32 v96, v200
v_exp_f32 v97, v201
v_cvt_pk_bf16_f32 v189, v98, v99
v_pk_mul_f32 v[86:87], v[194:195], v[86:87]
v_pk_fma_f32 v[88:89], v[88:89], s[50:51], s[50:51]
v_pk_fma_f32 v[90:91], v[90:91], s[50:51], s[50:51]
v_pk_fma_f32 v[92:93], v[92:93], s[50:51], s[50:51]
v_pk_fma_f32 v[94:95], v[94:95], s[50:51], s[50:51]
v_pk_fma_f32 v[208:209], v[208:209], v[68:69], v[72:73]
v_mfma_f32_16x16x32_bf16 v[216:219], a[216:219], a[76:79], v[216:219]
v_permlane16_swap_b32 v188, v190
v_mfma_f32_16x16x32_bf16 v[216:219], a[220:223], a[80:83], v[216:219]
v_permlane16_swap_b32 v189, v191
v_mfma_f32_16x16x32_bf16 v[216:219], a[224:227], a[84:87], v[216:219]
buffer_store_dwordx4 v[188:191], v42, s[32:35], s45 offen sc0 sc1
v_rcp_f32 v88, v88
v_cvt_pk_bf16_f32 v192, v84, v85
v_mfma_f32_16x16x32_bf16 v[216:219], a[228:231], a[112:115], v[216:219]
v_rcp_f32 v89, v89
v_mfma_f32_16x16x32_bf16 v[216:219], a[232:235], a[116:119], v[216:219]
v_rcp_f32 v90, v90
v_mfma_f32_16x16x32_bf16 v[216:219], a[236:239], a[120:123], v[216:219]
v_rcp_f32 v91, v91
v_mfma_f32_16x16x32_bf16 v[216:219], v[140:143], a[148:151], v[216:219]
v_rcp_f32 v92, v92
v_mfma_f32_16x16x32_bf16 v[216:219], v[136:139], a[152:155], v[216:219]
v_rcp_f32 v93, v93
v_mfma_f32_16x16x32_bf16 v[216:219], v[132:135], a[156:159], v[216:219]
v_rcp_f32 v94, v94
v_mfma_f32_16x16x32_bf16 v[216:219], v[128:131], a[184:187], v[216:219]
v_rcp_f32 v95, v95
v_mfma_f32_16x16x32_bf16 v[216:219], v[124:127], a[188:191], v[216:219]
v_exp_f32 v98, v202
v_mfma_f32_16x16x32_bf16 v[216:219], v[120:123], a[192:195], v[216:219]
v_exp_f32 v99, v203
v_mfma_f32_16x16x32_bf16 v[220:223], v[120:123], a[196:199], v[220:223]
v_exp_f32 v84, v208
v_exp_f32 v85, v209
v_cvt_pk_bf16_f32 v193, v86, v87
v_pk_mul_f32 v[88:89], v[196:197], v[88:89]
v_pk_mul_f32 v[90:91], v[198:199], v[90:91]
v_pk_mul_f32 v[92:93], v[204:205], v[92:93]
v_pk_mul_f32 v[94:95], v[206:207], v[94:95]
v_pk_fma_f32 v[96:97], v[96:97], s[50:51], s[50:51]
v_pk_fma_f32 v[98:99], v[98:99], s[50:51], s[50:51]
v_pk_fma_f32 v[210:211], v[210:211], v[70:71], v[74:75]
v_pk_fma_f32 v[212:213], v[212:213], v[68:69], v[72:73]
v_mfma_f32_16x16x32_bf16 v[220:223], v[124:127], a[192:195], v[220:223]
v_cvt_pk_bf16_f32 v194, v88, v89
v_cvt_pk_bf16_f32 v195, v90, v91
v_mfma_f32_16x16x32_bf16 v[220:223], v[128:131], a[188:191], v[220:223]
v_permlane16_swap_b32 v192, v194
v_mfma_f32_16x16x32_bf16 v[220:223], v[132:135], a[160:163], v[220:223]
v_permlane16_swap_b32 v193, v195
v_mfma_f32_16x16x32_bf16 v[220:223], v[136:139], a[156:159], v[220:223]
buffer_store_dwordx4 v[192:195], v42, s[32:35], s46 offen sc0 sc1
v_rcp_f32 v96, v96
v_cvt_pk_bf16_f32 v206, v92, v93
v_mfma_f32_16x16x32_bf16 v[220:223], v[140:143], a[152:155], v[220:223]
v_rcp_f32 v97, v97
v_mfma_f32_16x16x32_bf16 v[220:223], a[236:239], a[124:127], v[220:223]
v_rcp_f32 v98, v98
v_mfma_f32_16x16x32_bf16 v[220:223], a[232:235], a[120:123], v[220:223]
v_rcp_f32 v99, v99
v_mfma_f32_16x16x32_bf16 v[220:223], a[228:231], a[116:119], v[220:223]
v_exp_f32 v86, v210
v_mfma_f32_16x16x32_bf16 v[220:223], a[224:227], a[88:91], v[220:223]
v_exp_f32 v87, v211
v_mfma_f32_16x16x32_bf16 v[220:223], a[220:223], a[84:87], v[220:223]
v_exp_f32 v88, v212
v_exp_f32 v89, v213
v_cvt_pk_bf16_f32 v207, v94, v95
v_pk_mul_f32 v[96:97], v[200:201], v[96:97]
v_pk_mul_f32 v[98:99], v[202:203], v[98:99]
v_pk_fma_f32 v[84:85], v[84:85], s[50:51], s[50:51]
v_pk_fma_f32 v[86:87], v[86:87], s[50:51], s[50:51]
v_pk_fma_f32 v[214:215], v[214:215], v[70:71], v[74:75]
v_pk_fma_f32 v[216:217], v[216:217], v[68:69], v[72:73]
v_pk_fma_f32 v[218:219], v[218:219], v[70:71], v[74:75]
v_mfma_f32_16x16x32_bf16 v[220:223], a[216:219], a[80:83], v[220:223]
v_rcp_f32 v84, v84
v_mfma_f32_16x16x32_bf16 v[220:223], v[108:111], a[52:55], v[220:223]
v_rcp_f32 v85, v85
v_mfma_f32_16x16x32_bf16 v[220:223], v[112:115], a[48:51], v[220:223]
v_rcp_f32 v86, v86
v_mfma_f32_16x16x32_bf16 v[220:223], v[116:119], a[44:47], v[220:223]
v_rcp_f32 v87, v87
v_mfma_f32_16x16x32_bf16 v[224:227], v[116:119], a[48:51], v[224:227]
v_exp_f32 v90, v214
v_mfma_f32_16x16x32_bf16 v[224:227], v[112:115], a[52:55], v[224:227]
v_exp_f32 v91, v215
v_mfma_f32_16x16x32_bf16 v[224:227], v[108:111], a[56:59], v[224:227]
v_exp_f32 v92, v216
v_mfma_f32_16x16x32_bf16 v[224:227], a[216:219], a[84:87], v[224:227]
v_exp_f32 v93, v217
v_mfma_f32_16x16x32_bf16 v[224:227], a[220:223], a[88:91], v[224:227]
v_exp_f32 v94, v218
v_exp_f32 v95, v219
v_cvt_pk_bf16_f32 v204, v96, v97
v_pk_mul_f32 v[84:85], v[208:209], v[84:85]
v_pk_mul_f32 v[86:87], v[210:211], v[86:87]
v_pk_fma_f32 v[88:89], v[88:89], s[50:51], s[50:51]
v_pk_fma_f32 v[90:91], v[90:91], s[50:51], s[50:51]
v_pk_fma_f32 v[92:93], v[92:93], s[50:51], s[50:51]
v_pk_fma_f32 v[220:221], v[220:221], v[68:69], v[72:73]
v_pk_fma_f32 v[222:223], v[222:223], v[70:71], v[74:75]
v_mfma_f32_16x16x32_bf16 v[224:227], a[224:227], a[92:95], v[224:227]
v_cvt_pk_bf16_f32 v205, v98, v99
v_cvt_pk_bf16_f32 v208, v84, v85
v_mfma_f32_16x16x32_bf16 v[224:227], a[228:231], a[120:123], v[224:227]
v_permlane16_swap_b32 v204, v206
v_mfma_f32_16x16x32_bf16 v[224:227], a[232:235], a[124:127], v[224:227]
v_permlane16_swap_b32 v205, v207
v_mfma_f32_16x16x32_bf16 v[224:227], a[236:239], a[128:131], v[224:227]
buffer_store_dwordx4 v[204:207], v42, s[32:35], s47 offen sc0 sc1
v_rcp_f32 v88, v88
v_cvt_pk_bf16_f32 v209, v86, v87
v_mfma_f32_16x16x32_bf16 v[224:227], v[140:143], a[156:159], v[224:227]
ds_write_b64 v45, v[208:209] offset:0
v_mfma_f32_16x16x32_bf16 v[224:227], v[136:139], a[160:163], v[224:227]
v_rcp_f32 v89, v89
v_mfma_f32_16x16x32_bf16 v[224:227], v[132:135], a[164:167], v[224:227]
v_rcp_f32 v90, v90
v_mfma_f32_16x16x32_bf16 v[224:227], v[128:131], a[192:195], v[224:227]
v_rcp_f32 v91, v91
v_mfma_f32_16x16x32_bf16 v[224:227], v[124:127], a[196:199], v[224:227]
v_rcp_f32 v92, v92
v_mfma_f32_16x16x32_bf16 v[224:227], v[120:123], a[200:203], v[224:227]
v_rcp_f32 v93, v93
v_mfma_f32_16x16x32_bf16 v[228:231], v[120:123], a[204:207], v[228:231]
v_exp_f32 v96, v220
v_mfma_f32_16x16x32_bf16 v[228:231], v[124:127], a[200:203], v[228:231]
v_exp_f32 v97, v221
v_mfma_f32_16x16x32_bf16 v[228:231], v[128:131], a[196:199], v[228:231]
v_exp_f32 v98, v222
v_exp_f32 v99, v223
v_pk_mul_f32 v[88:89], v[212:213], v[88:89]
v_pk_mul_f32 v[90:91], v[214:215], v[90:91]
v_pk_mul_f32 v[92:93], v[216:217], v[92:93]
v_pk_fma_f32 v[94:95], v[94:95], s[50:51], s[50:51]
v_pk_fma_f32 v[96:97], v[96:97], s[50:51], s[50:51]
v_pk_fma_f32 v[224:225], v[224:225], v[68:69], v[72:73]
v_pk_fma_f32 v[226:227], v[226:227], v[70:71], v[74:75]
v_mfma_f32_16x16x32_bf16 v[228:231], v[132:135], a[168:171], v[228:231]
v_cvt_pk_bf16_f32 v212, v88, v89
v_cvt_pk_bf16_f32 v213, v90, v91
v_mfma_f32_16x16x32_bf16 v[228:231], v[136:139], a[164:167], v[228:231]
ds_write_b64 v45, v[212:213] offset:1024
v_mfma_f32_16x16x32_bf16 v[228:231], v[140:143], a[160:163], v[228:231]
ds_read_b64_tr_b16 a[248:249], v31 offset:49152
ds_read_b64_tr_b16 a[250:251], v31 offset:49664
v_mfma_f32_16x16x32_bf16 v[228:231], a[236:239], a[132:135], v[228:231]
v_rcp_f32 v94, v94
v_mfma_f32_16x16x32_bf16 v[228:231], a[232:235], a[128:131], v[228:231]
ds_read_b64_tr_b16 a[244:245], v32 offset:49152
ds_read_b64_tr_b16 a[246:247], v32 offset:49664
v_mfma_f32_16x16x32_bf16 v[228:231], a[228:231], a[124:127], v[228:231]
v_rcp_f32 v95, v95
v_mfma_f32_16x16x32_bf16 v[228:231], a[224:227], a[96:99], v[228:231]
ds_read_b64_tr_b16 a[240:241], v33 offset:49152
ds_read_b64_tr_b16 a[242:243], v33 offset:49664
v_mfma_f32_16x16x32_bf16 v[228:231], a[220:223], a[92:95], v[228:231]
v_rcp_f32 v96, v96
v_mfma_f32_16x16x32_bf16 v[228:231], a[216:219], a[88:91], v[228:231]
ds_read_b64_tr_b16 a[32:33], v25 offset:24576
ds_read_b64_tr_b16 a[34:35], v25 offset:25088
v_mfma_f32_16x16x32_bf16 v[228:231], v[108:111], a[60:63], v[228:231]
v_rcp_f32 v97, v97
v_mfma_f32_16x16x32_bf16 v[228:231], v[112:115], a[56:59], v[228:231]
ds_read_b64_tr_b16 a[28:29], v26 offset:24576
ds_read_b64_tr_b16 a[30:31], v26 offset:25088
v_mfma_f32_16x16x32_bf16 v[228:231], v[116:119], a[52:55], v[228:231]
v_exp_f32 v84, v224
v_mfma_f32_16x16x32_bf16 v[232:235], v[116:119], a[56:59], v[232:235]
ds_read_b64_tr_b16 a[24:25], v27 offset:24576
ds_read_b64_tr_b16 a[26:27], v27 offset:25088
v_mfma_f32_16x16x32_bf16 v[232:235], v[112:115], a[60:63], v[232:235]
v_exp_f32 v85, v225
v_mfma_f32_16x16x32_bf16 v[232:235], v[108:111], a[64:67], v[232:235]
ds_read_b64_tr_b16 a[20:21], v25 offset:36864
ds_read_b64_tr_b16 a[22:23], v25 offset:37376
v_exp_f32 v86, v226
v_cvt_pk_bf16_f32 v216, v92, v93
v_pk_mul_f32 v[94:95], v[218:219], v[94:95]
v_pk_mul_f32 v[96:97], v[220:221], v[96:97]
v_pk_fma_f32 v[98:99], v[98:99], s[50:51], s[50:51]
v_pk_fma_f32 v[84:85], v[84:85], s[50:51], s[50:51]
v_pk_fma_f32 v[228:229], v[228:229], v[68:69], v[72:73]
v_pk_fma_f32 v[230:231], v[230:231], v[70:71], v[74:75]
v_mfma_f32_16x16x32_bf16 v[232:235], a[216:219], a[92:95], v[232:235]
v_rcp_f32 v98, v98
v_mfma_f32_16x16x32_bf16 v[232:235], a[220:223], a[96:99], v[232:235]
ds_read_b64_tr_b16 a[16:17], v26 offset:36864
ds_read_b64_tr_b16 a[18:19], v26 offset:37376
v_mfma_f32_16x16x32_bf16 v[232:235], a[224:227], a[100:103], v[232:235]
v_rcp_f32 v99, v99
v_mfma_f32_16x16x32_bf16 v[232:235], a[228:231], a[128:131], v[232:235]
ds_read_b64_tr_b16 a[12:13], v27 offset:36864
ds_read_b64_tr_b16 a[14:15], v27 offset:37376
v_mfma_f32_16x16x32_bf16 v[232:235], a[232:235], a[132:135], v[232:235]
v_rcp_f32 v84, v84
v_mfma_f32_16x16x32_bf16 v[232:235], a[236:239], a[136:139], v[232:235]
ds_read_b64_tr_b16 a[252:253], v25 offset:0
ds_read_b64_tr_b16 a[254:255], v25 offset:512
v_mfma_f32_16x16x32_bf16 v[232:235], v[140:143], a[164:167], v[232:235]
v_rcp_f32 v85, v85
v_mfma_f32_16x16x32_bf16 v[232:235], v[136:139], a[168:171], v[232:235]
ds_read_b64_tr_b16 a[8:9], v26 offset:0
ds_read_b64_tr_b16 a[10:11], v26 offset:512
v_mfma_f32_16x16x32_bf16 v[232:235], v[132:135], a[172:175], v[232:235]
v_exp_f32 v87, v227
v_mfma_f32_16x16x32_bf16 v[232:235], v[128:131], a[200:203], v[232:235]
L_pad1_4:
s_cbranch_execz L_body1
ds_read_b64_tr_b16 a[4:5], v27 offset:0
ds_read_b64_tr_b16 a[6:7], v27 offset:512
v_mfma_f32_16x16x32_bf16 v[232:235], v[124:127], a[204:207], v[232:235]
v_exp_f32 v88, v228
v_mfma_f32_16x16x32_bf16 v[232:235], v[120:123], a[208:211], v[232:235]
ds_read_b64_tr_b16 v[104:105], v25 offset:12288
ds_read_b64_tr_b16 v[106:107], v25 offset:12800
v_mfma_f32_16x16x32_bf16 v[236:239], v[120:123], a[212:215], v[236:239]
v_exp_f32 v89, v229
v_mfma_f32_16x16x32_bf16 v[236:239], v[124:127], a[208:211], v[236:239]
ds_read_b64_tr_b16 a[0:1], v26 offset:12288
ds_read_b64_tr_b16 a[2:3], v26 offset:12800
v_mfma_f32_16x16x32_bf16 v[236:239], v[128:131], a[204:207], v[236:239]
v_exp_f32 v90, v230
v_exp_f32 v91, v231
v_cvt_pk_bf16_f32 v217, v94, v95
v_pk_mul_f32 v[98:99], v[222:223], v[98:99]
v_pk_mul_f32 v[84:85], v[224:225], v[84:85]
v_pk_fma_f32 v[86:87], v[86:87], s[50:51], s[50:51]
v_pk_fma_f32 v[88:89], v[88:89], s[50:51], s[50:51]
v_pk_fma_f32 v[232:233], v[232:233], v[68:69], v[72:73]
v_pk_fma_f32 v[234:235], v[234:235], v[70:71], v[74:75]
v_mfma_f32_16x16x32_bf16 v[236:239], v[132:135], a[176:179], v[236:239]
ds_read_b64_tr_b16 v[100:101], v27 offset:12288
ds_read_b64_tr_b16 v[102:103], v27 offset:12800
v_mfma_f32_16x16x32_bf16 v[236:239], v[136:139], a[172:175], v[236:239]
ds_write_b64 v45, v[216:217] offset:2048
v_mfma_f32_16x16x32_bf16 v[236:239], v[140:143], a[168:171], v[236:239]
v_cvt_pk_bf16_f32 v220, v96, v97
v_cvt_pk_bf16_f32 v221, v98, v99
v_mfma_f32_16x16x32_bf16 v[236:239], a[236:239], a[140:143], v[236:239]
ds_write_b64 v45, v[220:221] offset:3072
v_mfma_f32_16x16x32_bf16 v[236:239], a[232:235], a[136:139], v[236:239]
v_rcp_f32 v86, v86
v_mfma_f32_16x16x32_bf16 v[236:239], a[228:231], a[132:135], v[236:239]
v_rcp_f32 v87, v87
v_mfma_f32_16x16x32_bf16 v[236:239], a[224:227], a[104:107], v[236:239]
v_rcp_f32 v88, v88
v_mfma_f32_16x16x32_bf16 v[236:239], a[220:223], a[100:103], v[236:239]
v_rcp_f32 v89, v89
v_mfma_f32_16x16x32_bf16 v[236:239], a[216:219], a[96:99], v[236:239]
v_exp_f32 v92, v232
v_mfma_f32_16x16x32_bf16 v[236:239], v[108:111], a[68:71], v[236:239]
v_exp_f32 v93, v233
v_mfma_f32_16x16x32_bf16 v[236:239], v[112:115], a[64:67], v[236:239]
s_waitcnt lgkmcnt(0)
s_barrier
ds_read_b128 v[208:211], v46 offset:0
v_exp_f32 v94, v234
v_exp_f32 v95, v235
v_pk_mul_f32 v[86:87], v[226:227], v[86:87]
v_pk_mul_f32 v[88:89], v[228:229], v[88:89]
v_pk_fma_f32 v[90:91], v[90:91], s[50:51], s[50:51]
v_pk_fma_f32 v[92:93], v[92:93], s[50:51], s[50:51]
v_mfma_f32_16x16x32_bf16 v[236:239], v[116:119], a[60:63], v[236:239]
ds_read_b128 v[216:219], v46 offset:2048
v_cvt_pk_bf16_f32 v224, v84, v85
v_mfma_f32_16x16x32_bf16 v[240:243], a[248:251], a[48:51], v[240:243]
v_rcp_f32 v90, v90
v_mfma_f32_16x16x32_bf16 v[240:243], a[244:247], a[52:55], v[240:243]
v_rcp_f32 v91, v91
v_mfma_f32_16x16x32_bf16 v[240:243], a[240:243], a[56:59], v[240:243]
v_rcp_f32 v92, v92
v_rcp_f32 v93, v93
v_cvt_pk_bf16_f32 v225, v86, v87
v_pk_mul_f32 v[90:91], v[230:231], v[90:91]
v_pk_fma_f32 v[94:95], v[94:95], s[50:51], s[50:51]
v_pk_fma_f32 v[236:237], v[236:237], v[68:69], v[72:73]
v_pk_fma_f32 v[238:239], v[238:239], v[70:71], v[74:75]
v_mfma_f32_16x16x32_bf16 v[240:243], a[32:35], a[84:87], v[240:243]
ds_write_b64 v45, v[224:225] offset:4096
v_mfma_f32_16x16x32_bf16 v[240:243], a[28:31], a[88:91], v[240:243]
v_rcp_f32 v94, v94
v_mfma_f32_16x16x32_bf16 v[240:243], a[24:27], a[92:95], v[240:243]
v_rcp_f32 v95, v95
v_mfma_f32_16x16x32_bf16 v[240:243], a[20:23], a[120:123], v[240:243]
v_exp_f32 v96, v236
v_mfma_f32_16x16x32_bf16 v[240:243], a[16:19], a[124:127], v[240:243]
s_waitcnt lgkmcnt(2)
buffer_store_dwordx4 v[208:211], v43, s[32:35], s56 offen sc0 sc1
v_exp_f32 v97, v237
v_cvt_pk_bf16_f32 v228, v88, v89
v_mfma_f32_16x16x32_bf16 v[240:243], a[12:15], a[128:131], v[240:243]
v_exp_f32 v98, v238
v_exp_f32 v99, v239
v_cvt_pk_bf16_f32 v229, v90, v91
v_pk_mul_f32 v[92:93], v[232:233], v[92:93]
v_pk_mul_f32 v[94:95], v[234:235], v[94:95]
v_pk_fma_f32 v[96:97], v[96:97], s[50:51], s[50:51]
v_mfma_f32_16x16x32_bf16 v[240:243], a[252:255], a[156:159], v[240:243]
ds_write_b64 v45, v[228:229] offset:5120
v_mfma_f32_16x16x32_bf16 v[240:243], a[8:11], a[160:163], v[240:243]
v_rcp_f32 v96, v96
v_mfma_f32_16x16x32_bf16 v[240:243], a[4:7], a[164:167], v[240:243]
v_rcp_f32 v97, v97
v_mfma_f32_16x16x32_bf16 v[240:243], v[104:107], a[192:195], v[240:243]
v_cvt_pk_bf16_f32 v232, v92, v93
v_cvt_pk_bf16_f32 v233, v94, v95
v_mfma_f32_16x16x32_bf16 v[240:243], a[0:3], a[196:199], v[240:243]
ds_write_b64 v45, v[232:233] offset:6144
v_mfma_f32_16x16x32_bf16 v[240:243], v[100:103], a[200:203], v[240:243]
v_fma_f32 v98, v98, s50, s50
v_fma_f32 v99, v99, s50, s50
v_mfma_f32_16x16x32_bf16 v[244:247], v[100:103], a[204:207], v[244:247]
v_rcp_f32 v98, v98
v_mfma_f32_16x16x32_bf16 v[244:247], a[0:3], a[200:203], v[244:247]
v_rcp_f32 v99, v99
v_mfma_f32_16x16x32_bf16 v[244:247], v[104:107], a[196:199], v[244:247]
s_nop 0
v_fma_f32 v240, v240, v76, v80
v_fma_f32 v241, v241, v77, v81
v_mfma_f32_16x16x32_bf16 v[244:247], a[4:7], a[168:171], v[244:247]
v_exp_f32 v84, v240
v_exp_f32 v85, v241
v_pk_mul_f32 v[96:97], v[236:237], v[96:97]
v_pk_mul_f32 v[98:99], v[238:239], v[98:99]
v_pk_fma_f32 v[242:243], v[242:243], v[78:79], v[82:83]
v_mfma_f32_16x16x32_bf16 v[244:247], a[8:11], a[164:167], v[244:247]
v_exp_f32 v86, v242
v_mfma_f32_16x16x32_bf16 v[244:247], a[252:255], a[160:163], v[244:247]
v_exp_f32 v87, v243
v_mfma_f32_16x16x32_bf16 v[244:247], a[12:15], a[132:135], v[244:247]
s_waitcnt lgkmcnt(1)
buffer_store_dwordx4 v[216:219], v43, s[32:35], s57 offen sc0 sc1
v_cvt_pk_bf16_f32 v236, v96, v97
v_cvt_pk_bf16_f32 v237, v98, v99
v_fma_f32 v84, v84, s50, s50
v_mfma_f32_16x16x32_bf16 v[244:247], a[16:19], a[128:131], v[244:247]
ds_write_b64 v45, v[236:237] offset:7168
v_mfma_f32_16x16x32_bf16 v[244:247], a[20:23], a[124:127], v[244:247]
v_fma_f32 v85, v85, s50, s50
v_fma_f32 v86, v86, s50, s50
v_mfma_f32_16x16x32_bf16 v[244:247], a[24:27], a[96:99], v[244:247]
v_rcp_f32 v84, v84
v_mfma_f32_16x16x32_bf16 v[244:247], a[28:31], a[92:95], v[244:247]
v_rcp_f32 v85, v85
v_mfma_f32_16x16x32_bf16 v[244:247], a[32:35], a[88:91], v[244:247]
v_fma_f32 v87, v87, s50, s50
v_mul_f32 v84, v240, v84
v_mfma_f32_16x16x32_bf16 v[244:247], a[240:243], a[60:63], v[244:247]
v_rcp_f32 v86, v86
v_mfma_f32_16x16x32_bf16 v[244:247], a[244:247], a[56:59], v[244:247]
v_rcp_f32 v87, v87
v_mfma_f32_16x16x32_bf16 v[244:247], a[248:251], a[52:55], v[244:247]
s_waitcnt lgkmcnt(0)
s_barrier
ds_read_b128 v[224:227], v46 offset:4096
v_mul_f32 v85, v241, v85
v_mfma_f32_16x16x32_bf16 v[248:251], a[248:251], a[56:59], v[248:251]
ds_read_b128 v[232:235], v46 offset:6144
v_cvt_pk_bf16_f32 v240, v84, v85
v_mfma_f32_16x16x32_bf16 v[248:251], a[244:247], a[60:63], v[248:251]
v_mul_f32 v86, v242, v86
v_mul_f32 v87, v243, v87
v_mfma_f32_16x16x32_bf16 v[248:251], a[240:243], a[64:67], v[248:251]
v_cvt_pk_bf16_f32 v241, v86, v87
v_fma_f32 v244, v244, v76, v80
v_mfma_f32_16x16x32_bf16 v[248:251], a[32:35], a[92:95], v[248:251]
ds_write_b64 v45, v[240:241] offset:8192
v_mfma_f32_16x16x32_bf16 v[248:251], a[28:31], a[96:99], v[248:251]
v_fma_f32 v245, v245, v77, v81
v_fma_f32 v246, v246, v78, v82
v_mfma_f32_16x16x32_bf16 v[248:251], a[24:27], a[100:103], v[248:251]
v_exp_f32 v88, v244
v_mfma_f32_16x16x32_bf16 v[248:251], a[20:23], a[128:131], v[248:251]
v_exp_f32 v89, v245
v_mfma_f32_16x16x32_bf16 v[248:251], a[16:19], a[132:135], v[248:251]
v_fma_f32 v247, v247, v79, v83
v_fma_f32 v88, v88, s50, s50
v_mfma_f32_16x16x32_bf16 v[248:251], a[12:15], a[136:139], v[248:251]
s_waitcnt lgkmcnt(2)
buffer_store_dwordx4 v[224:227], v43, s[32:35], s58 offen sc0 sc1
v_exp_f32 v90, v246
v_fma_f32 v89, v89, s50, s50
v_mfma_f32_16x16x32_bf16 v[248:251], a[252:255], a[164:167], v[248:251]
v_rcp_f32 v88, v88
v_mfma_f32_16x16x32_bf16 v[248:251], a[8:11], a[168:171], v[248:251]
v_rcp_f32 v89, v89
v_mfma_f32_16x16x32_bf16 v[248:251], a[4:7], a[172:175], v[248:251]
v_exp_f32 v91, v247
v_mfma_f32_16x16x32_bf16 v[248:251], v[104:107], a[200:203], v[248:251]
v_fma_f32 v90, v90, s50, s50
v_fma_f32 v91, v91, s50, s50
v_mfma_f32_16x16x32_bf16 v[248:251], a[0:3], a[204:207], v[248:251]
v_rcp_f32 v90, v90
v_mfma_f32_16x16x32_bf16 v[248:251], v[100:103], a[208:211], v[248:251]
v_rcp_f32 v91, v91
v_mfma_f32_16x16x32_bf16 v[252:255], v[100:103], a[212:215], v[252:255]
v_mul_f32 v88, v244, v88
v_mul_f32 v89, v245, v89
v_mfma_f32_16x16x32_bf16 v[252:255], a[0:3], a[208:211], v[252:255]
v_cvt_pk_bf16_f32 v244, v88, v89
v_mul_f32 v90, v246, v90
v_mfma_f32_16x16x32_bf16 v[252:255], v[104:107], a[204:207], v[252:255]
v_mul_f32 v91, v247, v91
v_fma_f32 v248, v248, v76, v80
v_mfma_f32_16x16x32_bf16 v[252:255], a[4:7], a[176:179], v[252:255]
v_cvt_pk_bf16_f32 v245, v90, v91
v_fma_f32 v249, v249, v77, v81
v_mfma_f32_16x16x32_bf16 v[252:255], a[8:11], a[172:175], v[252:255]
ds_write_b64 v45, v[244:245] offset:9216
v_mfma_f32_16x16x32_bf16 v[252:255], a[252:255], a[168:171], v[252:255]
v_exp_f32 v92, v248
v_mfma_f32_16x16x32_bf16 v[252:255], a[12:15], a[140:143], v[252:255]
v_exp_f32 v93, v249
v_mfma_f32_16x16x32_bf16 v[252:255], a[16:19], a[136:139], v[252:255]
s_waitcnt lgkmcnt(1)
buffer_store_dwordx4 v[232:235], v43, s[32:35], s59 offen sc0 sc1
v_fma_f32 v92, v92, s50, s50
v_fma_f32 v93, v93, s50, s50
v_fma_f32 v250, v250, v78, v82
v_mfma_f32_16x16x32_bf16 v[252:255], a[20:23], a[132:135], v[252:255]
v_rcp_f32 v92, v92
v_mfma_f32_16x16x32_bf16 v[252:255], a[24:27], a[104:107], v[252:255]
v_rcp_f32 v93, v93
v_mfma_f32_16x16x32_bf16 v[252:255], a[28:31], a[100:103], v[252:255]
v_fma_f32 v251, v251, v79, v83
v_mul_f32 v92, v248, v92
v_mfma_f32_16x16x32_bf16 v[252:255], a[32:35], a[96:99], v[252:255]
s_waitcnt lgkmcnt(0)
s_barrier
ds_read_b128 v[240:243], v46 offset:8192
v_mul_f32 v93, v249, v93
v_mfma_f32_16x16x32_bf16 v[252:255], a[240:243], a[68:71], v[252:255]
v_exp_f32 v94, v250
v_mfma_f32_16x16x32_bf16 v[252:255], a[244:247], a[64:67], v[252:255]
v_exp_f32 v95, v251
v_mfma_f32_16x16x32_bf16 v[252:255], a[248:251], a[60:63], v[252:255]
v_cvt_pk_bf16_f32 v248, v92, v93
v_pk_fma_f32 v[94:95], v[94:95], s[50:51], s[50:51]
v_rcp_f32 v94, v94
v_rcp_f32 v95, v95
s_nop 0
v_pk_mul_f32 v[94:95], v[250:251], v[94:95]
v_cvt_pk_bf16_f32 v249, v94, v95
s_nop 0
v_pk_fma_f32 v[252:253], v[252:253], v[76:77], v[80:81]
v_pk_fma_f32 v[254:255], v[254:255], v[78:79], v[82:83]
ds_write_b64 v45, v[248:249] offset:10240
v_exp_f32 v96, v252
v_exp_f32 v97, v253
v_exp_f32 v98, v254
v_exp_f32 v99, v255
v_pk_fma_f32 v[96:97], v[96:97], s[50:51], s[50:51]
v_pk_fma_f32 v[98:99], v[98:99], s[50:51], s[50:51]
v_rcp_f32 v96, v96
v_rcp_f32 v97, v97
v_rcp_f32 v98, v98
v_rcp_f32 v99, v99
v_pk_mul_f32 v[96:97], v[252:253], v[96:97]
v_pk_mul_f32 v[98:99], v[254:255], v[98:99]
v_cvt_pk_bf16_f32 v252, v96, v97
v_cvt_pk_bf16_f32 v253, v98, v99
ds_write_b64 v45, v[252:253] offset:11264
s_waitcnt lgkmcnt(0)
s_barrier
ds_read_b128 v[248:251], v46 offset:10240
buffer_store_dwordx4 v[240:243], v44, s[32:35], s58 offen sc0 sc1
s_waitcnt lgkmcnt(0)
buffer_store_dwordx4 v[248:251], v44, s[32:35], s59 offen sc0 sc1
L_last:
s_endpgm
.section .rodata,"a"
.p2align 6
.amdhsa_kernel standalone__batchnorm__sampling_kernel
  .amdhsa_next_free_vgpr 512
  .amdhsa_next_free_sgpr 102
  .amdhsa_accum_offset 256
  .amdhsa_group_segment_fixed_size 0
  .amdhsa_kernarg_size 72
  .amdhsa_user_sgpr_count 2
  .amdhsa_user_sgpr_kernarg_segment_ptr 1
  .amdhsa_system_sgpr_workgroup_id_x 1
.end_amdhsa_kernel
```
